```python
import torch

def _softmax(x, axis=-1):
    return torch.softmax(x, dim=axis)

def _gelu(x):
    return torch.nn.functional.gelu(x, approximate='tanh')

def _silu(x):
    return torch.nn.functional.silu(x)

def _sigmoid(x):
    return torch.sigmoid(x)

def _layernorm(x, axis=-1, eps=1e-05):
    m = x.mean(dim=axis, keepdim=True)
    v = x.var(dim=axis, keepdim=True, unbiased=False)
    return (x - m) / torch.sqrt(v + eps)

def _scatter_add(tgt, idx, src, axis=0):
    return tgt.clone().index_add_(axis, idx, src)

def _segment_sum(src, seg, n):
    out = torch.zeros((n,) + src.shape[1:], dtype=src.dtype)
    return out.index_add_(0, seg, src)

def _pad(x, pw):
    flat = tuple((v for pair in reversed(pw) for v in pair))
    return torch.nn.functional.pad(x, flat)
kernel_name = 'concat_heads__memory_aug_recurrent_mem_tr__ssm_conv_s4__prompt'

def setup_inputs():

    _w = lambda a: (lambda t: t.to(torch.bfloat16) if t.is_floating_point() else t)(torch.as_tensor(a))

    def _A_setup():
        B, S, Dm = (1, 2048, 640)
        H, Dh = (32, 128)
        M, seg = (8, 32)
        seg = min(seg, S)
        S = S // seg * seg
        return {'x': _w((lambda *s: torch.randn(*s, dtype=torch.bfloat16) * 0.05)(B, S, Dm)), 'mem0': _w((lambda *s: torch.randn(*s, dtype=torch.bfloat16) * 0.4)(B, M, Dm)), 'Wq': _w((lambda *s: torch.randn(*s, dtype=torch.bfloat16) * 6.4)(Dm, H, Dh) * Dm ** (-0.5)), 'Wk': _w((lambda *s: torch.randn(*s, dtype=torch.bfloat16) * 6.4)(Dm, H, Dh) * Dm ** (-0.5)), 'Wv': _w((lambda *s: torch.randn(*s, dtype=torch.bfloat16) * 0.4)(Dm, H, Dh) * Dm ** (-0.5)), 'Wo': _w((lambda *s: torch.randn(*s, dtype=torch.bfloat16) * 0.4)(H, Dh, Dm) * (H * Dh) ** (-0.5)), 'seg_len': seg}
    _A_in = _A_setup()

    def _B_setup():
        B, L, D, N = (1, 2048, 640, 128)
        A_re = -(lambda _x: torch.exp(torch.as_tensor(_x)))((lambda *s: torch.randn(*s, dtype=torch.bfloat16) * 6.4)(D, N))
        A_im = torch.pi * (lambda *s: torch.randn(*s, dtype=torch.bfloat16) * 0.05)(D, N)
        B_re = (lambda *s: torch.randn(*s, dtype=torch.bfloat16) * 0.1)(D, N)
        B_im = (lambda *s: torch.randn(*s, dtype=torch.bfloat16) * 0.1)(D, N)
        C_re = (lambda *s: torch.randn(*s, dtype=torch.bfloat16) * 0.1)(D, N)
        C_im = (lambda *s: torch.randn(*s, dtype=torch.bfloat16) * 0.1)(D, N)
        log_dt = (lambda *s: torch.randn(*s, dtype=torch.bfloat16) * 0.05)(D) * 0.5 - 4.0
        Dskip = (lambda *s: torch.randn(*s, dtype=torch.bfloat16) * 0.05)(D)
        return {'u': _w((lambda *s: torch.randn(*s, dtype=torch.bfloat16) * 0.05)(B, L, D)), 'A_re': _w(A_re), 'A_im': _w(A_im), 'B_re': _w(B_re), 'B_im': _w(B_im), 'C_re': _w(C_re), 'C_im': _w(C_im), 'log_dt': _w(log_dt), 'Dskip': _w(Dskip)}
    _B_in = _B_setup()
    return {'A_x': _A_in['x'], 'A_mem0': _A_in['mem0'], 'A_Wq': _A_in['Wq'], 'A_Wk': _A_in['Wk'], 'A_Wv': _A_in['Wv'], 'A_Wo': _A_in['Wo'], 'A_seg_len': _A_in['seg_len'], 'B_u': _B_in['u'], 'B_A_re': _B_in['A_re'], 'B_A_im': _B_in['A_im'], 'B_B_re': _B_in['B_re'], 'B_B_im': _B_in['B_im'], 'B_C_re': _B_in['C_re'], 'B_C_im': _B_in['C_im'], 'B_log_dt': _B_in['log_dt'], 'B_Dskip': _B_in['Dskip']}

def reference(A_x, A_mem0, A_Wq, A_Wk, A_Wv, A_Wo, A_seg_len, B_u, B_A_re, B_A_im, B_B_re, B_B_im, B_C_re, B_C_im, B_log_dt, B_Dskip):

    def _A_ref(x, mem0, Wq, Wk, Wv, Wo, seg_len):
        B, S, Dm = x.shape
        H, Dh = (Wq.shape[1], Wq.shape[2])
        M = mem0.shape[1]
        scale = Dh ** (-0.5)
        n_seg = S // seg_len
        L = M + seg_len
        idx = torch.arange(L)
        mask = (idx[:, None] < M) | (idx[:, None] >= idx[None, :])
        mem = mem0
        outs = []
        for s in range(n_seg):
            xs = x[:, s * seg_len:(s + 1) * seg_len, :].clone()
            h = torch.concatenate([mem, xs], axis=1)
            q = torch.einsum('btd,dhe->bhte', h, Wq)
            k = torch.einsum('btd,dhe->bhte', h, Wk)
            v = torch.einsum('btd,dhe->bhte', h, Wv)
            scores = torch.einsum('bhqe,bhke->bhqk', q, k) * scale
            scores = torch.where(mask[None, None], scores, -1000000000.0)
            p = _softmax(scores, axis=-1)
            o = torch.einsum('bhqk,bhke->bhqe', p, v)
            o = torch.einsum('bhte,hed->btd', o, Wo)
            mem = o[:, :M, :].clone()
            outs.append(o[:, M:, :])
        return torch.concatenate(outs, axis=1)

    def _B_ref(u, A_re, A_im, B_re, B_im, C_re, C_im, log_dt, Dskip):
        Bsz, L, D = u.shape
        dt = torch.exp(log_dt)[:, None]
        A = A_re + 1j * A_im
        Bc = B_re + 1j * B_im
        Cc = C_re + 1j * C_im
        logdA = dt * A
        dB = dt * Bc
        l = (lambda x, dt: x.to(dt))(torch.arange(L), A_re.dtype)
        P = torch.exp(logdA[:, :, None] * l[None, None, :])
        K = torch.einsum('dn,dnl,dn->dl', Cc, P, dB).real
        L2 = 2 * L
        Kp = _pad(K, ((0, 0), (0, L)))
        up = (lambda x, *d: x.permute(*d))(u, 0, 2, 1)
        up = _pad(up, ((0, 0), (0, 0), (0, L)))
        Kf = (lambda x, axes=(-2, -1): torch.fft.rfft2(x.float(), dim=axes))(Kp[:, None, :], axes=(-2, -1))
        Uf = (lambda x, axes=(-2, -1): torch.fft.rfft2(x.float(), dim=axes))(up[:, :, None, :], axes=(-2, -1))
        Yf = Uf * Kf[None, :, :, :]
        y = (lambda x, s, axes=(-2, -1): torch.fft.irfft2(x, s=s, dim=axes).to(torch.bfloat16))(Yf, (1, L2), axes=(-2, -1))[:, :, 0, :L]
        y = (lambda x, *d: x.permute(*d))(y, 0, 2, 1) + u * Dskip[None, None, :]
        return y
    a = _A_ref(A_x, A_mem0, A_Wq, A_Wk, A_Wv, A_Wo, A_seg_len)
    b = _B_ref(B_u, B_A_re, B_A_im, B_B_re, B_B_im, B_C_re, B_C_im, B_log_dt, B_Dskip)
    return torch.concatenate([a, b], axis=-1)
```

```asm
; @launch grid=(256,1,1) block=(256,1,1) lds=163840
.amdgcn_target "amdgcn-amd-amdhsa--gfx950"
.text
.globl concat_heads__memory_aug_recurrent_mem_tr__ssm_conv_s4__prompt_kernel
.p2align 8
.type concat_heads__memory_aug_recurrent_mem_tr__ssm_conv_s4__prompt_kernel,@function
concat_heads__memory_aug_recurrent_mem_tr__ssm_conv_s4__prompt_kernel:
    s_cmp_ge_u32 s2, 256
    s_cbranch_scc1 L_end
    s_load_dwordx4 s[4:7], s[0:1], 136
    s_getreg_b32 s23, hwreg(HW_REG_XCC_ID)
    s_and_b32 s23, s23, 15
    s_lshl_b32 s24, s23, 2
    s_lshr_b32 s24, 0x76325140, s24
    s_and_b32 s24, s24, 7
    s_cmp_lt_u32 s23, 8
    s_cselect_b32 s23, s24, s23
    v_lshrrev_b32 v1, 6, v0
    v_and_b32 v255, 63, v0
    s_and_b32 s24, s23, 1
    s_lshl_b32 s24, s24, 6
    s_lshr_b32 s25, s23, 1
    s_lshl_b32 s25, s25, 2
    s_add_u32 s25, s25, 128
    s_cmp_lt_u32 s23, 2
    s_cselect_b32 s25, 0, s25
    s_add_u32 s24, s24, s25
    v_readfirstlane_b32 s22, v1
    v_mov_b32 v2, 0
    s_waitcnt lgkmcnt(0)
    s_mov_b32 s8, s6
    s_and_b32 s9, s7, 0xffff
    s_mov_b32 s10, 0x10000000
    s_mov_b32 s11, 0x00020000
    s_mov_b32 s16, s4
    s_and_b32 s17, s5, 0xffff
    s_mov_b32 s18, 0x100
    s_mov_b32 s19, 0x00020000
    s_cmp_lg_u32 s22, 0
    s_cbranch_scc1 L_noat
    s_mov_b64 exec, 1
    v_mov_b32 v3, 1
    buffer_atomic_add v3, off, s[16:19], s24 sc0 sc1
    s_mov_b64 exec, -1
    s_getpc_b64 s[26:27]
    s_bfe_u32 s28, s2, 0x30003
    s_lshl_b32 s28, s28, 13
    v_lshl_add_u32 v4, v255, 7, s28
    v_min_u32 v4, L_end-.-16, v4
    global_load_dword v254, v4, s[26:27]
L_noat:
    s_mov_b32 s46, 1
    s_cmp_lt_u32 s23, 6
    s_cbranch_scc1 L_pre2
    s_cmp_lg_u32 s22, 1
    s_cbranch_scc1 L_pre2
    s_and_b32 s26, s2, 127
    s_lshl_b32 s26, s26, 14
    s_add_u32 s26, s26, 83892224
    s_add_u32 s26, s6, s26
    s_addc_u32 s27, s7, 0
    s_load_dword s28, s[26:27], 0 glc
    s_load_dword s29, s[26:27], 8192 glc
    s_mov_b32 s34, 0
    s_mov_b32 s31, 0
    s_mov_b32 s33, -1
    s_mov_b32 s35, -1
    s_waitcnt lgkmcnt(0)
    s_xor_b32 s29, s29, s28
L_pro:
    s_cmp_eq_u32 s34, 0
    s_cselect_b32 s32, 400, 0
    s_not_b32 s30, s28
    s_load_dword s30, s[26:27], s31 glc
L_pr:
    s_add_u32 s32, s32, 1
    s_cmp_eq_u32 s30, s28
    s_cbranch_scc1 L_pre
    s_cmp_lt_u32 s32, 500
    s_cbranch_scc1 L_pr
L_pre:
    s_waitcnt lgkmcnt(0)
    s_min_u32 s32, s32, s33
    s_mov_b32 s33, s35
    s_mov_b32 s35, s32
    s_xor_b32 s28, s28, s29
    s_xor_b32 s31, s31, 8192
    s_add_u32 s34, s34, 1
    s_cmp_lt_u32 s34, 9
    s_cbranch_scc1 L_pro
    s_cmp_gt_u32 s35, s33
    s_cselect_b32 s46, 1, 0x10001
L_pre2:
    s_load_dwordx2 s[58:59], s[0:1], 8
    s_load_dwordx8 s[60:67], s[0:1], 16
    v_and_b32 v20, 63, v0
    v_lshrrev_b32 v21, 6, v0
    v_and_b32 v22, 15, v20
    v_lshrrev_b32 v23, 4, v20
    s_mul_i32 s57, s22, 38912
    s_add_u32 s57, s57, 8192
    v_and_b32 v24, 1, v23
    v_lshrrev_b32 v25, 1, v23
    v_lshlrev_b32 v26, 1, v23
    v_xor_b32 v26, v26, v22
    v_lshrrev_b32 v29, 1, v21
    v_and_b32 v30, 1, v21
    v_lshl_add_u32 v31, v25, 4, v24
    v_lshl_add_u32 v31, v29, 5, v31
    v_lshl_add_u32 v31, v30, 3, v31
    v_lshlrev_b32 v31, 13, v31
    v_lshl_add_u32 v32, v25, 3, v24
    v_lshl_add_u32 v32, v21, 4, v32
    v_lshlrev_b32 v32, 13, v32
    v_lshl_add_u32 v33, v25, 5, v24
    v_lshl_add_u32 v33, v21, 2, v33
    v_mul_u32_u24 v33, 1280, v33
    v_lshl_add_u32 v60, v26, 4, v31
    v_lshl_add_u32 v62, v26, 4, v32
    v_lshl_add_u32 v64, v26, 4, v33
    v_bfe_u32 v27, v26, 1, 1
    v_mul_u32_u24 v27, 81920, v27
    v_add_u32 v27, v27, v33
    v_lshrrev_b32 v34, 2, v26
    v_lshl_add_u32 v27, v34, 5, v27
    v_and_b32 v34, 1, v26
    v_lshl_add_u32 v66, v34, 4, v27
    v_xor_b32 v26, 8, v26
    v_lshl_add_u32 v61, v26, 4, v31
    v_lshl_add_u32 v63, v26, 4, v32
    v_lshl_add_u32 v65, v26, 4, v33
    v_bfe_u32 v27, v26, 1, 1
    v_mul_u32_u24 v27, 81920, v27
    v_add_u32 v27, v27, v33
    v_lshrrev_b32 v34, 2, v26
    v_lshl_add_u32 v27, v34, 5, v27
    v_and_b32 v34, 1, v26
    v_lshl_add_u32 v67, v34, 4, v27
    v_bfe_u32 v26, v20, 2, 2
    v_lshl_add_u32 v27, v24, 2, v26
    v_lshlrev_b32 v27, 1, v27
    v_bfe_u32 v29, v20, 1, 1
    v_lshl_add_u32 v29, v21, 2, v29
    v_xor_b32 v29, v29, v27
    v_lshlrev_b32 v29, 4, v29
    v_lshl_add_u32 v26, v24, 3, v26
    v_lshl_add_u32 v29, v26, 8, v29
    v_and_b32 v26, 1, v20
    v_lshl_add_u32 v29, v26, 3, v29
    v_mul_u32_u24 v26, 38912, v25
    v_add_u32 v26, 8192, v26
    v_add_u32 v68, v29, v26
    v_xor_b32 v29, 32, v29
    v_add_u32 v69, v29, v26
    v_add_u32 v70, 77824, v68
    v_add_u32 v71, 77824, v69
L_nopr:
    s_cmp_lg_u32 s22, 0
    s_cbranch_scc1 L_reg
    s_waitcnt vmcnt(1)
    s_mov_b64 exec, 1
    ds_write_b32 v2, v3
    s_mov_b64 exec, -1
    s_waitcnt lgkmcnt(0)
L_reg:
    s_barrier
    ds_read_b32 v3, v2
    s_waitcnt lgkmcnt(0)
    v_readfirstlane_b32 s21, v3
    s_mov_b32 s20, s23
    s_cmp_ge_u32 s23, 8
    s_cbranch_scc1 L_other
    s_cmp_lt_u32 s21, 32
    s_cbranch_scc1 L_seat
L_other:
    v_and_b32 v4, 1, v255
    v_lshlrev_b32 v4, 6, v4
    v_lshrrev_b32 v5, 1, v255
    v_lshlrev_b32 v5, 2, v5
    v_add_u32 v5, 128, v5
    v_cmp_gt_u32 vcc, 2, v255
    s_mov_b32 s26, 0
    s_nop 0
    v_cndmask_b32 v5, v5, v2, vcc
    v_add_u32 v4, v4, v5
L_cnt:
    s_mov_b64 exec, 0xffff
    buffer_load_dword v5, v4, s[16:19], 0 offen sc1
    s_add_u32 s26, s26, 1
    s_cmp_gt_u32 s26, 200000
    s_cbranch_scc1 L_end
    s_waitcnt vmcnt(0)
    s_mov_b64 exec, -1
    s_mov_b32 s27, 0
    s_mov_b32 s28, 0
    v_readlane_b32 s29, v5, 0
    s_add_u32 s27, s27, s29
    s_min_u32 s30, s29, 32
    s_sub_u32 s29, s29, s30
    s_cmp_gt_u32 s23, 0
    s_cselect_b32 s29, s29, 0
    s_add_u32 s28, s28, s29
    v_readlane_b32 s29, v5, 1
    s_add_u32 s27, s27, s29
    s_min_u32 s31, s29, 32
    s_sub_u32 s29, s29, s31
    s_cmp_gt_u32 s23, 1
    s_cselect_b32 s29, s29, 0
    s_add_u32 s28, s28, s29
    v_readlane_b32 s29, v5, 2
    s_add_u32 s27, s27, s29
    s_min_u32 s32, s29, 32
    s_sub_u32 s29, s29, s32
    s_cmp_gt_u32 s23, 2
    s_cselect_b32 s29, s29, 0
    s_add_u32 s28, s28, s29
    v_readlane_b32 s29, v5, 3
    s_add_u32 s27, s27, s29
    s_min_u32 s33, s29, 32
    s_sub_u32 s29, s29, s33
    s_cmp_gt_u32 s23, 3
    s_cselect_b32 s29, s29, 0
    s_add_u32 s28, s28, s29
    v_readlane_b32 s29, v5, 4
    s_add_u32 s27, s27, s29
    s_min_u32 s34, s29, 32
    s_sub_u32 s29, s29, s34
    s_cmp_gt_u32 s23, 4
    s_cselect_b32 s29, s29, 0
    s_add_u32 s28, s28, s29
    v_readlane_b32 s29, v5, 5
    s_add_u32 s27, s27, s29
    s_min_u32 s35, s29, 32
    s_sub_u32 s29, s29, s35
    s_cmp_gt_u32 s23, 5
    s_cselect_b32 s29, s29, 0
    s_add_u32 s28, s28, s29
    v_readlane_b32 s29, v5, 6
    s_add_u32 s27, s27, s29
    s_min_u32 s36, s29, 32
    s_sub_u32 s29, s29, s36
    s_cmp_gt_u32 s23, 6
    s_cselect_b32 s29, s29, 0
    s_add_u32 s28, s28, s29
    v_readlane_b32 s29, v5, 7
    s_add_u32 s27, s27, s29
    s_min_u32 s37, s29, 32
    s_sub_u32 s29, s29, s37
    s_cmp_gt_u32 s23, 7
    s_cselect_b32 s29, s29, 0
    s_add_u32 s28, s28, s29
    v_readlane_b32 s29, v5, 8
    s_add_u32 s27, s27, s29
    s_cmp_gt_u32 s23, 8
    s_cselect_b32 s29, s29, 0
    s_add_u32 s28, s28, s29
    v_readlane_b32 s29, v5, 9
    s_add_u32 s27, s27, s29
    s_cmp_gt_u32 s23, 9
    s_cselect_b32 s29, s29, 0
    s_add_u32 s28, s28, s29
    v_readlane_b32 s29, v5, 10
    s_add_u32 s27, s27, s29
    s_cmp_gt_u32 s23, 10
    s_cselect_b32 s29, s29, 0
    s_add_u32 s28, s28, s29
    v_readlane_b32 s29, v5, 11
    s_add_u32 s27, s27, s29
    s_cmp_gt_u32 s23, 11
    s_cselect_b32 s29, s29, 0
    s_add_u32 s28, s28, s29
    v_readlane_b32 s29, v5, 12
    s_add_u32 s27, s27, s29
    s_cmp_gt_u32 s23, 12
    s_cselect_b32 s29, s29, 0
    s_add_u32 s28, s28, s29
    v_readlane_b32 s29, v5, 13
    s_add_u32 s27, s27, s29
    s_cmp_gt_u32 s23, 13
    s_cselect_b32 s29, s29, 0
    s_add_u32 s28, s28, s29
    v_readlane_b32 s29, v5, 14
    s_add_u32 s27, s27, s29
    s_cmp_gt_u32 s23, 14
    s_cselect_b32 s29, s29, 0
    s_add_u32 s28, s28, s29
    v_readlane_b32 s29, v5, 15
    s_add_u32 s27, s27, s29
    s_cmp_gt_u32 s23, 15
    s_cselect_b32 s29, s29, 0
    s_add_u32 s28, s28, s29
    s_cmp_ge_u32 s27, 256
    s_cbranch_scc1 L_cntok
    s_sleep 4
    s_branch L_cnt
L_cntok:
    s_cmp_lt_u32 s23, 8
    s_cselect_b32 s29, 32, 0
    s_sub_u32 s29, s21, s29
    s_add_u32 s28, s28, s29
    s_add_u32 s21, s30, s28
    s_mov_b32 s20, 0
    s_cmp_lt_u32 s21, 32
    s_cbranch_scc1 L_seat
    s_sub_u32 s28, s21, 32
    s_add_u32 s21, s31, s28
    s_mov_b32 s20, 1
    s_cmp_lt_u32 s21, 32
    s_cbranch_scc1 L_seat
    s_sub_u32 s28, s21, 32
    s_add_u32 s21, s32, s28
    s_mov_b32 s20, 2
    s_cmp_lt_u32 s21, 32
    s_cbranch_scc1 L_seat
    s_sub_u32 s28, s21, 32
    s_add_u32 s21, s33, s28
    s_mov_b32 s20, 3
    s_cmp_lt_u32 s21, 32
    s_cbranch_scc1 L_seat
    s_sub_u32 s28, s21, 32
    s_add_u32 s21, s34, s28
    s_mov_b32 s20, 4
    s_cmp_lt_u32 s21, 32
    s_cbranch_scc1 L_seat
    s_sub_u32 s28, s21, 32
    s_add_u32 s21, s35, s28
    s_mov_b32 s20, 5
    s_cmp_lt_u32 s21, 32
    s_cbranch_scc1 L_seat
    s_sub_u32 s28, s21, 32
    s_add_u32 s21, s36, s28
    s_mov_b32 s20, 6
    s_cmp_lt_u32 s21, 32
    s_cbranch_scc1 L_seat
    s_sub_u32 s28, s21, 32
    s_add_u32 s21, s37, s28
    s_mov_b32 s20, 7
    s_cmp_lt_u32 s21, 32
    s_cbranch_scc1 L_seat
    s_sub_u32 s28, s21, 32
    s_branch L_end
L_seat:
    s_cmp_lt_u32 s20, 2
    s_cbranch_scc1 L_chain
    s_sub_u32 s20, s20, 2
    s_lshl_b32 s20, s20, 5
    s_add_u32 s21, s21, s20
    s_and_b32 s20, s21, 1
    s_mul_i32 s20, s20, 96
    s_lshr_b32 s23, s21, 1
    s_add_u32 s20, s20, s23
    s_barrier
    s_cmp_lt_u32 s21, 128
    s_cbranch_scc1 L_noarm
    s_bfe_u32 s24, s21, 0x10005
    s_and_b32 s25, s21, 31
    v_lshlrev_b32 v4, 4, v255
    s_load_dwordx2 s[36:37], s[0:1], 0
    s_load_dwordx2 s[38:39], s[0:1], 56
    s_sub_u32 s26, s21, 128
    s_lshl_b32 s26, s26, 2
    s_add_u32 s26, s26, s22
    s_lshl_b32 s26, s26, 13
    v_lshl_add_u32 v5, v255, 7, s26
    v_add_u32 v6, 0x200000, v5
    v_add_u32 v7, 0x400000, v5
    s_waitcnt lgkmcnt(0)
    s_mov_b32 s12, s36
    s_and_b32 s13, s37, 0xffff
    s_mov_b32 s14, 0x280000
    s_mov_b32 s15, 0x00020000
    buffer_load_dword v253, v5, s[12:15], 0 offen
    buffer_load_dword v253, v6, s[12:15], 0 offen
    v_mov_b32 v8, -1
    v_mov_b32 v9, -1
    v_mov_b32 v10, -1
    v_mov_b32 v11, -1
    s_lshl_b32 s26, s24, 5
    s_add_u32 s26, s26, s25
    s_lshl_b32 s26, s26, 2
    s_add_u32 s26, s26, s22
    s_lshl_b32 s28, s26, 13
    s_add_u32 s28, s28, 83886080
    buffer_store_dwordx4 v[8:11], v4, s[8:11], s28 offen offset:0 sc1
    buffer_store_dwordx4 v[8:11], v4, s[8:11], s28 offen offset:1024 sc1
    buffer_store_dwordx4 v[8:11], v4, s[8:11], s28 offen offset:2048 sc1
    buffer_store_dwordx4 v[8:11], v4, s[8:11], s28 offen offset:3072 sc1
    s_add_u32 s28, s28, 4096
    buffer_store_dwordx4 v[8:11], v4, s[8:11], s28 offen offset:0 sc1
    s_mul_i32 s28, s26, 2560
    s_add_u32 s28, s28, 85983232
    buffer_store_dwordx4 v[8:11], v4, s[8:11], s28 offen offset:0 sc1
    buffer_store_dwordx4 v[8:11], v4, s[8:11], s28 offen offset:1024 sc1
    s_mov_b32 exec_hi, 0
    buffer_store_dwordx4 v[8:11], v4, s[8:11], s28 offen offset:2048 sc1
    s_mov_b32 exec_hi, -1
    s_bfe_u32 s27, s26, 0x60001
    s_mul_i32 s28, s27, 540672
    s_and_b32 s27, s26, 1
    s_mul_i32 s27, s27, 2560
    s_add_u32 s28, s28, s27
    s_lshl_b32 s27, s24, 13
    s_add_u32 s28, s28, s27
    s_add_u32 s28, s28, 524288
    buffer_store_dwordx4 v[8:11], v4, s[8:11], s28 offen offset:0 sc1
    buffer_store_dwordx4 v[8:11], v4, s[8:11], s28 offen offset:1024 sc1
    s_mov_b32 exec_hi, 0
    buffer_store_dwordx4 v[8:11], v4, s[8:11], s28 offen offset:2048 sc1
    s_mov_b32 exec_hi, -1
    s_lshl_b32 s28, s26, 11
    s_add_u32 s28, s28, 83361792
    buffer_store_dwordx4 v[8:11], v4, s[8:11], s28 offen offset:0 sc1
    buffer_store_dwordx4 v[8:11], v4, s[8:11], s28 offen offset:1024 sc1
    s_nop 1
    v_mov_b32 v8, 0
    v_mov_b32 v9, 0
    v_mov_b32 v10, 0
    v_mov_b32 v11, 0
    s_lshl_b32 s28, s26, 9
    s_add_u32 s28, s28, 90177536
    s_mov_b32 exec_hi, 0
    buffer_store_dwordx4 v[8:11], v4, s[8:11], s28 offen offset:0 sc1
    s_mov_b64 exec, -1
    s_waitcnt vmcnt(0)
    s_barrier
    s_cmp_lg_u32 s22, 1
    s_cbranch_scc1 L_noar2
    s_mov_b64 exec, 1
    v_mov_b32 v8, s46
    buffer_atomic_add v8, off, s[16:19], 0 offset:96 sc1
    s_mov_b64 exec, -1
L_noar2:
    s_load_dwordx2 s[36:37], s[0:1], 0
    s_load_dwordx2 s[38:39], s[0:1], 56
    s_sub_u32 s26, s21, 128
    s_lshl_b32 s26, s26, 2
    s_add_u32 s26, s26, s22
    s_lshl_b32 s26, s26, 13
    v_lshl_add_u32 v5, v255, 7, s26
    v_add_u32 v6, 0x200000, v5
    v_add_u32 v7, 0x400000, v5
    s_waitcnt lgkmcnt(0)
    s_mov_b32 s12, s66
    s_and_b32 s13, s67, 0xffff
    s_mov_b32 s14, 0x500000
    s_mov_b32 s15, 0x00020000
    buffer_load_dword v253, v5, s[12:15], 0 offen
    buffer_load_dword v253, v6, s[12:15], 0 offen
    buffer_load_dword v253, v7, s[12:15], 0 offen
    s_mov_b32 s12, s38
    s_and_b32 s13, s39, 0xffff
    s_mov_b32 s14, 0x280000
    s_mov_b32 s15, 0x00020000
    buffer_load_dword v253, v5, s[12:15], 0 offen
    buffer_load_dword v253, v6, s[12:15], 0 offen
L_noarm:
    s_cmp_ge_u32 s20, 96
    s_cselect_b32 s26, 1, 0
    s_cselect_b32 s27, 96, 0
    s_sub_u32 s27, s20, s27
    s_lshr_b32 s24, s27, 5
    s_and_b32 s25, s27, 31
    s_load_dwordx2 s[36:37], s[0:1], 0
    s_load_dwordx2 s[38:39], s[0:1], 16
    s_load_dwordx4 s[40:43], s[0:1], 24
    s_waitcnt lgkmcnt(0)
    s_cmp_eq_u32 s24, 1
    s_cselect_b32 s40, s42, s40
    s_cselect_b32 s41, s43, s41
    s_cmp_eq_u32 s24, 2
    s_cselect_b32 s40, s38, s40
    s_cselect_b32 s41, s39, s41
    s_mov_b32 s12, s40
    s_and_b32 s13, s41, 0xffff
    s_mov_b32 s14, 0x500000
    s_mov_b32 s15, 0x00020000
    v_and_b32 v1, 15, v255
    v_lshrrev_b32 v2, 4, v255
    v_lshlrev_b32 v3, 1, v2
    v_xor_b32 v3, v3, v1
    v_lshlrev_b32 v3, 4, v3
    v_lshl_add_u32 v4, v2, 13, v3
    v_xor_b32 v5, 128, v4
    s_lshl_b32 s27, s25, 8
    s_mul_i32 s28, s22, 1310720
    s_add_u32 s27, s27, s28
    s_mul_i32 s33, s22, 40960
    s_mov_b32 m0, s33
    s_add_u32 s33, s33, 1024
    buffer_load_dwordx4 v4, s[12:15], s27 offen lds
    s_add_u32 s27, s27, 32768
    s_mov_b32 m0, s33
    s_add_u32 s33, s33, 1024
    buffer_load_dwordx4 v4, s[12:15], s27 offen lds
    s_add_u32 s27, s27, 32768
    s_mov_b32 m0, s33
    s_add_u32 s33, s33, 1024
    buffer_load_dwordx4 v5, s[12:15], s27 offen lds
    s_add_u32 s27, s27, 32768
    s_mov_b32 m0, s33
    s_add_u32 s33, s33, 1024
    buffer_load_dwordx4 v5, s[12:15], s27 offen lds
    s_add_u32 s27, s27, 32768
    s_mov_b32 m0, s33
    s_add_u32 s33, s33, 1024
    buffer_load_dwordx4 v4, s[12:15], s27 offen lds
    s_add_u32 s27, s27, 32768
    s_mov_b32 m0, s33
    s_add_u32 s33, s33, 1024
    buffer_load_dwordx4 v4, s[12:15], s27 offen lds
    s_add_u32 s27, s27, 32768
    s_mov_b32 m0, s33
    s_add_u32 s33, s33, 1024
    buffer_load_dwordx4 v5, s[12:15], s27 offen lds
    s_add_u32 s27, s27, 32768
    s_mov_b32 m0, s33
    s_add_u32 s33, s33, 1024
    buffer_load_dwordx4 v5, s[12:15], s27 offen lds
    s_add_u32 s27, s27, 32768
    s_mov_b32 m0, s33
    s_add_u32 s33, s33, 1024
    buffer_load_dwordx4 v4, s[12:15], s27 offen lds
    s_add_u32 s27, s27, 32768
    s_mov_b32 m0, s33
    s_add_u32 s33, s33, 1024
    buffer_load_dwordx4 v4, s[12:15], s27 offen lds
    s_add_u32 s27, s27, 32768
    s_mov_b32 m0, s33
    s_add_u32 s33, s33, 1024
    buffer_load_dwordx4 v5, s[12:15], s27 offen lds
    s_add_u32 s27, s27, 32768
    s_mov_b32 m0, s33
    s_add_u32 s33, s33, 1024
    buffer_load_dwordx4 v5, s[12:15], s27 offen lds
    s_add_u32 s27, s27, 32768
    s_mov_b32 m0, s33
    s_add_u32 s33, s33, 1024
    buffer_load_dwordx4 v4, s[12:15], s27 offen lds
    s_add_u32 s27, s27, 32768
    s_mov_b32 m0, s33
    s_add_u32 s33, s33, 1024
    buffer_load_dwordx4 v4, s[12:15], s27 offen lds
    s_add_u32 s27, s27, 32768
    s_mov_b32 m0, s33
    s_add_u32 s33, s33, 1024
    buffer_load_dwordx4 v5, s[12:15], s27 offen lds
    s_add_u32 s27, s27, 32768
    s_mov_b32 m0, s33
    s_add_u32 s33, s33, 1024
    buffer_load_dwordx4 v5, s[12:15], s27 offen lds
    s_add_u32 s27, s27, 32768
    s_mov_b32 m0, s33
    s_add_u32 s33, s33, 1024
    buffer_load_dwordx4 v4, s[12:15], s27 offen lds
    s_add_u32 s27, s27, 32768
    s_mov_b32 m0, s33
    s_add_u32 s33, s33, 1024
    buffer_load_dwordx4 v4, s[12:15], s27 offen lds
    s_add_u32 s27, s27, 32768
    s_mov_b32 m0, s33
    s_add_u32 s33, s33, 1024
    buffer_load_dwordx4 v5, s[12:15], s27 offen lds
    s_add_u32 s27, s27, 32768
    s_mov_b32 m0, s33
    s_add_u32 s33, s33, 1024
    buffer_load_dwordx4 v5, s[12:15], s27 offen lds
    s_add_u32 s27, s27, 32768
    s_mov_b32 m0, s33
    s_add_u32 s33, s33, 1024
    buffer_load_dwordx4 v4, s[12:15], s27 offen lds
    s_add_u32 s27, s27, 32768
    s_mov_b32 m0, s33
    s_add_u32 s33, s33, 1024
    buffer_load_dwordx4 v4, s[12:15], s27 offen lds
    s_add_u32 s27, s27, 32768
    s_mov_b32 m0, s33
    s_add_u32 s33, s33, 1024
    buffer_load_dwordx4 v5, s[12:15], s27 offen lds
    s_add_u32 s27, s27, 32768
    s_mov_b32 m0, s33
    s_add_u32 s33, s33, 1024
    buffer_load_dwordx4 v5, s[12:15], s27 offen lds
    s_add_u32 s27, s27, 32768
    s_mov_b32 m0, s33
    s_add_u32 s33, s33, 1024
    buffer_load_dwordx4 v4, s[12:15], s27 offen lds
    s_add_u32 s27, s27, 32768
    s_mov_b32 m0, s33
    s_add_u32 s33, s33, 1024
    buffer_load_dwordx4 v4, s[12:15], s27 offen lds
    s_add_u32 s27, s27, 32768
    s_mov_b32 m0, s33
    s_add_u32 s33, s33, 1024
    buffer_load_dwordx4 v5, s[12:15], s27 offen lds
    s_add_u32 s27, s27, 32768
    s_mov_b32 m0, s33
    s_add_u32 s33, s33, 1024
    buffer_load_dwordx4 v5, s[12:15], s27 offen lds
    s_add_u32 s27, s27, 32768
    s_mov_b32 m0, s33
    s_add_u32 s33, s33, 1024
    buffer_load_dwordx4 v4, s[12:15], s27 offen lds
    s_add_u32 s27, s27, 32768
    s_mov_b32 m0, s33
    s_add_u32 s33, s33, 1024
    buffer_load_dwordx4 v4, s[12:15], s27 offen lds
    s_add_u32 s27, s27, 32768
    s_mov_b32 m0, s33
    s_add_u32 s33, s33, 1024
    buffer_load_dwordx4 v5, s[12:15], s27 offen lds
    s_add_u32 s27, s27, 32768
    s_mov_b32 m0, s33
    s_add_u32 s33, s33, 1024
    buffer_load_dwordx4 v5, s[12:15], s27 offen lds
    s_add_u32 s27, s27, 32768
    s_mov_b32 m0, s33
    s_add_u32 s33, s33, 1024
    buffer_load_dwordx4 v4, s[12:15], s27 offen lds
    s_add_u32 s27, s27, 32768
    s_mov_b32 m0, s33
    s_add_u32 s33, s33, 1024
    buffer_load_dwordx4 v4, s[12:15], s27 offen lds
    s_add_u32 s27, s27, 32768
    s_mov_b32 m0, s33
    s_add_u32 s33, s33, 1024
    buffer_load_dwordx4 v5, s[12:15], s27 offen lds
    s_add_u32 s27, s27, 32768
    s_mov_b32 m0, s33
    s_add_u32 s33, s33, 1024
    buffer_load_dwordx4 v5, s[12:15], s27 offen lds
    s_add_u32 s27, s27, 32768
    s_mov_b32 m0, s33
    s_add_u32 s33, s33, 1024
    buffer_load_dwordx4 v4, s[12:15], s27 offen lds
    s_add_u32 s27, s27, 32768
    s_mov_b32 m0, s33
    s_add_u32 s33, s33, 1024
    buffer_load_dwordx4 v4, s[12:15], s27 offen lds
    s_add_u32 s27, s27, 32768
    s_mov_b32 m0, s33
    s_add_u32 s33, s33, 1024
    buffer_load_dwordx4 v5, s[12:15], s27 offen lds
    s_add_u32 s27, s27, 32768
    s_mov_b32 m0, s33
    s_add_u32 s33, s33, 1024
    buffer_load_dwordx4 v5, s[12:15], s27 offen lds
    s_add_u32 s27, s27, 32768
    v_bfe_u32 v6, v255, 2, 2
    v_and_b32 v7, 1, v2
    v_lshl_add_u32 v7, v7, 2, v6
    v_lshlrev_b32 v7, 1, v7
    v_bfe_u32 v8, v255, 1, 1
    s_lshl_b32 s27, s22, 2
    v_add_u32 v8, s27, v8
    v_xor_b32 v8, v8, v7
    v_lshlrev_b32 v8, 4, v8
    v_lshl_add_u32 v9, v2, 3, v6
    v_lshl_add_u32 v8, v9, 8, v8
    v_and_b32 v9, 1, v255
    v_lshl_add_u32 v8, v9, 3, v8
    v_xor_b32 v9, 32, v8
    s_lshl_b32 s27, s21, 2
    s_add_u32 s27, s27, s22
    s_mul_i32 s27, s27, 10240
    v_lshl_add_u32 v26, v255, 7, s27
    v_add_u32 v27, 8192, v26
    s_mov_b32 s12, s60
    s_and_b32 s13, s61, 0xffff
    s_mov_b32 s14, 0x500000
    s_mov_b32 s15, 0x00020000
    buffer_load_dword v28, v26, s[12:15], 0 offen
    s_mov_b64 exec, 0xffff
    buffer_load_dword v28, v27, s[12:15], 0 offen
    s_mov_b64 exec, -1
    s_mul_i32 s27, s22, 640
    v_add_u32 v20, s27, v255
    s_mov_b32 s28, 52429
    v_mul_lo_u32 v21, v20, s28
    v_lshrrev_b32 v21, 22, v21
    v_mul_u32_u24 v22, 80, v21
    v_sub_u32 v23, v20, v22
    v_and_b32 v21, 15, v21
    v_xor_b32 v23, v23, v21
    v_add_lshl_u32 v10, v22, v23, 4
    v_add_u32 v20, 64, v20
    v_mul_lo_u32 v21, v20, s28
    v_lshrrev_b32 v21, 22, v21
    v_mul_u32_u24 v22, 80, v21
    v_sub_u32 v23, v20, v22
    v_and_b32 v21, 15, v21
    v_xor_b32 v23, v23, v21
    v_add_lshl_u32 v11, v22, v23, 4
    v_add_u32 v20, 64, v20
    v_mul_lo_u32 v21, v20, s28
    v_lshrrev_b32 v21, 22, v21
    v_mul_u32_u24 v22, 80, v21
    v_sub_u32 v23, v20, v22
    v_and_b32 v21, 15, v21
    v_xor_b32 v23, v23, v21
    v_add_lshl_u32 v12, v22, v23, 4
    v_add_u32 v20, 64, v20
    v_mul_lo_u32 v21, v20, s28
    v_lshrrev_b32 v21, 22, v21
    v_mul_u32_u24 v22, 80, v21
    v_sub_u32 v23, v20, v22
    v_and_b32 v21, 15, v21
    v_xor_b32 v23, v23, v21
    v_add_lshl_u32 v13, v22, v23, 4
    v_add_u32 v20, 64, v20
    v_mul_lo_u32 v21, v20, s28
    v_lshrrev_b32 v21, 22, v21
    v_mul_u32_u24 v22, 80, v21
    v_sub_u32 v23, v20, v22
    v_and_b32 v21, 15, v21
    v_xor_b32 v23, v23, v21
    v_add_lshl_u32 v14, v22, v23, 4
    v_add_u32 v20, 64, v20
    v_mul_lo_u32 v21, v20, s28
    v_lshrrev_b32 v21, 22, v21
    v_mul_u32_u24 v22, 80, v21
    v_sub_u32 v23, v20, v22
    v_and_b32 v21, 15, v21
    v_xor_b32 v23, v23, v21
    v_add_lshl_u32 v15, v22, v23, 4
    v_add_u32 v20, 64, v20
    v_mul_lo_u32 v21, v20, s28
    v_lshrrev_b32 v21, 22, v21
    v_mul_u32_u24 v22, 80, v21
    v_sub_u32 v23, v20, v22
    v_and_b32 v21, 15, v21
    v_xor_b32 v23, v23, v21
    v_add_lshl_u32 v16, v22, v23, 4
    v_add_u32 v20, 64, v20
    v_mul_lo_u32 v21, v20, s28
    v_lshrrev_b32 v21, 22, v21
    v_mul_u32_u24 v22, 80, v21
    v_sub_u32 v23, v20, v22
    v_and_b32 v21, 15, v21
    v_xor_b32 v23, v23, v21
    v_add_lshl_u32 v17, v22, v23, 4
    v_add_u32 v20, 64, v20
    v_mul_lo_u32 v21, v20, s28
    v_lshrrev_b32 v21, 22, v21
    v_mul_u32_u24 v22, 80, v21
    v_sub_u32 v23, v20, v22
    v_and_b32 v21, 15, v21
    v_xor_b32 v23, v23, v21
    v_add_lshl_u32 v18, v22, v23, 4
    v_add_u32 v20, 64, v20
    v_mul_lo_u32 v21, v20, s28
    v_lshrrev_b32 v21, 22, v21
    v_mul_u32_u24 v22, 80, v21
    v_sub_u32 v23, v20, v22
    v_and_b32 v21, 15, v21
    v_xor_b32 v23, v23, v21
    v_add_lshl_u32 v19, v22, v23, 4
    v_add_u32 v20, 64, v20
    v_mul_u32_u24 v24, 1280, v1
    v_add_u32 v25, 0, v2
    v_xor_b32 v25, v25, v1
    v_lshl_add_u32 v20, v25, 4, v24
    v_add_u32 v25, 4, v2
    v_xor_b32 v25, v25, v1
    v_lshl_add_u32 v21, v25, 4, v24
    v_add_u32 v25, 8, v2
    v_xor_b32 v25, v25, v1
    v_lshl_add_u32 v22, v25, 4, v24
    v_add_u32 v25, 12, v2
    v_xor_b32 v25, v25, v1
    v_lshl_add_u32 v23, v25, 4, v24
    v_lshlrev_b32 v0, 4, v255
    s_lshl_b32 s27, s25, 14
    s_lshl_b32 s28, s22, 12
    s_add_u32 s29, s27, s28
    s_lshl_b32 s27, s24, 11
    s_add_u32 s27, s29, s27
    s_lshr_b32 s29, s29, 1
    s_add_u32 s29, s29, 37748736
    s_cmp_eq_u32 s24, 2
    s_cselect_b32 s29, s29, s27
    s_mov_b32 s28, 540672
    s_cselect_b32 s30, 0x40000, s28
    s_mul_i32 s27, s26, s30
    s_add_u32 s29, s29, s27
    s_lshl_b32 s30, s30, 1
    s_mul_i32 s31, s26, 40960
    s_lshl_b32 s34, s20, 7
    s_add_u32 s34, s34, 90177536
    s_waitcnt vmcnt(2)
    s_barrier
    ds_read_b64_tr_b16 a[0:1], v8 offset:0
    ds_read_b64_tr_b16 a[2:3], v8 offset:1024
    ds_read_b64_tr_b16 a[4:5], v9 offset:0
    ds_read_b64_tr_b16 a[6:7], v9 offset:1024
    ds_read_b64_tr_b16 a[8:9], v8 offset:8192
    ds_read_b64_tr_b16 a[10:11], v8 offset:9216
    ds_read_b64_tr_b16 a[12:13], v9 offset:8192
    ds_read_b64_tr_b16 a[14:15], v9 offset:9216
    ds_read_b64_tr_b16 a[16:17], v8 offset:16384
    ds_read_b64_tr_b16 a[18:19], v8 offset:17408
    ds_read_b64_tr_b16 a[20:21], v9 offset:16384
    ds_read_b64_tr_b16 a[22:23], v9 offset:17408
    ds_read_b64_tr_b16 a[24:25], v8 offset:24576
    ds_read_b64_tr_b16 a[26:27], v8 offset:25600
    ds_read_b64_tr_b16 a[28:29], v9 offset:24576
    ds_read_b64_tr_b16 a[30:31], v9 offset:25600
    ds_read_b64_tr_b16 a[32:33], v8 offset:32768
    ds_read_b64_tr_b16 a[34:35], v8 offset:33792
    ds_read_b64_tr_b16 a[36:37], v9 offset:32768
    ds_read_b64_tr_b16 a[38:39], v9 offset:33792
    ds_read_b64_tr_b16 a[40:41], v8 offset:40960
    ds_read_b64_tr_b16 a[42:43], v8 offset:41984
    ds_read_b64_tr_b16 a[44:45], v9 offset:40960
    ds_read_b64_tr_b16 a[46:47], v9 offset:41984
    ds_read_b64_tr_b16 a[48:49], v8 offset:49152
    ds_read_b64_tr_b16 a[50:51], v8 offset:50176
    ds_read_b64_tr_b16 a[52:53], v9 offset:49152
    ds_read_b64_tr_b16 a[54:55], v9 offset:50176
    ds_read_b64_tr_b16 a[56:57], v8 offset:57344
    ds_read_b64_tr_b16 a[58:59], v8 offset:58368
    ds_read_b64_tr_b16 a[60:61], v9 offset:57344
    ds_read_b64_tr_b16 a[62:63], v9 offset:58368
    v_add_u32 v8, 0x10000, v8
    v_add_u32 v9, 0x10000, v9
    ds_read_b64_tr_b16 a[64:65], v8 offset:0
    ds_read_b64_tr_b16 a[66:67], v8 offset:1024
    ds_read_b64_tr_b16 a[68:69], v9 offset:0
    ds_read_b64_tr_b16 a[70:71], v9 offset:1024
    ds_read_b64_tr_b16 a[72:73], v8 offset:8192
    ds_read_b64_tr_b16 a[74:75], v8 offset:9216
    ds_read_b64_tr_b16 a[76:77], v9 offset:8192
    ds_read_b64_tr_b16 a[78:79], v9 offset:9216
    ds_read_b64_tr_b16 a[80:81], v8 offset:16384
    ds_read_b64_tr_b16 a[82:83], v8 offset:17408
    ds_read_b64_tr_b16 a[84:85], v9 offset:16384
    ds_read_b64_tr_b16 a[86:87], v9 offset:17408
    ds_read_b64_tr_b16 a[88:89], v8 offset:24576
    ds_read_b64_tr_b16 a[90:91], v8 offset:25600
    ds_read_b64_tr_b16 a[92:93], v9 offset:24576
    ds_read_b64_tr_b16 a[94:95], v9 offset:25600
    ds_read_b64_tr_b16 a[96:97], v8 offset:32768
    ds_read_b64_tr_b16 a[98:99], v8 offset:33792
    ds_read_b64_tr_b16 a[100:101], v9 offset:32768
    ds_read_b64_tr_b16 a[102:103], v9 offset:33792
    ds_read_b64_tr_b16 a[104:105], v8 offset:40960
    ds_read_b64_tr_b16 a[106:107], v8 offset:41984
    ds_read_b64_tr_b16 a[108:109], v9 offset:40960
    ds_read_b64_tr_b16 a[110:111], v9 offset:41984
    ds_read_b64_tr_b16 a[112:113], v8 offset:49152
    ds_read_b64_tr_b16 a[114:115], v8 offset:50176
    ds_read_b64_tr_b16 a[116:117], v9 offset:49152
    ds_read_b64_tr_b16 a[118:119], v9 offset:50176
    ds_read_b64_tr_b16 a[120:121], v8 offset:57344
    ds_read_b64_tr_b16 a[122:123], v8 offset:58368
    ds_read_b64_tr_b16 a[124:125], v9 offset:57344
    ds_read_b64_tr_b16 a[126:127], v9 offset:58368
    v_add_u32 v8, 0x10000, v8
    v_add_u32 v9, 0x10000, v9
    ds_read_b64_tr_b16 a[128:129], v8 offset:0
    ds_read_b64_tr_b16 a[130:131], v8 offset:1024
    ds_read_b64_tr_b16 a[132:133], v9 offset:0
    ds_read_b64_tr_b16 a[134:135], v9 offset:1024
    ds_read_b64_tr_b16 a[136:137], v8 offset:8192
    ds_read_b64_tr_b16 a[138:139], v8 offset:9216
    ds_read_b64_tr_b16 a[140:141], v9 offset:8192
    ds_read_b64_tr_b16 a[142:143], v9 offset:9216
    ds_read_b64_tr_b16 a[144:145], v8 offset:16384
    ds_read_b64_tr_b16 a[146:147], v8 offset:17408
    ds_read_b64_tr_b16 a[148:149], v9 offset:16384
    ds_read_b64_tr_b16 a[150:151], v9 offset:17408
    ds_read_b64_tr_b16 a[152:153], v8 offset:24576
    ds_read_b64_tr_b16 a[154:155], v8 offset:25600
    ds_read_b64_tr_b16 a[156:157], v9 offset:24576
    ds_read_b64_tr_b16 a[158:159], v9 offset:25600
    s_mov_b32 s12, s36
    s_and_b32 s13, s37, 0xffff
    s_mov_b32 s14, 0x280000
    s_mov_b32 s15, 0x00020000
    s_mul_i32 s33, s22, 10240
    s_waitcnt lgkmcnt(0)
    s_barrier
    buffer_load_dword v30, off, s[16:19], 0 offset:96 sc1
    s_add_u32 m0, s33, 0
    s_nop 0
    buffer_load_dwordx4 v10, s[12:15], s31 offen lds
    s_add_u32 m0, s33, 1024
    s_nop 0
    buffer_load_dwordx4 v11, s[12:15], s31 offen lds
    s_add_u32 m0, s33, 2048
    s_nop 0
    buffer_load_dwordx4 v12, s[12:15], s31 offen lds
    s_add_u32 m0, s33, 3072
    s_nop 0
    buffer_load_dwordx4 v13, s[12:15], s31 offen lds
    s_add_u32 m0, s33, 4096
    s_nop 0
    buffer_load_dwordx4 v14, s[12:15], s31 offen lds
    s_add_u32 m0, s33, 5120
    s_nop 0
    buffer_load_dwordx4 v15, s[12:15], s31 offen lds
    s_add_u32 m0, s33, 6144
    s_nop 0
    buffer_load_dwordx4 v16, s[12:15], s31 offen lds
    s_add_u32 m0, s33, 7168
    s_nop 0
    buffer_load_dwordx4 v17, s[12:15], s31 offen lds
    s_add_u32 m0, s33, 8192
    s_nop 0
    buffer_load_dwordx4 v18, s[12:15], s31 offen lds
    s_add_u32 m0, s33, 9216
    s_nop 0
    buffer_load_dwordx4 v19, s[12:15], s31 offen lds
    s_add_u32 s31, s31, 81920
    s_min_u32 s31, s31, 2580480
    s_add_u32 s33, s33, 40960
    s_cmp_ge_u32 s33, 163840
    s_cselect_b32 s27, 163840, 0
    s_sub_u32 s33, s33, s27
    s_add_u32 m0, s33, 0
    s_nop 0
    buffer_load_dwordx4 v10, s[12:15], s31 offen lds
    s_add_u32 m0, s33, 1024
    s_nop 0
    buffer_load_dwordx4 v11, s[12:15], s31 offen lds
    s_add_u32 m0, s33, 2048
    s_nop 0
    buffer_load_dwordx4 v12, s[12:15], s31 offen lds
    s_add_u32 m0, s33, 3072
    s_nop 0
    buffer_load_dwordx4 v13, s[12:15], s31 offen lds
    s_add_u32 m0, s33, 4096
    s_nop 0
    buffer_load_dwordx4 v14, s[12:15], s31 offen lds
    s_add_u32 m0, s33, 5120
    s_nop 0
    buffer_load_dwordx4 v15, s[12:15], s31 offen lds
    s_add_u32 m0, s33, 6144
    s_nop 0
    buffer_load_dwordx4 v16, s[12:15], s31 offen lds
    s_add_u32 m0, s33, 7168
    s_nop 0
    buffer_load_dwordx4 v17, s[12:15], s31 offen lds
    s_add_u32 m0, s33, 8192
    s_nop 0
    buffer_load_dwordx4 v18, s[12:15], s31 offen lds
    s_add_u32 m0, s33, 9216
    s_nop 0
    buffer_load_dwordx4 v19, s[12:15], s31 offen lds
    s_add_u32 s31, s31, 81920
    s_min_u32 s31, s31, 2580480
    s_add_u32 s33, s33, 40960
    s_cmp_ge_u32 s33, 163840
    s_cselect_b32 s27, 163840, 0
    s_sub_u32 s33, s33, s27
    s_add_u32 m0, s33, 0
    s_nop 0
    buffer_load_dwordx4 v10, s[12:15], s31 offen lds
    s_add_u32 m0, s33, 1024
    s_nop 0
    buffer_load_dwordx4 v11, s[12:15], s31 offen lds
    s_add_u32 m0, s33, 2048
    s_nop 0
    buffer_load_dwordx4 v12, s[12:15], s31 offen lds
    s_add_u32 m0, s33, 3072
    s_nop 0
    buffer_load_dwordx4 v13, s[12:15], s31 offen lds
    s_add_u32 m0, s33, 4096
    s_nop 0
    buffer_load_dwordx4 v14, s[12:15], s31 offen lds
    s_add_u32 m0, s33, 5120
    s_nop 0
    buffer_load_dwordx4 v15, s[12:15], s31 offen lds
    s_add_u32 m0, s33, 6144
    s_nop 0
    buffer_load_dwordx4 v16, s[12:15], s31 offen lds
    s_add_u32 m0, s33, 7168
    s_nop 0
    buffer_load_dwordx4 v17, s[12:15], s31 offen lds
    s_add_u32 m0, s33, 8192
    s_nop 0
    buffer_load_dwordx4 v18, s[12:15], s31 offen lds
    s_add_u32 m0, s33, 9216
    s_nop 0
    buffer_load_dwordx4 v19, s[12:15], s31 offen lds
    s_add_u32 s31, s31, 81920
    s_min_u32 s31, s31, 2580480
    s_add_u32 s33, s33, 40960
    s_cmp_ge_u32 s33, 163840
    s_cselect_b32 s27, 163840, 0
    s_sub_u32 s33, s33, s27
    s_mov_b32 s32, 0
    s_waitcnt vmcnt(20)
    s_cmp_eq_u32 s24, 1
    s_cbranch_scc1 L_vq
L_kq:
    s_barrier
    ds_read_b128 v[32:35], v20 offset:0
    ds_read_b128 v[36:39], v20 offset:20480
    ds_read_b128 v[40:43], v21 offset:0
    ds_read_b128 v[44:47], v21 offset:20480
    ds_read_b128 v[48:51], v22 offset:0
    ds_read_b128 v[52:55], v22 offset:20480
    s_cmp_lg_u32 s22, 0
    s_cbranch_scc1 L_knfq
    s_cmp_lt_u32 s32, 4
    s_cbranch_scc1 L_knfq
    s_cmp_gt_u32 s32, 4
    s_cbranch_scc1 L_kniq
    s_mov_b32 s27, 0
    s_branch L_kicq
L_kiwq:
    buffer_load_dword v30, off, s[16:19], 0 offset:96 sc1
    s_add_u32 s27, s27, 1
    s_cmp_gt_u32 s27, 50000
    s_cbranch_scc1 L_end
    s_waitcnt vmcnt(0)
L_kicq:
    v_readfirstlane_b32 s44, v30
    s_and_b32 s44, s44, 0xffff
    s_cmp_ge_u32 s44, 64
    s_cbranch_scc1 L_kniq
    s_sleep 32
    s_branch L_kiwq
L_kniq:
    s_sub_u32 s27, s32, 3
    v_mov_b32 v30, s27
    s_mov_b64 exec, 1
    buffer_store_dword v30, off, s[8:11], s34 sc1
    s_mov_b64 exec, -1
L_knfq:
    s_waitcnt lgkmcnt(5)
    v_mfma_f32_16x16x32_bf16 v[64:67], a[0:3], v[32:35], 0
    ds_read_b128 v[56:59], v23 offset:0
    v_mfma_f32_16x16x32_bf16 v[68:71], a[4:7], v[32:35], 0
    s_add_u32 m0, s33, 0
    s_waitcnt lgkmcnt(5)
    v_mfma_f32_16x16x32_bf16 v[72:75], a[0:3], v[36:39], 0
    ds_read_b128 v[60:63], v23 offset:20480
    v_mfma_f32_16x16x32_bf16 v[76:79], a[4:7], v[36:39], 0
    buffer_load_dwordx4 v10, s[12:15], s31 offen lds
    s_waitcnt lgkmcnt(5)
    v_mfma_f32_16x16x32_bf16 v[64:67], a[8:11], v[40:43], v[64:67]
    ds_read_b128 v[32:35], v20 offset:256
    v_mfma_f32_16x16x32_bf16 v[68:71], a[12:15], v[40:43], v[68:71]
    s_add_u32 m0, s33, 1024
    s_waitcnt lgkmcnt(5)
    v_mfma_f32_16x16x32_bf16 v[72:75], a[8:11], v[44:47], v[72:75]
    ds_read_b128 v[36:39], v20 offset:20736
    v_mfma_f32_16x16x32_bf16 v[76:79], a[12:15], v[44:47], v[76:79]
    buffer_load_dwordx4 v11, s[12:15], s31 offen lds
    s_waitcnt lgkmcnt(5)
    v_mfma_f32_16x16x32_bf16 v[64:67], a[16:19], v[48:51], v[64:67]
    ds_read_b128 v[40:43], v21 offset:256
    v_mfma_f32_16x16x32_bf16 v[68:71], a[20:23], v[48:51], v[68:71]
    s_add_u32 m0, s33, 2048
    s_waitcnt lgkmcnt(5)
    v_mfma_f32_16x16x32_bf16 v[72:75], a[16:19], v[52:55], v[72:75]
    ds_read_b128 v[44:47], v21 offset:20736
    v_mfma_f32_16x16x32_bf16 v[76:79], a[20:23], v[52:55], v[76:79]
    buffer_load_dwordx4 v12, s[12:15], s31 offen lds
    s_waitcnt lgkmcnt(5)
    v_mfma_f32_16x16x32_bf16 v[64:67], a[24:27], v[56:59], v[64:67]
    ds_read_b128 v[48:51], v22 offset:256
    v_mfma_f32_16x16x32_bf16 v[68:71], a[28:31], v[56:59], v[68:71]
    s_add_u32 m0, s33, 3072
    s_waitcnt lgkmcnt(5)
    v_mfma_f32_16x16x32_bf16 v[72:75], a[24:27], v[60:63], v[72:75]
    ds_read_b128 v[52:55], v22 offset:20736
    v_mfma_f32_16x16x32_bf16 v[76:79], a[28:31], v[60:63], v[76:79]
    buffer_load_dwordx4 v13, s[12:15], s31 offen lds
    s_waitcnt lgkmcnt(5)
    v_mfma_f32_16x16x32_bf16 v[64:67], a[32:35], v[32:35], v[64:67]
    ds_read_b128 v[56:59], v23 offset:256
    v_mfma_f32_16x16x32_bf16 v[68:71], a[36:39], v[32:35], v[68:71]
    s_add_u32 m0, s33, 4096
    s_waitcnt lgkmcnt(5)
    v_mfma_f32_16x16x32_bf16 v[72:75], a[32:35], v[36:39], v[72:75]
    ds_read_b128 v[60:63], v23 offset:20736
    v_mfma_f32_16x16x32_bf16 v[76:79], a[36:39], v[36:39], v[76:79]
    buffer_load_dwordx4 v14, s[12:15], s31 offen lds
    s_waitcnt lgkmcnt(5)
    v_mfma_f32_16x16x32_bf16 v[64:67], a[40:43], v[40:43], v[64:67]
    ds_read_b128 v[32:35], v20 offset:512
    v_mfma_f32_16x16x32_bf16 v[68:71], a[44:47], v[40:43], v[68:71]
    s_add_u32 m0, s33, 5120
    s_waitcnt lgkmcnt(5)
    v_mfma_f32_16x16x32_bf16 v[72:75], a[40:43], v[44:47], v[72:75]
    ds_read_b128 v[36:39], v20 offset:20992
    v_mfma_f32_16x16x32_bf16 v[76:79], a[44:47], v[44:47], v[76:79]
    buffer_load_dwordx4 v15, s[12:15], s31 offen lds
    s_waitcnt lgkmcnt(5)
    v_mfma_f32_16x16x32_bf16 v[64:67], a[48:51], v[48:51], v[64:67]
    ds_read_b128 v[40:43], v21 offset:512
    v_mfma_f32_16x16x32_bf16 v[68:71], a[52:55], v[48:51], v[68:71]
    s_add_u32 m0, s33, 6144
    s_waitcnt lgkmcnt(5)
    v_mfma_f32_16x16x32_bf16 v[72:75], a[48:51], v[52:55], v[72:75]
    ds_read_b128 v[44:47], v21 offset:20992
    v_mfma_f32_16x16x32_bf16 v[76:79], a[52:55], v[52:55], v[76:79]
    buffer_load_dwordx4 v16, s[12:15], s31 offen lds
    s_waitcnt lgkmcnt(5)
    v_mfma_f32_16x16x32_bf16 v[64:67], a[56:59], v[56:59], v[64:67]
    ds_read_b128 v[48:51], v22 offset:512
    v_mfma_f32_16x16x32_bf16 v[68:71], a[60:63], v[56:59], v[68:71]
    s_add_u32 m0, s33, 7168
    s_waitcnt lgkmcnt(5)
    v_mfma_f32_16x16x32_bf16 v[72:75], a[56:59], v[60:63], v[72:75]
    ds_read_b128 v[52:55], v22 offset:20992
    v_mfma_f32_16x16x32_bf16 v[76:79], a[60:63], v[60:63], v[76:79]
    buffer_load_dwordx4 v17, s[12:15], s31 offen lds
    s_waitcnt lgkmcnt(5)
    v_mfma_f32_16x16x32_bf16 v[64:67], a[64:67], v[32:35], v[64:67]
    ds_read_b128 v[56:59], v23 offset:512
    v_mfma_f32_16x16x32_bf16 v[68:71], a[68:71], v[32:35], v[68:71]
    s_add_u32 m0, s33, 8192
    s_waitcnt lgkmcnt(5)
    v_mfma_f32_16x16x32_bf16 v[72:75], a[64:67], v[36:39], v[72:75]
    ds_read_b128 v[60:63], v23 offset:20992
    v_mfma_f32_16x16x32_bf16 v[76:79], a[68:71], v[36:39], v[76:79]
    buffer_load_dwordx4 v18, s[12:15], s31 offen lds
    s_waitcnt lgkmcnt(5)
    v_mfma_f32_16x16x32_bf16 v[64:67], a[72:75], v[40:43], v[64:67]
    ds_read_b128 v[32:35], v20 offset:768
    v_mfma_f32_16x16x32_bf16 v[68:71], a[76:79], v[40:43], v[68:71]
    s_add_u32 m0, s33, 9216
    s_waitcnt lgkmcnt(5)
    v_mfma_f32_16x16x32_bf16 v[72:75], a[72:75], v[44:47], v[72:75]
    ds_read_b128 v[36:39], v20 offset:21248
    v_mfma_f32_16x16x32_bf16 v[76:79], a[76:79], v[44:47], v[76:79]
    buffer_load_dwordx4 v19, s[12:15], s31 offen lds
    s_waitcnt lgkmcnt(5)
    v_mfma_f32_16x16x32_bf16 v[64:67], a[80:83], v[48:51], v[64:67]
    ds_read_b128 v[40:43], v21 offset:768
    v_mfma_f32_16x16x32_bf16 v[68:71], a[84:87], v[48:51], v[68:71]
    s_add_u32 s31, s31, 81920
    s_waitcnt lgkmcnt(5)
    v_mfma_f32_16x16x32_bf16 v[72:75], a[80:83], v[52:55], v[72:75]
    ds_read_b128 v[44:47], v21 offset:21248
    v_mfma_f32_16x16x32_bf16 v[76:79], a[84:87], v[52:55], v[76:79]
    s_min_u32 s31, s31, 2580480
    s_waitcnt lgkmcnt(5)
    v_mfma_f32_16x16x32_bf16 v[64:67], a[88:91], v[56:59], v[64:67]
    ds_read_b128 v[48:51], v22 offset:768
    v_mfma_f32_16x16x32_bf16 v[68:71], a[92:95], v[56:59], v[68:71]
    s_add_u32 s33, s33, 40960
    s_waitcnt lgkmcnt(5)
    v_mfma_f32_16x16x32_bf16 v[72:75], a[88:91], v[60:63], v[72:75]
    ds_read_b128 v[52:55], v22 offset:21248
    v_mfma_f32_16x16x32_bf16 v[76:79], a[92:95], v[60:63], v[76:79]
    s_cmp_ge_u32 s33, 163840
    s_waitcnt lgkmcnt(5)
    v_mfma_f32_16x16x32_bf16 v[64:67], a[96:99], v[32:35], v[64:67]
    ds_read_b128 v[56:59], v23 offset:768
    v_mfma_f32_16x16x32_bf16 v[68:71], a[100:103], v[32:35], v[68:71]
    s_cselect_b32 s27, 163840, 0
    s_waitcnt lgkmcnt(5)
    v_mfma_f32_16x16x32_bf16 v[72:75], a[96:99], v[36:39], v[72:75]
    ds_read_b128 v[60:63], v23 offset:21248
    v_mfma_f32_16x16x32_bf16 v[76:79], a[100:103], v[36:39], v[76:79]
    s_sub_u32 s33, s33, s27
    s_waitcnt lgkmcnt(5)
    v_mfma_f32_16x16x32_bf16 v[64:67], a[104:107], v[40:43], v[64:67]
    ds_read_b128 v[32:35], v20 offset:1024
    v_mfma_f32_16x16x32_bf16 v[68:71], a[108:111], v[40:43], v[68:71]
    s_waitcnt lgkmcnt(5)
    v_mfma_f32_16x16x32_bf16 v[72:75], a[104:107], v[44:47], v[72:75]
    ds_read_b128 v[36:39], v20 offset:21504
    v_mfma_f32_16x16x32_bf16 v[76:79], a[108:111], v[44:47], v[76:79]
    s_waitcnt lgkmcnt(5)
    v_mfma_f32_16x16x32_bf16 v[64:67], a[112:115], v[48:51], v[64:67]
    ds_read_b128 v[40:43], v21 offset:1024
    v_mfma_f32_16x16x32_bf16 v[68:71], a[116:119], v[48:51], v[68:71]
    s_waitcnt lgkmcnt(5)
    v_mfma_f32_16x16x32_bf16 v[72:75], a[112:115], v[52:55], v[72:75]
    ds_read_b128 v[44:47], v21 offset:21504
    v_mfma_f32_16x16x32_bf16 v[76:79], a[116:119], v[52:55], v[76:79]
    s_waitcnt lgkmcnt(5)
    v_mfma_f32_16x16x32_bf16 v[64:67], a[120:123], v[56:59], v[64:67]
    ds_read_b128 v[48:51], v22 offset:1024
    v_mfma_f32_16x16x32_bf16 v[68:71], a[124:127], v[56:59], v[68:71]
    s_waitcnt lgkmcnt(5)
    v_mfma_f32_16x16x32_bf16 v[72:75], a[120:123], v[60:63], v[72:75]
    ds_read_b128 v[52:55], v22 offset:21504
    v_mfma_f32_16x16x32_bf16 v[76:79], a[124:127], v[60:63], v[76:79]
    s_waitcnt lgkmcnt(5)
    v_mfma_f32_16x16x32_bf16 v[64:67], a[128:131], v[32:35], v[64:67]
    ds_read_b128 v[56:59], v23 offset:1024
    v_mfma_f32_16x16x32_bf16 v[68:71], a[132:135], v[32:35], v[68:71]
    s_waitcnt lgkmcnt(5)
    v_mfma_f32_16x16x32_bf16 v[72:75], a[128:131], v[36:39], v[72:75]
    ds_read_b128 v[60:63], v23 offset:21504
    v_mfma_f32_16x16x32_bf16 v[76:79], a[132:135], v[36:39], v[76:79]
    s_waitcnt lgkmcnt(5)
    v_mfma_f32_16x16x32_bf16 v[64:67], a[136:139], v[40:43], v[64:67]
    v_mfma_f32_16x16x32_bf16 v[68:71], a[140:143], v[40:43], v[68:71]
    s_waitcnt lgkmcnt(4)
    v_mfma_f32_16x16x32_bf16 v[72:75], a[136:139], v[44:47], v[72:75]
    v_mfma_f32_16x16x32_bf16 v[76:79], a[140:143], v[44:47], v[76:79]
    s_waitcnt lgkmcnt(3)
    v_mfma_f32_16x16x32_bf16 v[64:67], a[144:147], v[48:51], v[64:67]
    v_mfma_f32_16x16x32_bf16 v[68:71], a[148:151], v[48:51], v[68:71]
    s_waitcnt lgkmcnt(2)
    v_mfma_f32_16x16x32_bf16 v[72:75], a[144:147], v[52:55], v[72:75]
    v_mfma_f32_16x16x32_bf16 v[76:79], a[148:151], v[52:55], v[76:79]
    s_waitcnt lgkmcnt(1)
    v_mfma_f32_16x16x32_bf16 v[64:67], a[152:155], v[56:59], v[64:67]
    v_mfma_f32_16x16x32_bf16 v[68:71], a[156:159], v[56:59], v[68:71]
    s_waitcnt lgkmcnt(0)
    v_mfma_f32_16x16x32_bf16 v[72:75], a[152:155], v[60:63], v[72:75]
    v_mfma_f32_16x16x32_bf16 v[76:79], a[156:159], v[60:63], v[76:79]
    s_add_u32 s32, s32, 1
    s_and_b32 s27, s32, 3
    s_cmp_eq_u32 s27, 0
    s_mov_b32 s28, 40960
    s_cselect_b32 s27, -122880, s28
    v_add_u32 v20, s27, v20
    v_add_u32 v21, s27, v21
    v_add_u32 v22, s27, v22
    v_add_u32 v23, s27, v23
    v_cvt_pk_bf16_f32 v80, v64, v65
    v_cvt_pk_bf16_f32 v81, v66, v67
    v_cvt_pk_bf16_f32 v82, v68, v69
    v_cvt_pk_bf16_f32 v83, v70, v71
    buffer_store_dwordx4 v[80:83], v0, s[8:11], s29 offen offset:0 sc1
    v_cvt_pk_bf16_f32 v84, v72, v73
    v_cvt_pk_bf16_f32 v85, v74, v75
    v_cvt_pk_bf16_f32 v86, v76, v77
    v_cvt_pk_bf16_f32 v87, v78, v79
    buffer_store_dwordx4 v[84:87], v0, s[8:11], s29 offen offset:1024 sc1
    s_add_u32 s29, s29, s30
    s_cmp_lt_u32 s32, 3
    s_cbranch_scc1 L_keq
    s_cmp_lt_u32 s32, 32
    s_waitcnt vmcnt(26)
    s_cbranch_scc1 L_kq
    s_branch L_endq
L_keq:
    s_waitcnt vmcnt(22)
    s_branch L_kq
L_vq:
    s_barrier
    ds_read_b128 v[32:35], v20 offset:0
    ds_read_b128 v[36:39], v20 offset:20480
    ds_read_b128 v[40:43], v21 offset:0
    ds_read_b128 v[44:47], v21 offset:20480
    ds_read_b128 v[48:51], v22 offset:0
    ds_read_b128 v[52:55], v22 offset:20480
    s_cmp_lg_u32 s22, 0
    s_cbranch_scc1 L_vnfq
    s_cmp_lt_u32 s32, 4
    s_cbranch_scc1 L_vnfq
    s_cmp_gt_u32 s32, 4
    s_cbranch_scc1 L_vniq
    s_mov_b32 s27, 0
    s_branch L_vicq
L_viwq:
    buffer_load_dword v30, off, s[16:19], 0 offset:96 sc1
    s_add_u32 s27, s27, 1
    s_cmp_gt_u32 s27, 50000
    s_cbranch_scc1 L_end
    s_waitcnt vmcnt(0)
L_vicq:
    v_readfirstlane_b32 s44, v30
    s_and_b32 s44, s44, 0xffff
    s_cmp_ge_u32 s44, 64
    s_cbranch_scc1 L_vniq
    s_sleep 32
    s_branch L_viwq
L_vniq:
    s_sub_u32 s27, s32, 3
    v_mov_b32 v30, s27
    s_mov_b64 exec, 1
    buffer_store_dword v30, off, s[8:11], s34 sc1
    s_mov_b64 exec, -1
L_vnfq:
    s_waitcnt lgkmcnt(5)
    v_mfma_f32_16x16x32_bf16 v[64:67], v[32:35], a[0:3], 0
    ds_read_b128 v[56:59], v23 offset:0
    v_mfma_f32_16x16x32_bf16 v[68:71], v[32:35], a[4:7], 0
    s_add_u32 m0, s33, 0
    s_waitcnt lgkmcnt(5)
    v_mfma_f32_16x16x32_bf16 v[72:75], v[36:39], a[0:3], 0
    ds_read_b128 v[60:63], v23 offset:20480
    v_mfma_f32_16x16x32_bf16 v[76:79], v[36:39], a[4:7], 0
    buffer_load_dwordx4 v10, s[12:15], s31 offen lds
    s_waitcnt lgkmcnt(5)
    v_mfma_f32_16x16x32_bf16 v[64:67], v[40:43], a[8:11], v[64:67]
    ds_read_b128 v[32:35], v20 offset:256
    v_mfma_f32_16x16x32_bf16 v[68:71], v[40:43], a[12:15], v[68:71]
    s_add_u32 m0, s33, 1024
    s_waitcnt lgkmcnt(5)
    v_mfma_f32_16x16x32_bf16 v[72:75], v[44:47], a[8:11], v[72:75]
    ds_read_b128 v[36:39], v20 offset:20736
    v_mfma_f32_16x16x32_bf16 v[76:79], v[44:47], a[12:15], v[76:79]
    buffer_load_dwordx4 v11, s[12:15], s31 offen lds
    s_waitcnt lgkmcnt(5)
    v_mfma_f32_16x16x32_bf16 v[64:67], v[48:51], a[16:19], v[64:67]
    ds_read_b128 v[40:43], v21 offset:256
    v_mfma_f32_16x16x32_bf16 v[68:71], v[48:51], a[20:23], v[68:71]
    s_add_u32 m0, s33, 2048
    s_waitcnt lgkmcnt(5)
    v_mfma_f32_16x16x32_bf16 v[72:75], v[52:55], a[16:19], v[72:75]
    ds_read_b128 v[44:47], v21 offset:20736
    v_mfma_f32_16x16x32_bf16 v[76:79], v[52:55], a[20:23], v[76:79]
    buffer_load_dwordx4 v12, s[12:15], s31 offen lds
    s_waitcnt lgkmcnt(5)
    v_mfma_f32_16x16x32_bf16 v[64:67], v[56:59], a[24:27], v[64:67]
    ds_read_b128 v[48:51], v22 offset:256
    v_mfma_f32_16x16x32_bf16 v[68:71], v[56:59], a[28:31], v[68:71]
    s_add_u32 m0, s33, 3072
    s_waitcnt lgkmcnt(5)
    v_mfma_f32_16x16x32_bf16 v[72:75], v[60:63], a[24:27], v[72:75]
    ds_read_b128 v[52:55], v22 offset:20736
    v_mfma_f32_16x16x32_bf16 v[76:79], v[60:63], a[28:31], v[76:79]
    buffer_load_dwordx4 v13, s[12:15], s31 offen lds
    s_waitcnt lgkmcnt(5)
    v_mfma_f32_16x16x32_bf16 v[64:67], v[32:35], a[32:35], v[64:67]
    ds_read_b128 v[56:59], v23 offset:256
    v_mfma_f32_16x16x32_bf16 v[68:71], v[32:35], a[36:39], v[68:71]
    s_add_u32 m0, s33, 4096
    s_waitcnt lgkmcnt(5)
    v_mfma_f32_16x16x32_bf16 v[72:75], v[36:39], a[32:35], v[72:75]
    ds_read_b128 v[60:63], v23 offset:20736
    v_mfma_f32_16x16x32_bf16 v[76:79], v[36:39], a[36:39], v[76:79]
    buffer_load_dwordx4 v14, s[12:15], s31 offen lds
    s_waitcnt lgkmcnt(5)
    v_mfma_f32_16x16x32_bf16 v[64:67], v[40:43], a[40:43], v[64:67]
    ds_read_b128 v[32:35], v20 offset:512
    v_mfma_f32_16x16x32_bf16 v[68:71], v[40:43], a[44:47], v[68:71]
    s_add_u32 m0, s33, 5120
    s_waitcnt lgkmcnt(5)
    v_mfma_f32_16x16x32_bf16 v[72:75], v[44:47], a[40:43], v[72:75]
    ds_read_b128 v[36:39], v20 offset:20992
    v_mfma_f32_16x16x32_bf16 v[76:79], v[44:47], a[44:47], v[76:79]
    buffer_load_dwordx4 v15, s[12:15], s31 offen lds
    s_waitcnt lgkmcnt(5)
    v_mfma_f32_16x16x32_bf16 v[64:67], v[48:51], a[48:51], v[64:67]
    ds_read_b128 v[40:43], v21 offset:512
    v_mfma_f32_16x16x32_bf16 v[68:71], v[48:51], a[52:55], v[68:71]
    s_add_u32 m0, s33, 6144
    s_waitcnt lgkmcnt(5)
    v_mfma_f32_16x16x32_bf16 v[72:75], v[52:55], a[48:51], v[72:75]
    ds_read_b128 v[44:47], v21 offset:20992
    v_mfma_f32_16x16x32_bf16 v[76:79], v[52:55], a[52:55], v[76:79]
    buffer_load_dwordx4 v16, s[12:15], s31 offen lds
    s_waitcnt lgkmcnt(5)
    v_mfma_f32_16x16x32_bf16 v[64:67], v[56:59], a[56:59], v[64:67]
    ds_read_b128 v[48:51], v22 offset:512
    v_mfma_f32_16x16x32_bf16 v[68:71], v[56:59], a[60:63], v[68:71]
    s_add_u32 m0, s33, 7168
    s_waitcnt lgkmcnt(5)
    v_mfma_f32_16x16x32_bf16 v[72:75], v[60:63], a[56:59], v[72:75]
    ds_read_b128 v[52:55], v22 offset:20992
    v_mfma_f32_16x16x32_bf16 v[76:79], v[60:63], a[60:63], v[76:79]
    buffer_load_dwordx4 v17, s[12:15], s31 offen lds
    s_waitcnt lgkmcnt(5)
    v_mfma_f32_16x16x32_bf16 v[64:67], v[32:35], a[64:67], v[64:67]
    ds_read_b128 v[56:59], v23 offset:512
    v_mfma_f32_16x16x32_bf16 v[68:71], v[32:35], a[68:71], v[68:71]
    s_add_u32 m0, s33, 8192
    s_waitcnt lgkmcnt(5)
    v_mfma_f32_16x16x32_bf16 v[72:75], v[36:39], a[64:67], v[72:75]
    ds_read_b128 v[60:63], v23 offset:20992
    v_mfma_f32_16x16x32_bf16 v[76:79], v[36:39], a[68:71], v[76:79]
    buffer_load_dwordx4 v18, s[12:15], s31 offen lds
    s_waitcnt lgkmcnt(5)
    v_mfma_f32_16x16x32_bf16 v[64:67], v[40:43], a[72:75], v[64:67]
    ds_read_b128 v[32:35], v20 offset:768
    v_mfma_f32_16x16x32_bf16 v[68:71], v[40:43], a[76:79], v[68:71]
    s_add_u32 m0, s33, 9216
    s_waitcnt lgkmcnt(5)
    v_mfma_f32_16x16x32_bf16 v[72:75], v[44:47], a[72:75], v[72:75]
    ds_read_b128 v[36:39], v20 offset:21248
    v_mfma_f32_16x16x32_bf16 v[76:79], v[44:47], a[76:79], v[76:79]
    buffer_load_dwordx4 v19, s[12:15], s31 offen lds
    s_waitcnt lgkmcnt(5)
    v_mfma_f32_16x16x32_bf16 v[64:67], v[48:51], a[80:83], v[64:67]
    ds_read_b128 v[40:43], v21 offset:768
    v_mfma_f32_16x16x32_bf16 v[68:71], v[48:51], a[84:87], v[68:71]
    s_add_u32 s31, s31, 81920
    s_waitcnt lgkmcnt(5)
    v_mfma_f32_16x16x32_bf16 v[72:75], v[52:55], a[80:83], v[72:75]
    ds_read_b128 v[44:47], v21 offset:21248
    v_mfma_f32_16x16x32_bf16 v[76:79], v[52:55], a[84:87], v[76:79]
    s_min_u32 s31, s31, 2580480
    s_waitcnt lgkmcnt(5)
    v_mfma_f32_16x16x32_bf16 v[64:67], v[56:59], a[88:91], v[64:67]
    ds_read_b128 v[48:51], v22 offset:768
    v_mfma_f32_16x16x32_bf16 v[68:71], v[56:59], a[92:95], v[68:71]
    s_add_u32 s33, s33, 40960
    s_waitcnt lgkmcnt(5)
    v_mfma_f32_16x16x32_bf16 v[72:75], v[60:63], a[88:91], v[72:75]
    ds_read_b128 v[52:55], v22 offset:21248
    v_mfma_f32_16x16x32_bf16 v[76:79], v[60:63], a[92:95], v[76:79]
    s_cmp_ge_u32 s33, 163840
    s_waitcnt lgkmcnt(5)
    v_mfma_f32_16x16x32_bf16 v[64:67], v[32:35], a[96:99], v[64:67]
    ds_read_b128 v[56:59], v23 offset:768
    v_mfma_f32_16x16x32_bf16 v[68:71], v[32:35], a[100:103], v[68:71]
    s_cselect_b32 s27, 163840, 0
    s_waitcnt lgkmcnt(5)
    v_mfma_f32_16x16x32_bf16 v[72:75], v[36:39], a[96:99], v[72:75]
    ds_read_b128 v[60:63], v23 offset:21248
    v_mfma_f32_16x16x32_bf16 v[76:79], v[36:39], a[100:103], v[76:79]
    s_sub_u32 s33, s33, s27
    s_waitcnt lgkmcnt(5)
    v_mfma_f32_16x16x32_bf16 v[64:67], v[40:43], a[104:107], v[64:67]
    ds_read_b128 v[32:35], v20 offset:1024
    v_mfma_f32_16x16x32_bf16 v[68:71], v[40:43], a[108:111], v[68:71]
    s_waitcnt lgkmcnt(5)
    v_mfma_f32_16x16x32_bf16 v[72:75], v[44:47], a[104:107], v[72:75]
    ds_read_b128 v[36:39], v20 offset:21504
    v_mfma_f32_16x16x32_bf16 v[76:79], v[44:47], a[108:111], v[76:79]
    s_waitcnt lgkmcnt(5)
    v_mfma_f32_16x16x32_bf16 v[64:67], v[48:51], a[112:115], v[64:67]
    ds_read_b128 v[40:43], v21 offset:1024
    v_mfma_f32_16x16x32_bf16 v[68:71], v[48:51], a[116:119], v[68:71]
    s_waitcnt lgkmcnt(5)
    v_mfma_f32_16x16x32_bf16 v[72:75], v[52:55], a[112:115], v[72:75]
    ds_read_b128 v[44:47], v21 offset:21504
    v_mfma_f32_16x16x32_bf16 v[76:79], v[52:55], a[116:119], v[76:79]
    s_waitcnt lgkmcnt(5)
    v_mfma_f32_16x16x32_bf16 v[64:67], v[56:59], a[120:123], v[64:67]
    ds_read_b128 v[48:51], v22 offset:1024
    v_mfma_f32_16x16x32_bf16 v[68:71], v[56:59], a[124:127], v[68:71]
    s_waitcnt lgkmcnt(5)
    v_mfma_f32_16x16x32_bf16 v[72:75], v[60:63], a[120:123], v[72:75]
    ds_read_b128 v[52:55], v22 offset:21504
    v_mfma_f32_16x16x32_bf16 v[76:79], v[60:63], a[124:127], v[76:79]
    s_waitcnt lgkmcnt(5)
    v_mfma_f32_16x16x32_bf16 v[64:67], v[32:35], a[128:131], v[64:67]
    ds_read_b128 v[56:59], v23 offset:1024
    v_mfma_f32_16x16x32_bf16 v[68:71], v[32:35], a[132:135], v[68:71]
    s_waitcnt lgkmcnt(5)
    v_mfma_f32_16x16x32_bf16 v[72:75], v[36:39], a[128:131], v[72:75]
    ds_read_b128 v[60:63], v23 offset:21504
    v_mfma_f32_16x16x32_bf16 v[76:79], v[36:39], a[132:135], v[76:79]
    s_waitcnt lgkmcnt(5)
    v_mfma_f32_16x16x32_bf16 v[64:67], v[40:43], a[136:139], v[64:67]
    v_mfma_f32_16x16x32_bf16 v[68:71], v[40:43], a[140:143], v[68:71]
    s_waitcnt lgkmcnt(4)
    v_mfma_f32_16x16x32_bf16 v[72:75], v[44:47], a[136:139], v[72:75]
    v_mfma_f32_16x16x32_bf16 v[76:79], v[44:47], a[140:143], v[76:79]
    s_waitcnt lgkmcnt(3)
    v_mfma_f32_16x16x32_bf16 v[64:67], v[48:51], a[144:147], v[64:67]
    v_mfma_f32_16x16x32_bf16 v[68:71], v[48:51], a[148:151], v[68:71]
    s_waitcnt lgkmcnt(2)
    v_mfma_f32_16x16x32_bf16 v[72:75], v[52:55], a[144:147], v[72:75]
    v_mfma_f32_16x16x32_bf16 v[76:79], v[52:55], a[148:151], v[76:79]
    s_waitcnt lgkmcnt(1)
    v_mfma_f32_16x16x32_bf16 v[64:67], v[56:59], a[152:155], v[64:67]
    v_mfma_f32_16x16x32_bf16 v[68:71], v[56:59], a[156:159], v[68:71]
    s_waitcnt lgkmcnt(0)
    v_mfma_f32_16x16x32_bf16 v[72:75], v[60:63], a[152:155], v[72:75]
    v_mfma_f32_16x16x32_bf16 v[76:79], v[60:63], a[156:159], v[76:79]
    s_add_u32 s32, s32, 1
    s_and_b32 s27, s32, 3
    s_cmp_eq_u32 s27, 0
    s_mov_b32 s28, 40960
    s_cselect_b32 s27, -122880, s28
    v_add_u32 v20, s27, v20
    v_add_u32 v21, s27, v21
    v_add_u32 v22, s27, v22
    v_add_u32 v23, s27, v23
    v_cvt_pk_bf16_f32 v80, v64, v65
    v_cvt_pk_bf16_f32 v81, v66, v67
    v_cvt_pk_bf16_f32 v82, v72, v73
    v_cvt_pk_bf16_f32 v83, v74, v75
    buffer_store_dwordx4 v[80:83], v0, s[8:11], s29 offen offset:0 sc1
    v_cvt_pk_bf16_f32 v84, v68, v69
    v_cvt_pk_bf16_f32 v85, v70, v71
    v_cvt_pk_bf16_f32 v86, v76, v77
    v_cvt_pk_bf16_f32 v87, v78, v79
    buffer_store_dwordx4 v[84:87], v0, s[8:11], s29 offen offset:1024 sc1
    s_add_u32 s29, s29, s30
    s_cmp_lt_u32 s32, 3
    s_cbranch_scc1 L_veq
    s_cmp_lt_u32 s32, 32
    s_waitcnt vmcnt(26)
    s_cbranch_scc1 L_vq
    s_branch L_endq
L_veq:
    s_waitcnt vmcnt(22)
    s_branch L_vq
L_endq:
    s_waitcnt vmcnt(0)
    s_barrier
    s_cmp_lg_u32 s22, 0
    s_cbranch_scc1 L_nfq
    v_mov_b32 v30, 32
    s_mov_b64 exec, 1
    buffer_store_dword v30, off, s[8:11], s34 sc1
    s_mov_b64 exec, -1
L_nfq:
    s_cmp_lt_u32 s21, 64
    s_cbranch_scc1 L_ma
    s_and_b32 s23, s21, 31
    s_lshr_b32 s24, s21, 5
    s_sub_u32 s24, s24, 2
    s_cmp_lt_u32 s23, 20
    s_cbranch_scc1 L_out
    s_cmp_ge_u32 s23, 30
    s_cbranch_scc1 L_fin
    s_mul_i32 s24, s24, 10
    s_add_u32 s20, s24, s23
    s_sub_u32 s20, s20, 20
    s_load_dwordx16 s[36:51], s[0:1], 56
    s_load_dwordx4 s[52:55], s[0:1], 120
    s_lshl_b32 s24, s20, 4
    s_add_u32 s24, s24, s22
    s_mov_b32 s32, 0
    s_mul_i32 s27, s22, 16640
    s_mul_i32 s28, s22, 7680
    s_add_u32 s28, s28, 66560
    s_lshl_b32 s25, s22, 11
    s_add_u32 s29, s25, 97280
    s_add_u32 s30, s25, 105472
    v_lshlrev_b32 v0, 2, v255
    v_and_b32 v1, 31, v255
    v_lshrrev_b32 v2, 5, v255
    s_waitcnt lgkmcnt(0)
    s_mov_b32 s12, s36
    s_and_b32 s13, s37, 0xffff
    s_mov_b32 s14, 0x280000
    s_mov_b32 s15, 0x00020000
    v_mul_u32_u24 v3, 1280, v255
    s_mul_i32 s25, s22, 655360
    s_lshl_b32 s26, s20, 5
    s_add_u32 s25, s25, s26
    buffer_load_dwordx4 a[0:3], v3, s[12:15], s25 offen
    buffer_load_dwordx4 a[4:7], v3, s[12:15], s25 offen offset:16
    s_add_u32 s25, s25, 81920
    buffer_load_dwordx4 a[8:11], v3, s[12:15], s25 offen
    buffer_load_dwordx4 a[12:15], v3, s[12:15], s25 offen offset:16
    s_add_u32 s25, s25, 81920
    buffer_load_dwordx4 a[16:19], v3, s[12:15], s25 offen
    buffer_load_dwordx4 a[20:23], v3, s[12:15], s25 offen offset:16
    s_add_u32 s25, s25, 81920
    buffer_load_dwordx4 a[24:27], v3, s[12:15], s25 offen
    buffer_load_dwordx4 a[28:31], v3, s[12:15], s25 offen offset:16
    s_add_u32 s25, s25, 81920
    buffer_load_dwordx4 a[32:35], v3, s[12:15], s25 offen
    buffer_load_dwordx4 a[36:39], v3, s[12:15], s25 offen offset:16
    s_add_u32 s25, s25, 81920
    buffer_load_dwordx4 a[40:43], v3, s[12:15], s25 offen
    buffer_load_dwordx4 a[44:47], v3, s[12:15], s25 offen offset:16
    s_add_u32 s25, s25, 81920
    buffer_load_dwordx4 a[48:51], v3, s[12:15], s25 offen
    buffer_load_dwordx4 a[52:55], v3, s[12:15], s25 offen offset:16
    s_add_u32 s25, s25, 81920
    buffer_load_dwordx4 a[56:59], v3, s[12:15], s25 offen
    buffer_load_dwordx4 a[60:63], v3, s[12:15], s25 offen offset:16
    s_add_u32 s25, s25, 81920
L_rnds:
    s_lshl_b32 s25, s24, 8
    s_lshl_b32 s26, s24, 1
    s_mov_b32 s12, s38
    s_and_b32 s13, s39, 0xffff
    s_mov_b32 s14, 0x28000
    s_mov_b32 s15, 0x00020000
    buffer_load_dword v10, v0, s[12:15], s25 offen
    s_mov_b32 s12, s40
    s_and_b32 s13, s41, 0xffff
    s_mov_b32 s14, 0x28000
    s_mov_b32 s15, 0x00020000
    buffer_load_dword v11, v0, s[12:15], s25 offen
    s_mov_b32 s12, s42
    s_and_b32 s13, s43, 0xffff
    s_mov_b32 s14, 0x28000
    s_mov_b32 s15, 0x00020000
    buffer_load_dword v12, v0, s[12:15], s25 offen
    s_mov_b32 s12, s44
    s_and_b32 s13, s45, 0xffff
    s_mov_b32 s14, 0x28000
    s_mov_b32 s15, 0x00020000
    buffer_load_dword v13, v0, s[12:15], s25 offen
    s_mov_b32 s12, s46
    s_and_b32 s13, s47, 0xffff
    s_mov_b32 s14, 0x28000
    s_mov_b32 s15, 0x00020000
    buffer_load_dword v14, v0, s[12:15], s25 offen
    s_mov_b32 s12, s48
    s_and_b32 s13, s49, 0xffff
    s_mov_b32 s14, 0x28000
    s_mov_b32 s15, 0x00020000
    buffer_load_dword v15, v0, s[12:15], s25 offen
    s_mov_b32 s12, s50
    s_and_b32 s13, s51, 0xffff
    s_mov_b32 s14, 0x500
    s_mov_b32 s15, 0x00020000
    buffer_load_ushort v16, off, s[12:15], s26
    s_mov_b32 s12, s52
    s_and_b32 s13, s53, 0xffff
    s_mov_b32 s14, 0x500
    s_mov_b32 s15, 0x00020000
    buffer_load_ushort v17, off, s[12:15], s26
    v_mov_b32 v4, 0
    v_mov_b32 v5, 0
    v_mov_b32 v6, 0
    v_mov_b32 v7, 0
    v_lshlrev_b32 v8, 4, v255
    v_add_u32 v9, s28, v8
    ds_write_b128 v9, v[4:7]
    ds_write_b128 v9, v[4:7] offset:1024
    v_lshlrev_b32 v9, 3, v255
    v_add_u32 v9, s28, v9
    ds_write_b64 v9, v[4:5] offset:2048
    v_lshlrev_b32 v9, 2, v1
    v_add_u32 v9, s27, v9
    ds_write_b32 v9, v4 offset:0
    ds_write_b32 v9, v4 offset:4160
    ds_write_b32 v9, v4 offset:8320
    ds_write_b32 v9, v4 offset:12480
    s_waitcnt vmcnt(0)
    v_lshlrev_b32 v16, 16, v16
    v_mul_f32 v16, 0x3fb8aa3b, v16
    v_exp_f32 v16, v16
    v_lshlrev_b32 v17, 16, v17
    v_cvt_pk_bf16_f32 v16, v16, v16
    v_lshlrev_b32 v16, 16, v16
    v_lshlrev_b32 v20, 16, v10
    v_lshlrev_b32 v21, 16, v11
    v_lshlrev_b32 v22, 16, v12
    v_lshlrev_b32 v23, 16, v13
    v_lshlrev_b32 v24, 16, v14
    v_lshlrev_b32 v25, 16, v15
    v_mul_f32 v20, v16, v20
    v_mul_f32 v21, v16, v21
    v_mul_f32 v22, v16, v22
    v_mul_f32 v23, v16, v23
    v_mul_f32 v28, 0x3fb8aa3b, v20
    v_mul_f32 v29, 0.15915494309189535, v21
    v_mul_f32 v30, v24, v22
    v_fma_f32 v30, -v25, v23, v30
    v_mul_f32 v31, v24, v23
    v_fmac_f32 v31, v25, v22
    v_and_b32 v20, 0xffff0000, v10
    v_and_b32 v21, 0xffff0000, v11
    v_and_b32 v22, 0xffff0000, v12
    v_and_b32 v23, 0xffff0000, v13
    v_and_b32 v24, 0xffff0000, v14
    v_and_b32 v25, 0xffff0000, v15
    v_mul_f32 v20, v16, v20
    v_mul_f32 v21, v16, v21
    v_mul_f32 v22, v16, v22
    v_mul_f32 v23, v16, v23
    v_mul_f32 v32, 0x3fb8aa3b, v20
    v_mul_f32 v33, 0.15915494309189535, v21
    v_mul_f32 v34, v24, v22
    v_fma_f32 v34, -v25, v23, v34
    v_mul_f32 v35, v24, v23
    v_fmac_f32 v35, v25, v22
    v_lshlrev_b32 v9, 5, v255
    v_add_u32 v9, s29, v9
    ds_write_b128 v9, v[28:31]
    ds_write_b128 v9, v[32:35] offset:16
    v_lshlrev_b32 v10, 3, v1
    v_cvt_f32_u32 v10, v10
    v_mov_b32 v11, v1
    v_mov_b32 v12, v1
    v_mov_b32 v13, 8
    v_lshlrev_b32 v14, 1, v1
    v_add_u32 v14, 240, v14
    v_add_u32 v15, 248, v1
    v_cmp_le_u32 vcc, 8, v1
    v_mov_b32 v18, 4
    s_nop 0
    v_cndmask_b32 v11, v11, v14, vcc
    v_cndmask_b32 v12, v12, v15, vcc
    v_cndmask_b32 v13, v13, v18, vcc
    v_bfe_u32 v19, v1, 1, 1
    v_and_b32 v20, 1, v1
    v_lshlrev_b32 v14, 8, v19
    v_lshl_add_u32 v14, v20, 2, v14
    v_add_u32 v14, 512, v14
    v_lshl_add_u32 v15, v19, 6, v20
    v_add_u32 v15, 384, v15
    v_cmp_le_u32 vcc, 12, v1
    v_mov_b32 v18, 2
    s_nop 0
    v_cndmask_b32 v11, v11, v14, vcc
    v_cndmask_b32 v12, v12, v15, vcc
    v_cndmask_b32 v13, v13, v18, vcc
    v_min_u32 v19, 21, v1
    v_lshlrev_b32 v14, 8, v19
    v_add_u32 v14, -3072, v14
    v_lshlrev_b32 v15, 5, v19
    v_cmp_le_u32 vcc, 16, v1
    v_mov_b32 v18, 1
    s_nop 0
    v_cndmask_b32 v11, v11, v14, vcc
    v_cndmask_b32 v12, v12, v15, vcc
    v_cndmask_b32 v13, v13, v18, vcc
    v_cvt_f32_u32 v11, v11
    v_lshlrev_b32 v9, 6, v2
    v_add_u32 v9, s29, v9
    v_mov_b32 v64, 0
    v_mov_b32 v65, 0
    v_mov_b32 v66, 0
    v_mov_b32 v67, 0
    v_mov_b32 v68, 0
    v_mov_b32 v69, 0
    v_mov_b32 v70, 0
    v_mov_b32 v71, 0
    v_mov_b32 v72, 0
    v_mov_b32 v73, 0
    v_mov_b32 v74, 0
    v_mov_b32 v75, 0
    v_mov_b32 v76, 0
    v_mov_b32 v77, 0
    v_mov_b32 v78, 0
    v_mov_b32 v79, 0
    s_mov_b32 s31, 0
L_kgs:
    ds_read_b128 v[40:43], v9 offset:0
    ds_read_b128 v[44:47], v9 offset:16
    ds_read_b128 v[48:51], v9 offset:32
    ds_read_b128 v[52:55], v9 offset:48
    v_add_u32 v9, 128, v9
    s_waitcnt lgkmcnt(3)
    v_mul_f32 v20, v40, v10
    v_mul_f32 v21, v41, v10
    v_mul_f32 v24, v40, v11
    v_mul_f32 v25, v41, v11
    v_fract_f32 v21, v21
    v_fract_f32 v25, v25
    v_exp_f32 v20, v20
    v_cos_f32 v22, v21
    v_sin_f32 v23, v21
    v_exp_f32 v24, v24
    v_cos_f32 v26, v25
    v_sin_f32 v27, v25
    v_mul_f32 v28, v22, v42
    v_mul_f32 v29, v22, v43
    v_fma_f32 v28, -v23, v43, v28
    v_fmac_f32 v29, v23, v42
    v_mul_f32 v26, v26, v24
    v_mul_f32 v27, v27, v24
    v_mul_f32 v28, v28, v20
    v_mul_f32 v29, -v29, v20
    v_cvt_pk_bf16_f32 v60, v26, v27
    v_cvt_pk_bf16_f32 v56, v28, v29
    s_waitcnt lgkmcnt(2)
    v_mul_f32 v20, v44, v10
    v_mul_f32 v21, v45, v10
    v_mul_f32 v24, v44, v11
    v_mul_f32 v25, v45, v11
    v_fract_f32 v21, v21
    v_fract_f32 v25, v25
    v_exp_f32 v20, v20
    v_cos_f32 v22, v21
    v_sin_f32 v23, v21
    v_exp_f32 v24, v24
    v_cos_f32 v26, v25
    v_sin_f32 v27, v25
    v_mul_f32 v28, v22, v46
    v_mul_f32 v29, v22, v47
    v_fma_f32 v28, -v23, v47, v28
    v_fmac_f32 v29, v23, v46
    v_mul_f32 v26, v26, v24
    v_mul_f32 v27, v27, v24
    v_mul_f32 v28, v28, v20
    v_mul_f32 v29, -v29, v20
    v_cvt_pk_bf16_f32 v61, v26, v27
    v_cvt_pk_bf16_f32 v57, v28, v29
    s_waitcnt lgkmcnt(1)
    v_mul_f32 v20, v48, v10
    v_mul_f32 v21, v49, v10
    v_mul_f32 v24, v48, v11
    v_mul_f32 v25, v49, v11
    v_fract_f32 v21, v21
    v_fract_f32 v25, v25
    v_exp_f32 v20, v20
    v_cos_f32 v22, v21
    v_sin_f32 v23, v21
    v_exp_f32 v24, v24
    v_cos_f32 v26, v25
    v_sin_f32 v27, v25
    v_mul_f32 v28, v22, v50
    v_mul_f32 v29, v22, v51
    v_fma_f32 v28, -v23, v51, v28
    v_fmac_f32 v29, v23, v50
    v_mul_f32 v26, v26, v24
    v_mul_f32 v27, v27, v24
    v_mul_f32 v28, v28, v20
    v_mul_f32 v29, -v29, v20
    v_cvt_pk_bf16_f32 v62, v26, v27
    v_cvt_pk_bf16_f32 v58, v28, v29
    s_waitcnt lgkmcnt(0)
    v_mul_f32 v20, v52, v10
    v_mul_f32 v21, v53, v10
    v_mul_f32 v24, v52, v11
    v_mul_f32 v25, v53, v11
    v_fract_f32 v21, v21
    v_fract_f32 v25, v25
    v_exp_f32 v20, v20
    v_cos_f32 v22, v21
    v_sin_f32 v23, v21
    v_exp_f32 v24, v24
    v_cos_f32 v26, v25
    v_sin_f32 v27, v25
    v_mul_f32 v28, v22, v54
    v_mul_f32 v29, v22, v55
    v_fma_f32 v28, -v23, v55, v28
    v_fmac_f32 v29, v23, v54
    v_mul_f32 v26, v26, v24
    v_mul_f32 v27, v27, v24
    v_mul_f32 v28, v28, v20
    v_mul_f32 v29, -v29, v20
    v_cvt_pk_bf16_f32 v63, v26, v27
    v_cvt_pk_bf16_f32 v59, v28, v29
    s_add_u32 s31, s31, 1
    s_cmp_lt_u32 s31, 16
    v_mfma_f32_32x32x16_bf16 v[64:79], v[56:59], v[60:63], v[64:79]
    s_cbranch_scc1 L_kgs
    s_lshl_b32 s25, s22, 4
    s_add_u32 s25, s25, 32
    v_add_u32 v3, s25, v2
    v_mul_u32_u24 v3, 80, v3
    v_lshl_add_u32 v3, v1, 1, v3
    v_add_u32 v3, 66560, v3
    v_accvgpr_read_b32 v200, a0
    v_accvgpr_read_b32 v201, a1
    v_accvgpr_read_b32 v202, a8
    v_accvgpr_read_b32 v203, a9
    v_accvgpr_read_b32 v204, a16
    v_accvgpr_read_b32 v205, a17
    v_accvgpr_read_b32 v206, a24
    v_accvgpr_read_b32 v207, a25
    v_accvgpr_read_b32 v208, a32
    v_accvgpr_read_b32 v209, a33
    v_accvgpr_read_b32 v210, a40
    v_accvgpr_read_b32 v211, a41
    v_accvgpr_read_b32 v212, a48
    v_accvgpr_read_b32 v213, a49
    v_accvgpr_read_b32 v214, a56
    v_accvgpr_read_b32 v215, a57
    ds_write_b16 v3, v200 offset:0
    ds_write_b16_d16_hi v3, v200 offset:7680
    ds_write_b16 v3, v201 offset:15360
    ds_write_b16_d16_hi v3, v201 offset:23040
    ds_write_b16 v3, v202 offset:160
    ds_write_b16_d16_hi v3, v202 offset:7840
    ds_write_b16 v3, v203 offset:15520
    ds_write_b16_d16_hi v3, v203 offset:23200
    ds_write_b16 v3, v204 offset:320
    ds_write_b16_d16_hi v3, v204 offset:8000
    ds_write_b16 v3, v205 offset:15680
    ds_write_b16_d16_hi v3, v205 offset:23360
    ds_write_b16 v3, v206 offset:480
    ds_write_b16_d16_hi v3, v206 offset:8160
    ds_write_b16 v3, v207 offset:15840
    ds_write_b16_d16_hi v3, v207 offset:23520
    ds_write_b16 v3, v208 offset:640
    ds_write_b16_d16_hi v3, v208 offset:8320
    ds_write_b16 v3, v209 offset:16000
    ds_write_b16_d16_hi v3, v209 offset:23680
    ds_write_b16 v3, v210 offset:800
    ds_write_b16_d16_hi v3, v210 offset:8480
    ds_write_b16 v3, v211 offset:16160
    ds_write_b16_d16_hi v3, v211 offset:23840
    ds_write_b16 v3, v212 offset:960
    ds_write_b16_d16_hi v3, v212 offset:8640
    ds_write_b16 v3, v213 offset:16320
    ds_write_b16_d16_hi v3, v213 offset:24000
    ds_write_b16 v3, v214 offset:1120
    ds_write_b16_d16_hi v3, v214 offset:8800
    ds_write_b16 v3, v215 offset:16480
    ds_write_b16_d16_hi v3, v215 offset:24160
    v_lshlrev_b32 v13, 1, v13
    v_lshlrev_b32 v14, 2, v2
    v_mul_u32_u24 v14, v14, v13
    v_lshl_add_u32 v12, v12, 1, v14
    v_add_u32 v12, s30, v12
    v_mul_u32_u24 v14, 5, v13
    v_cvt_pk_bf16_f32 v20, v64, v65
    ds_write_b16 v12, v20
    v_add_u32 v12, v12, v13
    ds_write_b16_d16_hi v12, v20
    v_add_u32 v12, v12, v13
    v_cvt_pk_bf16_f32 v20, v66, v67
    ds_write_b16 v12, v20
    v_add_u32 v12, v12, v13
    ds_write_b16_d16_hi v12, v20
    v_add_u32 v12, v12, v14
    v_cvt_pk_bf16_f32 v20, v68, v69
    ds_write_b16 v12, v20
    v_add_u32 v12, v12, v13
    ds_write_b16_d16_hi v12, v20
    v_add_u32 v12, v12, v13
    v_cvt_pk_bf16_f32 v20, v70, v71
    ds_write_b16 v12, v20
    v_add_u32 v12, v12, v13
    ds_write_b16_d16_hi v12, v20
    v_add_u32 v12, v12, v14
    v_cvt_pk_bf16_f32 v20, v72, v73
    ds_write_b16 v12, v20
    v_add_u32 v12, v12, v13
    ds_write_b16_d16_hi v12, v20
    v_add_u32 v12, v12, v13
    v_cvt_pk_bf16_f32 v20, v74, v75
    ds_write_b16 v12, v20
    v_add_u32 v12, v12, v13
    ds_write_b16_d16_hi v12, v20
    v_add_u32 v12, v12, v14
    v_cvt_pk_bf16_f32 v20, v76, v77
    ds_write_b16 v12, v20
    v_add_u32 v12, v12, v13
    ds_write_b16_d16_hi v12, v20
    v_add_u32 v12, v12, v13
    v_cvt_pk_bf16_f32 v20, v78, v79
    ds_write_b16 v12, v20
    v_add_u32 v12, v12, v13
    ds_write_b16_d16_hi v12, v20
    v_add_u32 v12, v12, v14
    v_lshlrev_b32 v20, 1, v255
    v_add_u32 v21, s30, v20
    s_sub_u32 s25, s30, 34048
    v_cvt_f32_u32 v22, v255
    ds_read_u16 v80, v21 offset:0
    ds_read_u16 v81, v21 offset:128
    ds_read_u16 v82, v21 offset:256
    ds_read_u16 v83, v21 offset:384
    v_add_f32 v23, 256.0, v22
    v_cvt_pk_bf16_f32 v23, v23, 0
    v_lshl_add_u32 v23, v23, 1, s25
    ds_read_u16 v84, v23
    v_add_f32 v23, 320.0, v22
    v_cvt_pk_bf16_f32 v23, v23, 0
    v_lshl_add_u32 v23, v23, 1, s25
    ds_read_u16 v85, v23
    v_add_f32 v23, 384.0, v22
    v_cvt_pk_bf16_f32 v23, v23, 0
    v_lshl_add_u32 v23, v23, 1, s25
    ds_read_u16 v86, v23
    v_add_f32 v23, 448.0, v22
    v_cvt_pk_bf16_f32 v23, v23, 0
    v_lshl_add_u32 v23, v23, 1, s25
    ds_read_u16 v87, v23
    v_add_f32 v23, 512.0, v22
    v_cvt_pk_bf16_f32 v23, v23, 0
    v_lshl_add_u32 v23, v23, 1, s25
    ds_read_u16 v88, v23
    v_add_f32 v23, 576.0, v22
    v_cvt_pk_bf16_f32 v23, v23, 0
    v_lshl_add_u32 v23, v23, 1, s25
    ds_read_u16 v89, v23
    v_add_f32 v23, 640.0, v22
    v_cvt_pk_bf16_f32 v23, v23, 0
    v_lshl_add_u32 v23, v23, 1, s25
    ds_read_u16 v90, v23
    v_add_f32 v23, 704.0, v22
    v_cvt_pk_bf16_f32 v23, v23, 0
    v_lshl_add_u32 v23, v23, 1, s25
    ds_read_u16 v91, v23
    v_add_f32 v23, 768.0, v22
    v_cvt_pk_bf16_f32 v23, v23, 0
    v_lshl_add_u32 v23, v23, 1, s25
    ds_read_u16 v92, v23
    v_add_f32 v23, 832.0, v22
    v_cvt_pk_bf16_f32 v23, v23, 0
    v_lshl_add_u32 v23, v23, 1, s25
    ds_read_u16 v93, v23
    v_add_f32 v23, 896.0, v22
    v_cvt_pk_bf16_f32 v23, v23, 0
    v_lshl_add_u32 v23, v23, 1, s25
    ds_read_u16 v94, v23
    v_add_f32 v23, 960.0, v22
    v_cvt_pk_bf16_f32 v23, v23, 0
    v_lshl_add_u32 v23, v23, 1, s25
    ds_read_u16 v95, v23
    v_add_f32 v23, 1024.0, v22
    v_cvt_pk_bf16_f32 v23, v23, 0
    v_lshl_add_u32 v23, v23, 1, s25
    ds_read_u16 v96, v23
    v_add_f32 v23, 1088.0, v22
    v_cvt_pk_bf16_f32 v23, v23, 0
    v_lshl_add_u32 v23, v23, 1, s25
    ds_read_u16 v97, v23
    v_add_f32 v23, 1152.0, v22
    v_cvt_pk_bf16_f32 v23, v23, 0
    v_lshl_add_u32 v23, v23, 1, s25
    ds_read_u16 v98, v23
    v_add_f32 v23, 1216.0, v22
    v_cvt_pk_bf16_f32 v23, v23, 0
    v_lshl_add_u32 v23, v23, 1, s25
    ds_read_u16 v99, v23
    v_add_f32 v23, 1280.0, v22
    v_cvt_pk_bf16_f32 v23, v23, 0
    v_lshl_add_u32 v23, v23, 1, s25
    ds_read_u16 v100, v23
    v_add_f32 v23, 1344.0, v22
    v_cvt_pk_bf16_f32 v23, v23, 0
    v_lshl_add_u32 v23, v23, 1, s25
    ds_read_u16 v101, v23
    v_add_f32 v23, 1408.0, v22
    v_cvt_pk_bf16_f32 v23, v23, 0
    v_lshl_add_u32 v23, v23, 1, s25
    ds_read_u16 v102, v23
    v_add_f32 v23, 1472.0, v22
    v_cvt_pk_bf16_f32 v23, v23, 0
    v_lshl_add_u32 v23, v23, 1, s25
    ds_read_u16 v103, v23
    v_add_f32 v23, 1536.0, v22
    v_cvt_pk_bf16_f32 v23, v23, 0
    v_lshl_add_u32 v23, v23, 1, s25
    ds_read_u16 v104, v23
    v_add_f32 v23, 1600.0, v22
    v_cvt_pk_bf16_f32 v23, v23, 0
    v_lshl_add_u32 v23, v23, 1, s25
    ds_read_u16 v105, v23
    v_add_f32 v23, 1664.0, v22
    v_cvt_pk_bf16_f32 v23, v23, 0
    v_lshl_add_u32 v23, v23, 1, s25
    ds_read_u16 v106, v23
    v_add_f32 v23, 1728.0, v22
    v_cvt_pk_bf16_f32 v23, v23, 0
    v_lshl_add_u32 v23, v23, 1, s25
    ds_read_u16 v107, v23
    v_add_f32 v23, 1792.0, v22
    v_cvt_pk_bf16_f32 v23, v23, 0
    v_lshl_add_u32 v23, v23, 1, s25
    ds_read_u16 v108, v23
    v_add_f32 v23, 1856.0, v22
    v_cvt_pk_bf16_f32 v23, v23, 0
    v_lshl_add_u32 v23, v23, 1, s25
    ds_read_u16 v109, v23
    v_add_f32 v23, 1920.0, v22
    v_cvt_pk_bf16_f32 v23, v23, 0
    v_lshl_add_u32 v23, v23, 1, s25
    ds_read_u16 v110, v23
    v_add_f32 v23, 1984.0, v22
    v_cvt_pk_bf16_f32 v23, v23, 0
    v_lshl_add_u32 v23, v23, 1, s25
    ds_read_u16 v111, v23
    v_add_u32 v20, s27, v20
    s_waitcnt lgkmcnt(0)
    ds_write_b16 v20, v80 offset:64
    ds_write_b16 v20, v80 offset:4226
    ds_write_b16 v20, v80 offset:8388
    ds_write_b16 v20, v80 offset:12550
    ds_write_b16 v20, v81 offset:192
    ds_write_b16 v20, v81 offset:4354
    ds_write_b16 v20, v81 offset:8516
    ds_write_b16 v20, v81 offset:12678
    ds_write_b16 v20, v82 offset:320
    ds_write_b16 v20, v82 offset:4482
    ds_write_b16 v20, v82 offset:8644
    ds_write_b16 v20, v82 offset:12806
    ds_write_b16 v20, v83 offset:448
    ds_write_b16 v20, v83 offset:4610
    ds_write_b16 v20, v83 offset:8772
    ds_write_b16 v20, v83 offset:12934
    ds_write_b16 v20, v84 offset:576
    ds_write_b16 v20, v84 offset:4738
    ds_write_b16 v20, v84 offset:8900
    ds_write_b16 v20, v84 offset:13062
    ds_write_b16 v20, v85 offset:704
    ds_write_b16 v20, v85 offset:4866
    ds_write_b16 v20, v85 offset:9028
    ds_write_b16 v20, v85 offset:13190
    ds_write_b16 v20, v86 offset:832
    ds_write_b16 v20, v86 offset:4994
    ds_write_b16 v20, v86 offset:9156
    ds_write_b16 v20, v86 offset:13318
    ds_write_b16 v20, v87 offset:960
    ds_write_b16 v20, v87 offset:5122
    ds_write_b16 v20, v87 offset:9284
    ds_write_b16 v20, v87 offset:13446
    ds_write_b16 v20, v88 offset:1088
    ds_write_b16 v20, v88 offset:5250
    ds_write_b16 v20, v88 offset:9412
    ds_write_b16 v20, v88 offset:13574
    ds_write_b16 v20, v89 offset:1216
    ds_write_b16 v20, v89 offset:5378
    ds_write_b16 v20, v89 offset:9540
    ds_write_b16 v20, v89 offset:13702
    ds_write_b16 v20, v90 offset:1344
    ds_write_b16 v20, v90 offset:5506
    ds_write_b16 v20, v90 offset:9668
    ds_write_b16 v20, v90 offset:13830
    ds_write_b16 v20, v91 offset:1472
    ds_write_b16 v20, v91 offset:5634
    ds_write_b16 v20, v91 offset:9796
    ds_write_b16 v20, v91 offset:13958
    ds_write_b16 v20, v92 offset:1600
    ds_write_b16 v20, v92 offset:5762
    ds_write_b16 v20, v92 offset:9924
    ds_write_b16 v20, v92 offset:14086
    ds_write_b16 v20, v93 offset:1728
    ds_write_b16 v20, v93 offset:5890
    ds_write_b16 v20, v93 offset:10052
    ds_write_b16 v20, v93 offset:14214
    ds_write_b16 v20, v94 offset:1856
    ds_write_b16 v20, v94 offset:6018
    ds_write_b16 v20, v94 offset:10180
    ds_write_b16 v20, v94 offset:14342
    ds_write_b16 v20, v95 offset:1984
    ds_write_b16 v20, v95 offset:6146
    ds_write_b16 v20, v95 offset:10308
    ds_write_b16 v20, v95 offset:14470
    ds_write_b16 v20, v96 offset:2112
    ds_write_b16 v20, v96 offset:6274
    ds_write_b16 v20, v96 offset:10436
    ds_write_b16 v20, v96 offset:14598
    ds_write_b16 v20, v97 offset:2240
    ds_write_b16 v20, v97 offset:6402
    ds_write_b16 v20, v97 offset:10564
    ds_write_b16 v20, v97 offset:14726
    ds_write_b16 v20, v98 offset:2368
    ds_write_b16 v20, v98 offset:6530
    ds_write_b16 v20, v98 offset:10692
    ds_write_b16 v20, v98 offset:14854
    ds_write_b16 v20, v99 offset:2496
    ds_write_b16 v20, v99 offset:6658
    ds_write_b16 v20, v99 offset:10820
    ds_write_b16 v20, v99 offset:14982
    ds_write_b16 v20, v100 offset:2624
    ds_write_b16 v20, v100 offset:6786
    ds_write_b16 v20, v100 offset:10948
    ds_write_b16 v20, v100 offset:15110
    ds_write_b16 v20, v101 offset:2752
    ds_write_b16 v20, v101 offset:6914
    ds_write_b16 v20, v101 offset:11076
    ds_write_b16 v20, v101 offset:15238
    ds_write_b16 v20, v102 offset:2880
    ds_write_b16 v20, v102 offset:7042
    ds_write_b16 v20, v102 offset:11204
    ds_write_b16 v20, v102 offset:15366
    ds_write_b16 v20, v103 offset:3008
    ds_write_b16 v20, v103 offset:7170
    ds_write_b16 v20, v103 offset:11332
    ds_write_b16 v20, v103 offset:15494
    ds_write_b16 v20, v104 offset:3136
    ds_write_b16 v20, v104 offset:7298
    ds_write_b16 v20, v104 offset:11460
    ds_write_b16 v20, v104 offset:15622
    ds_write_b16 v20, v105 offset:3264
    ds_write_b16 v20, v105 offset:7426
    ds_write_b16 v20, v105 offset:11588
    ds_write_b16 v20, v105 offset:15750
    ds_write_b16 v20, v106 offset:3392
    ds_write_b16 v20, v106 offset:7554
    ds_write_b16 v20, v106 offset:11716
    ds_write_b16 v20, v106 offset:15878
    ds_write_b16 v20, v107 offset:3520
    ds_write_b16 v20, v107 offset:7682
    ds_write_b16 v20, v107 offset:11844
    ds_write_b16 v20, v107 offset:16006
    ds_write_b16 v20, v108 offset:3648
    ds_write_b16 v20, v108 offset:7810
    ds_write_b16 v20, v108 offset:11972
    ds_write_b16 v20, v108 offset:16134
    ds_write_b16 v20, v109 offset:3776
    ds_write_b16 v20, v109 offset:7938
    ds_write_b16 v20, v109 offset:12100
    ds_write_b16 v20, v109 offset:16262
    ds_write_b16 v20, v110 offset:3904
    ds_write_b16 v20, v110 offset:8066
    ds_write_b16 v20, v110 offset:12228
    ds_write_b16 v20, v110 offset:16390
    v_sub_u32 v21, 63, v255
    ds_write_b16 v20, v111 offset:4032
    v_cmp_le_u32 vcc, 1, v21
    s_and_b64 exec, exec, vcc
    ds_write_b16 v20, v111 offset:8194
    v_cmp_le_u32 vcc, 2, v21
    s_and_b64 exec, exec, vcc
    ds_write_b16 v20, v111 offset:12356
    v_cmp_le_u32 vcc, 3, v21
    s_and_b64 exec, exec, vcc
    ds_write_b16 v20, v111 offset:16518
    s_mov_b64 exec, -1
    v_bfe_u32 v4, v255, 2, 2
    v_mul_u32_u24 v4, 4160, v4
    v_and_b32 v5, 3, v255
    v_lshl_add_u32 v4, v5, 3, v4
    v_bfe_u32 v5, v255, 4, 1
    v_lshl_add_u32 v4, v5, 5, v4
    v_lshlrev_b32 v5, 4, v2
    v_sub_u32 v4, v4, v5
    v_add_u32 v4, 24, v4
    v_add_u32 v4, s27, v4
    v_mul_u32_u24 v6, 80, v1
    v_add_u32 v6, s28, v6
    v_add_u32 v7, v6, v5
    v_add_u32 v5, 2400, v7
    v_lshl_add_u32 v6, v2, 3, v6
    v_mov_b32 v64, 0
    v_mov_b32 v65, 0
    v_mov_b32 v66, 0
    v_mov_b32 v67, 0
    v_mov_b32 v68, 0
    v_mov_b32 v69, 0
    v_mov_b32 v70, 0
    v_mov_b32 v71, 0
    v_mov_b32 v72, 0
    v_mov_b32 v73, 0
    v_mov_b32 v74, 0
    v_mov_b32 v75, 0
    v_mov_b32 v76, 0
    v_mov_b32 v77, 0
    v_mov_b32 v78, 0
    v_mov_b32 v79, 0
    v_mov_b32 v80, 0
    v_mov_b32 v81, 0
    v_mov_b32 v82, 0
    v_mov_b32 v83, 0
    v_mov_b32 v84, 0
    v_mov_b32 v85, 0
    v_mov_b32 v86, 0
    v_mov_b32 v87, 0
    v_mov_b32 v88, 0
    v_mov_b32 v89, 0
    v_mov_b32 v90, 0
    v_mov_b32 v91, 0
    v_mov_b32 v92, 0
    v_mov_b32 v93, 0
    v_mov_b32 v94, 0
    v_mov_b32 v95, 0
    s_waitcnt lgkmcnt(0)
    s_barrier
    ds_read_b64_tr_b16 v[100:101], v4 offset:40
    ds_read_b64_tr_b16 v[102:103], v4 offset:32
    ds_read_b128 v[108:111], v5 offset:160
    ds_read_b64_tr_b16 v[104:105], v4 offset:2088
    ds_read_b64_tr_b16 v[106:107], v4 offset:2080
    ds_read_b128 v[112:115], v5 offset:2720
    ds_read_b64_tr_b16 v[116:117], v4 offset:8
    ds_read_b64_tr_b16 v[118:119], v4 offset:0
    ds_read_b128 v[124:127], v5 offset:192
    ds_read_b64_tr_b16 v[120:121], v4 offset:2056
    ds_read_b64_tr_b16 v[122:123], v4 offset:2048
    ds_read_b128 v[128:131], v5 offset:2752
    s_mov_b32 s31, 0
L_cvs:
    s_waitcnt lgkmcnt(0)
    v_mfma_f32_32x32x16_bf16 v[64:79], v[100:103], v[108:111], v[64:79]
    ds_read_b64_tr_b16 v[132:133], v4 offset:104
    ds_read_b64_tr_b16 v[134:135], v4 offset:96
    ds_read_b128 v[140:143], v5 offset:80
    v_mfma_f32_32x32x16_bf16 v[80:95], v[100:103], v[112:115], v[80:95]
    ds_read_b64_tr_b16 v[136:137], v4 offset:2152
    ds_read_b64_tr_b16 v[138:139], v4 offset:2144
    ds_read_b128 v[144:147], v5 offset:2640
    v_mfma_f32_32x32x16_bf16 v[80:95], v[104:107], v[108:111], v[80:95]
    ds_read_b64_tr_b16 v[148:149], v4 offset:72
    ds_read_b64_tr_b16 v[150:151], v4 offset:64
    ds_read_b128 v[156:159], v5 offset:112
    v_mfma_f32_32x32x16_bf16 v[64:79], v[116:119], v[124:127], v[64:79]
    ds_read_b64_tr_b16 v[152:153], v4 offset:2120
    ds_read_b64_tr_b16 v[154:155], v4 offset:2112
    ds_read_b128 v[160:163], v5 offset:2672
    v_mfma_f32_32x32x16_bf16 v[80:95], v[116:119], v[128:131], v[80:95]
    v_mfma_f32_32x32x16_bf16 v[80:95], v[120:123], v[124:127], v[80:95]
    s_waitcnt lgkmcnt(0)
    v_mfma_f32_32x32x16_bf16 v[64:79], v[132:135], v[140:143], v[64:79]
    ds_read_b64_tr_b16 v[100:101], v4 offset:168
    ds_read_b64_tr_b16 v[102:103], v4 offset:160
    ds_read_b128 v[108:111], v5 offset:0
    v_mfma_f32_32x32x16_bf16 v[80:95], v[132:135], v[144:147], v[80:95]
    ds_read_b64_tr_b16 v[104:105], v4 offset:2216
    ds_read_b64_tr_b16 v[106:107], v4 offset:2208
    ds_read_b128 v[112:115], v5 offset:2560
    v_mfma_f32_32x32x16_bf16 v[80:95], v[136:139], v[140:143], v[80:95]
    ds_read_b64_tr_b16 v[116:117], v4 offset:136
    ds_read_b64_tr_b16 v[118:119], v4 offset:128
    ds_read_b128 v[124:127], v5 offset:32
    v_mfma_f32_32x32x16_bf16 v[64:79], v[148:151], v[156:159], v[64:79]
    ds_read_b64_tr_b16 v[120:121], v4 offset:2184
    ds_read_b64_tr_b16 v[122:123], v4 offset:2176
    ds_read_b128 v[128:131], v5 offset:2592
    v_mfma_f32_32x32x16_bf16 v[80:95], v[148:151], v[160:163], v[80:95]
    v_mfma_f32_32x32x16_bf16 v[80:95], v[152:155], v[156:159], v[80:95]
    v_add_u32 v4, 128, v4
    v_add_u32 v5, -160, v5
    s_add_u32 s31, s31, 1
    s_cmp_lt_u32 s31, 16
    s_cbranch_scc1 L_cvs
    s_waitcnt lgkmcnt(0)
    ds_read_b64 v[100:101], v6 offset:2560
    ds_read_b64 v[102:103], v6 offset:2576
    ds_read_b64 v[104:105], v6 offset:2592
    ds_read_b64 v[106:107], v6 offset:2608
    ds_read_b64 v[108:109], v6 offset:5120
    ds_read_b64 v[110:111], v6 offset:5136
    ds_read_b64 v[112:113], v6 offset:5152
    ds_read_b64 v[114:115], v6 offset:5168
    s_nop 3
    s_waitcnt lgkmcnt(0)
    v_lshlrev_b32 v20, 16, v100
    v_and_b32 v21, 0xffff0000, v100
    v_mul_f32 v20, v20, v17
    v_mul_f32 v21, v21, v17
    v_cvt_pk_bf16_f32 v20, v20, v21
    v_cvt_pk_bf16_f32 v22, v64, v65
    v_and_b32 v21, 0xffff0000, v20
    v_lshlrev_b32 v20, 16, v20
    v_and_b32 v23, 0xffff0000, v22
    v_lshlrev_b32 v22, 16, v22
    v_add_f32 v20, v20, v22
    v_add_f32 v21, v21, v23
    v_cvt_pk_bf16_f32 v100, v20, v21
    v_lshlrev_b32 v20, 16, v101
    v_and_b32 v21, 0xffff0000, v101
    v_mul_f32 v20, v20, v17
    v_mul_f32 v21, v21, v17
    v_cvt_pk_bf16_f32 v20, v20, v21
    v_cvt_pk_bf16_f32 v22, v66, v67
    v_and_b32 v21, 0xffff0000, v20
    v_lshlrev_b32 v20, 16, v20
    v_and_b32 v23, 0xffff0000, v22
    v_lshlrev_b32 v22, 16, v22
    v_add_f32 v20, v20, v22
    v_add_f32 v21, v21, v23
    v_cvt_pk_bf16_f32 v101, v20, v21
    v_lshlrev_b32 v20, 16, v102
    v_and_b32 v21, 0xffff0000, v102
    v_mul_f32 v20, v20, v17
    v_mul_f32 v21, v21, v17
    v_cvt_pk_bf16_f32 v20, v20, v21
    v_cvt_pk_bf16_f32 v22, v68, v69
    v_and_b32 v21, 0xffff0000, v20
    v_lshlrev_b32 v20, 16, v20
    v_and_b32 v23, 0xffff0000, v22
    v_lshlrev_b32 v22, 16, v22
    v_add_f32 v20, v20, v22
    v_add_f32 v21, v21, v23
    v_cvt_pk_bf16_f32 v102, v20, v21
    v_lshlrev_b32 v20, 16, v103
    v_and_b32 v21, 0xffff0000, v103
    v_mul_f32 v20, v20, v17
    v_mul_f32 v21, v21, v17
    v_cvt_pk_bf16_f32 v20, v20, v21
    v_cvt_pk_bf16_f32 v22, v70, v71
    v_and_b32 v21, 0xffff0000, v20
    v_lshlrev_b32 v20, 16, v20
    v_and_b32 v23, 0xffff0000, v22
    v_lshlrev_b32 v22, 16, v22
    v_add_f32 v20, v20, v22
    v_add_f32 v21, v21, v23
    v_cvt_pk_bf16_f32 v103, v20, v21
    v_lshlrev_b32 v20, 16, v104
    v_and_b32 v21, 0xffff0000, v104
    v_mul_f32 v20, v20, v17
    v_mul_f32 v21, v21, v17
    v_cvt_pk_bf16_f32 v20, v20, v21
    v_cvt_pk_bf16_f32 v22, v72, v73
    v_and_b32 v21, 0xffff0000, v20
    v_lshlrev_b32 v20, 16, v20
    v_and_b32 v23, 0xffff0000, v22
    v_lshlrev_b32 v22, 16, v22
    v_add_f32 v20, v20, v22
    v_add_f32 v21, v21, v23
    v_cvt_pk_bf16_f32 v104, v20, v21
    v_lshlrev_b32 v20, 16, v105
    v_and_b32 v21, 0xffff0000, v105
    v_mul_f32 v20, v20, v17
    v_mul_f32 v21, v21, v17
    v_cvt_pk_bf16_f32 v20, v20, v21
    v_cvt_pk_bf16_f32 v22, v74, v75
    v_and_b32 v21, 0xffff0000, v20
    v_lshlrev_b32 v20, 16, v20
    v_and_b32 v23, 0xffff0000, v22
    v_lshlrev_b32 v22, 16, v22
    v_add_f32 v20, v20, v22
    v_add_f32 v21, v21, v23
    v_cvt_pk_bf16_f32 v105, v20, v21
    v_lshlrev_b32 v20, 16, v106
    v_and_b32 v21, 0xffff0000, v106
    v_mul_f32 v20, v20, v17
    v_mul_f32 v21, v21, v17
    v_cvt_pk_bf16_f32 v20, v20, v21
    v_cvt_pk_bf16_f32 v22, v76, v77
    v_and_b32 v21, 0xffff0000, v20
    v_lshlrev_b32 v20, 16, v20
    v_and_b32 v23, 0xffff0000, v22
    v_lshlrev_b32 v22, 16, v22
    v_add_f32 v20, v20, v22
    v_add_f32 v21, v21, v23
    v_cvt_pk_bf16_f32 v106, v20, v21
    v_lshlrev_b32 v20, 16, v107
    v_and_b32 v21, 0xffff0000, v107
    v_mul_f32 v20, v20, v17
    v_mul_f32 v21, v21, v17
    v_cvt_pk_bf16_f32 v20, v20, v21
    v_cvt_pk_bf16_f32 v22, v78, v79
    v_and_b32 v21, 0xffff0000, v20
    v_lshlrev_b32 v20, 16, v20
    v_and_b32 v23, 0xffff0000, v22
    v_lshlrev_b32 v22, 16, v22
    v_add_f32 v20, v20, v22
    v_add_f32 v21, v21, v23
    v_cvt_pk_bf16_f32 v107, v20, v21
    v_lshlrev_b32 v20, 16, v108
    v_and_b32 v21, 0xffff0000, v108
    v_mul_f32 v20, v20, v17
    v_mul_f32 v21, v21, v17
    v_cvt_pk_bf16_f32 v20, v20, v21
    v_cvt_pk_bf16_f32 v22, v80, v81
    v_and_b32 v21, 0xffff0000, v20
    v_lshlrev_b32 v20, 16, v20
    v_and_b32 v23, 0xffff0000, v22
    v_lshlrev_b32 v22, 16, v22
    v_add_f32 v20, v20, v22
    v_add_f32 v21, v21, v23
    v_cvt_pk_bf16_f32 v108, v20, v21
    v_lshlrev_b32 v20, 16, v109
    v_and_b32 v21, 0xffff0000, v109
    v_mul_f32 v20, v20, v17
    v_mul_f32 v21, v21, v17
    v_cvt_pk_bf16_f32 v20, v20, v21
    v_cvt_pk_bf16_f32 v22, v82, v83
    v_and_b32 v21, 0xffff0000, v20
    v_lshlrev_b32 v20, 16, v20
    v_and_b32 v23, 0xffff0000, v22
    v_lshlrev_b32 v22, 16, v22
    v_add_f32 v20, v20, v22
    v_add_f32 v21, v21, v23
    v_cvt_pk_bf16_f32 v109, v20, v21
    v_lshlrev_b32 v20, 16, v110
    v_and_b32 v21, 0xffff0000, v110
    v_mul_f32 v20, v20, v17
    v_mul_f32 v21, v21, v17
    v_cvt_pk_bf16_f32 v20, v20, v21
    v_cvt_pk_bf16_f32 v22, v84, v85
    v_and_b32 v21, 0xffff0000, v20
    v_lshlrev_b32 v20, 16, v20
    v_and_b32 v23, 0xffff0000, v22
    v_lshlrev_b32 v22, 16, v22
    v_add_f32 v20, v20, v22
    v_add_f32 v21, v21, v23
    v_cvt_pk_bf16_f32 v110, v20, v21
    v_lshlrev_b32 v20, 16, v111
    v_and_b32 v21, 0xffff0000, v111
    v_mul_f32 v20, v20, v17
    v_mul_f32 v21, v21, v17
    v_cvt_pk_bf16_f32 v20, v20, v21
    v_cvt_pk_bf16_f32 v22, v86, v87
    v_and_b32 v21, 0xffff0000, v20
    v_lshlrev_b32 v20, 16, v20
    v_and_b32 v23, 0xffff0000, v22
    v_lshlrev_b32 v22, 16, v22
    v_add_f32 v20, v20, v22
    v_add_f32 v21, v21, v23
    v_cvt_pk_bf16_f32 v111, v20, v21
    v_lshlrev_b32 v20, 16, v112
    v_and_b32 v21, 0xffff0000, v112
    v_mul_f32 v20, v20, v17
    v_mul_f32 v21, v21, v17
    v_cvt_pk_bf16_f32 v20, v20, v21
    v_cvt_pk_bf16_f32 v22, v88, v89
    v_and_b32 v21, 0xffff0000, v20
    v_lshlrev_b32 v20, 16, v20
    v_and_b32 v23, 0xffff0000, v22
    v_lshlrev_b32 v22, 16, v22
    v_add_f32 v20, v20, v22
    v_add_f32 v21, v21, v23
    v_cvt_pk_bf16_f32 v112, v20, v21
    v_lshlrev_b32 v20, 16, v113
    v_and_b32 v21, 0xffff0000, v113
    v_mul_f32 v20, v20, v17
    v_mul_f32 v21, v21, v17
    v_cvt_pk_bf16_f32 v20, v20, v21
    v_cvt_pk_bf16_f32 v22, v90, v91
    v_and_b32 v21, 0xffff0000, v20
    v_lshlrev_b32 v20, 16, v20
    v_and_b32 v23, 0xffff0000, v22
    v_lshlrev_b32 v22, 16, v22
    v_add_f32 v20, v20, v22
    v_add_f32 v21, v21, v23
    v_cvt_pk_bf16_f32 v113, v20, v21
    v_lshlrev_b32 v20, 16, v114
    v_and_b32 v21, 0xffff0000, v114
    v_mul_f32 v20, v20, v17
    v_mul_f32 v21, v21, v17
    v_cvt_pk_bf16_f32 v20, v20, v21
    v_cvt_pk_bf16_f32 v22, v92, v93
    v_and_b32 v21, 0xffff0000, v20
    v_lshlrev_b32 v20, 16, v20
    v_and_b32 v23, 0xffff0000, v22
    v_lshlrev_b32 v22, 16, v22
    v_add_f32 v20, v20, v22
    v_add_f32 v21, v21, v23
    v_cvt_pk_bf16_f32 v114, v20, v21
    v_lshlrev_b32 v20, 16, v115
    v_and_b32 v21, 0xffff0000, v115
    v_mul_f32 v20, v20, v17
    v_mul_f32 v21, v21, v17
    v_cvt_pk_bf16_f32 v20, v20, v21
    v_cvt_pk_bf16_f32 v22, v94, v95
    v_and_b32 v21, 0xffff0000, v20
    v_lshlrev_b32 v20, 16, v20
    v_and_b32 v23, 0xffff0000, v22
    v_lshlrev_b32 v22, 16, v22
    v_add_f32 v20, v20, v22
    v_add_f32 v21, v21, v23
    v_cvt_pk_bf16_f32 v115, v20, v21
    ds_write_b64 v6, v[100:101] offset:2560
    ds_write_b64 v6, v[102:103] offset:2576
    ds_write_b64 v6, v[104:105] offset:2592
    ds_write_b64 v6, v[106:107] offset:2608
    ds_write_b64 v6, v[108:109] offset:5120
    ds_write_b64 v6, v[110:111] offset:5136
    ds_write_b64 v6, v[112:113] offset:5152
    ds_write_b64 v6, v[114:115] offset:5168
    s_waitcnt lgkmcnt(0)
    s_barrier
    ds_read_u16 v100, v3 offset:0
    ds_read_u16 v101, v3 offset:7680
    ds_read_u16 v102, v3 offset:15360
    ds_read_u16 v103, v3 offset:23040
    ds_read_u16 v104, v3 offset:160
    ds_read_u16 v105, v3 offset:7840
    ds_read_u16 v106, v3 offset:15520
    ds_read_u16 v107, v3 offset:23200
    ds_read_u16 v108, v3 offset:320
    ds_read_u16 v109, v3 offset:8000
    ds_read_u16 v110, v3 offset:15680
    ds_read_u16 v111, v3 offset:23360
    ds_read_u16 v112, v3 offset:480
    ds_read_u16 v113, v3 offset:8160
    ds_read_u16 v114, v3 offset:15840
    ds_read_u16 v115, v3 offset:23520
    ds_read_u16 v116, v3 offset:640
    ds_read_u16 v117, v3 offset:8320
    ds_read_u16 v118, v3 offset:16000
    ds_read_u16 v119, v3 offset:23680
    ds_read_u16 v120, v3 offset:800
    ds_read_u16 v121, v3 offset:8480
    ds_read_u16 v122, v3 offset:16160
    ds_read_u16 v123, v3 offset:23840
    ds_read_u16 v124, v3 offset:960
    ds_read_u16 v125, v3 offset:8640
    ds_read_u16 v126, v3 offset:16320
    ds_read_u16 v127, v3 offset:24000
    ds_read_u16 v128, v3 offset:1120
    ds_read_u16 v129, v3 offset:8800
    ds_read_u16 v130, v3 offset:16480
    ds_read_u16 v131, v3 offset:24160
    v_accvgpr_mov_b32 a0, a2
    v_accvgpr_mov_b32 a1, a3
    v_accvgpr_mov_b32 a2, a4
    v_accvgpr_mov_b32 a3, a5
    v_accvgpr_mov_b32 a4, a6
    v_accvgpr_mov_b32 a5, a7
    v_accvgpr_mov_b32 a8, a10
    v_accvgpr_mov_b32 a9, a11
    v_accvgpr_mov_b32 a10, a12
    v_accvgpr_mov_b32 a11, a13
    v_accvgpr_mov_b32 a12, a14
    v_accvgpr_mov_b32 a13, a15
    v_accvgpr_mov_b32 a16, a18
    v_accvgpr_mov_b32 a17, a19
    v_accvgpr_mov_b32 a18, a20
    v_accvgpr_mov_b32 a19, a21
    v_accvgpr_mov_b32 a20, a22
    v_accvgpr_mov_b32 a21, a23
    v_accvgpr_mov_b32 a24, a26
    v_accvgpr_mov_b32 a25, a27
    v_accvgpr_mov_b32 a26, a28
    v_accvgpr_mov_b32 a27, a29
    v_accvgpr_mov_b32 a28, a30
    v_accvgpr_mov_b32 a29, a31
    v_accvgpr_mov_b32 a32, a34
    v_accvgpr_mov_b32 a33, a35
    v_accvgpr_mov_b32 a34, a36
    v_accvgpr_mov_b32 a35, a37
    v_accvgpr_mov_b32 a36, a38
    v_accvgpr_mov_b32 a37, a39
    v_accvgpr_mov_b32 a40, a42
    v_accvgpr_mov_b32 a41, a43
    v_accvgpr_mov_b32 a42, a44
    v_accvgpr_mov_b32 a43, a45
    v_accvgpr_mov_b32 a44, a46
    v_accvgpr_mov_b32 a45, a47
    v_accvgpr_mov_b32 a48, a50
    v_accvgpr_mov_b32 a49, a51
    v_accvgpr_mov_b32 a50, a52
    v_accvgpr_mov_b32 a51, a53
    v_accvgpr_mov_b32 a52, a54
    v_accvgpr_mov_b32 a53, a55
    v_accvgpr_mov_b32 a56, a58
    v_accvgpr_mov_b32 a57, a59
    v_accvgpr_mov_b32 a58, a60
    v_accvgpr_mov_b32 a59, a61
    v_accvgpr_mov_b32 a60, a62
    v_accvgpr_mov_b32 a61, a63
    s_waitcnt lgkmcnt(0)
    s_barrier
    v_lshl_or_b32 v20, v101, 16, v100
    v_lshl_or_b32 v21, v103, 16, v102
    v_accvgpr_write_b32 a6, v20
    v_accvgpr_write_b32 a7, v21
    v_lshl_or_b32 v20, v105, 16, v104
    v_lshl_or_b32 v21, v107, 16, v106
    v_accvgpr_write_b32 a14, v20
    v_accvgpr_write_b32 a15, v21
    v_lshl_or_b32 v20, v109, 16, v108
    v_lshl_or_b32 v21, v111, 16, v110
    v_accvgpr_write_b32 a22, v20
    v_accvgpr_write_b32 a23, v21
    v_lshl_or_b32 v20, v113, 16, v112
    v_lshl_or_b32 v21, v115, 16, v114
    v_accvgpr_write_b32 a30, v20
    v_accvgpr_write_b32 a31, v21
    v_lshl_or_b32 v20, v117, 16, v116
    v_lshl_or_b32 v21, v119, 16, v118
    v_accvgpr_write_b32 a38, v20
    v_accvgpr_write_b32 a39, v21
    v_lshl_or_b32 v20, v121, 16, v120
    v_lshl_or_b32 v21, v123, 16, v122
    v_accvgpr_write_b32 a46, v20
    v_accvgpr_write_b32 a47, v21
    v_lshl_or_b32 v20, v125, 16, v124
    v_lshl_or_b32 v21, v127, 16, v126
    v_accvgpr_write_b32 a54, v20
    v_accvgpr_write_b32 a55, v21
    v_lshl_or_b32 v20, v129, 16, v128
    v_lshl_or_b32 v21, v131, 16, v130
    v_accvgpr_write_b32 a62, v20
    v_accvgpr_write_b32 a63, v21
    s_add_u32 s24, s24, 4
    s_add_u32 s32, s32, 1
    s_cmp_lt_u32 s32, 4
    s_cbranch_scc1 L_rnds
    s_mov_b32 s12, s54
    s_and_b32 s13, s55, 0xffff
    s_mov_b32 s14, 0x500000
    s_mov_b32 s15, 0x00020000
    v_mul_u32_u24 v8, 2560, v255
    s_mul_i32 s25, s22, 1310720
    s_lshl_b32 s26, s20, 5
    s_add_u32 s25, s25, s26
    s_add_u32 s25, s25, 1280
    buffer_store_dwordx4 a[0:3], v8, s[12:15], s25 offen
    buffer_store_dwordx4 a[4:7], v8, s[12:15], s25 offen offset:16
    s_add_u32 s25, s25, 163840
    buffer_store_dwordx4 a[8:11], v8, s[12:15], s25 offen
    buffer_store_dwordx4 a[12:15], v8, s[12:15], s25 offen offset:16
    s_add_u32 s25, s25, 163840
    buffer_store_dwordx4 a[16:19], v8, s[12:15], s25 offen
    buffer_store_dwordx4 a[20:23], v8, s[12:15], s25 offen offset:16
    s_add_u32 s25, s25, 163840
    buffer_store_dwordx4 a[24:27], v8, s[12:15], s25 offen
    buffer_store_dwordx4 a[28:31], v8, s[12:15], s25 offen offset:16
    s_add_u32 s25, s25, 163840
    buffer_store_dwordx4 a[32:35], v8, s[12:15], s25 offen
    buffer_store_dwordx4 a[36:39], v8, s[12:15], s25 offen offset:16
    s_add_u32 s25, s25, 163840
    buffer_store_dwordx4 a[40:43], v8, s[12:15], s25 offen
    buffer_store_dwordx4 a[44:47], v8, s[12:15], s25 offen offset:16
    s_add_u32 s25, s25, 163840
    buffer_store_dwordx4 a[48:51], v8, s[12:15], s25 offen
    buffer_store_dwordx4 a[52:55], v8, s[12:15], s25 offen offset:16
    s_add_u32 s25, s25, 163840
    buffer_store_dwordx4 a[56:59], v8, s[12:15], s25 offen
    buffer_store_dwordx4 a[60:63], v8, s[12:15], s25 offen offset:16
    s_add_u32 s25, s25, 163840
    s_waitcnt vmcnt(0)
    s_and_b32 s3, s21, 31
    s_add_u32 s3, s3, s22
    s_cmp_lg_u32 s3, 20
    s_cbranch_scc1 L_fin
    buffer_wbl2 sc1
    s_branch L_fin
L_ma:
    s_lshr_b32 s24, s21, 1
    s_and_b32 s25, s21, 1
    s_and_b32 s53, s22, 1
    s_lshr_b32 s54, s22, 1
    s_load_dwordx2 s[36:37], s[0:1], 32
    s_waitcnt lgkmcnt(0)
    s_mov_b32 s12, s36
    s_and_b32 s13, s37, 0xffff
    s_mov_b32 s14, 0x500000
    s_mov_b32 s15, 0x00020000
    v_and_b32 v1, 15, v255
    v_lshrrev_b32 v2, 4, v255
    v_lshlrev_b32 v3, 1, v2
    v_xor_b32 v3, v3, v1
    v_lshlrev_b32 v3, 4, v3
    v_lshl_add_u32 v4, v2, 13, v3
    v_xor_b32 v5, 128, v4
    s_lshl_b32 s26, s24, 8
    s_mul_i32 s27, s22, 1310720
    s_add_u32 s26, s26, s27
    s_mul_i32 s35, s22, 40960
    s_mov_b32 m0, s35
    s_add_u32 s35, s35, 1024
    buffer_load_dwordx4 v4, s[12:15], s26 offen lds
    s_add_u32 s26, s26, 32768
    s_mov_b32 m0, s35
    s_add_u32 s35, s35, 1024
    buffer_load_dwordx4 v4, s[12:15], s26 offen lds
    s_add_u32 s26, s26, 32768
    s_mov_b32 m0, s35
    s_add_u32 s35, s35, 1024
    buffer_load_dwordx4 v5, s[12:15], s26 offen lds
    s_add_u32 s26, s26, 32768
    s_mov_b32 m0, s35
    s_add_u32 s35, s35, 1024
    buffer_load_dwordx4 v5, s[12:15], s26 offen lds
    s_add_u32 s26, s26, 32768
    s_mov_b32 m0, s35
    s_add_u32 s35, s35, 1024
    buffer_load_dwordx4 v4, s[12:15], s26 offen lds
    s_add_u32 s26, s26, 32768
    s_mov_b32 m0, s35
    s_add_u32 s35, s35, 1024
    buffer_load_dwordx4 v4, s[12:15], s26 offen lds
    s_add_u32 s26, s26, 32768
    s_mov_b32 m0, s35
    s_add_u32 s35, s35, 1024
    buffer_load_dwordx4 v5, s[12:15], s26 offen lds
    s_add_u32 s26, s26, 32768
    s_mov_b32 m0, s35
    s_add_u32 s35, s35, 1024
    buffer_load_dwordx4 v5, s[12:15], s26 offen lds
    s_add_u32 s26, s26, 32768
    s_mov_b32 m0, s35
    s_add_u32 s35, s35, 1024
    buffer_load_dwordx4 v4, s[12:15], s26 offen lds
    s_add_u32 s26, s26, 32768
    s_mov_b32 m0, s35
    s_add_u32 s35, s35, 1024
    buffer_load_dwordx4 v4, s[12:15], s26 offen lds
    s_add_u32 s26, s26, 32768
    s_mov_b32 m0, s35
    s_add_u32 s35, s35, 1024
    buffer_load_dwordx4 v5, s[12:15], s26 offen lds
    s_add_u32 s26, s26, 32768
    s_mov_b32 m0, s35
    s_add_u32 s35, s35, 1024
    buffer_load_dwordx4 v5, s[12:15], s26 offen lds
    s_add_u32 s26, s26, 32768
    s_mov_b32 m0, s35
    s_add_u32 s35, s35, 1024
    buffer_load_dwordx4 v4, s[12:15], s26 offen lds
    s_add_u32 s26, s26, 32768
    s_mov_b32 m0, s35
    s_add_u32 s35, s35, 1024
    buffer_load_dwordx4 v4, s[12:15], s26 offen lds
    s_add_u32 s26, s26, 32768
    s_mov_b32 m0, s35
    s_add_u32 s35, s35, 1024
    buffer_load_dwordx4 v5, s[12:15], s26 offen lds
    s_add_u32 s26, s26, 32768
    s_mov_b32 m0, s35
    s_add_u32 s35, s35, 1024
    buffer_load_dwordx4 v5, s[12:15], s26 offen lds
    s_add_u32 s26, s26, 32768
    s_mov_b32 m0, s35
    s_add_u32 s35, s35, 1024
    buffer_load_dwordx4 v4, s[12:15], s26 offen lds
    s_add_u32 s26, s26, 32768
    s_mov_b32 m0, s35
    s_add_u32 s35, s35, 1024
    buffer_load_dwordx4 v4, s[12:15], s26 offen lds
    s_add_u32 s26, s26, 32768
    s_mov_b32 m0, s35
    s_add_u32 s35, s35, 1024
    buffer_load_dwordx4 v5, s[12:15], s26 offen lds
    s_add_u32 s26, s26, 32768
    s_mov_b32 m0, s35
    s_add_u32 s35, s35, 1024
    buffer_load_dwordx4 v5, s[12:15], s26 offen lds
    s_add_u32 s26, s26, 32768
    s_mov_b32 m0, s35
    s_add_u32 s35, s35, 1024
    buffer_load_dwordx4 v4, s[12:15], s26 offen lds
    s_add_u32 s26, s26, 32768
    s_mov_b32 m0, s35
    s_add_u32 s35, s35, 1024
    buffer_load_dwordx4 v4, s[12:15], s26 offen lds
    s_add_u32 s26, s26, 32768
    s_mov_b32 m0, s35
    s_add_u32 s35, s35, 1024
    buffer_load_dwordx4 v5, s[12:15], s26 offen lds
    s_add_u32 s26, s26, 32768
    s_mov_b32 m0, s35
    s_add_u32 s35, s35, 1024
    buffer_load_dwordx4 v5, s[12:15], s26 offen lds
    s_add_u32 s26, s26, 32768
    s_mov_b32 m0, s35
    s_add_u32 s35, s35, 1024
    buffer_load_dwordx4 v4, s[12:15], s26 offen lds
    s_add_u32 s26, s26, 32768
    s_mov_b32 m0, s35
    s_add_u32 s35, s35, 1024
    buffer_load_dwordx4 v4, s[12:15], s26 offen lds
    s_add_u32 s26, s26, 32768
    s_mov_b32 m0, s35
    s_add_u32 s35, s35, 1024
    buffer_load_dwordx4 v5, s[12:15], s26 offen lds
    s_add_u32 s26, s26, 32768
    s_mov_b32 m0, s35
    s_add_u32 s35, s35, 1024
    buffer_load_dwordx4 v5, s[12:15], s26 offen lds
    s_add_u32 s26, s26, 32768
    s_mov_b32 m0, s35
    s_add_u32 s35, s35, 1024
    buffer_load_dwordx4 v4, s[12:15], s26 offen lds
    s_add_u32 s26, s26, 32768
    s_mov_b32 m0, s35
    s_add_u32 s35, s35, 1024
    buffer_load_dwordx4 v4, s[12:15], s26 offen lds
    s_add_u32 s26, s26, 32768
    s_mov_b32 m0, s35
    s_add_u32 s35, s35, 1024
    buffer_load_dwordx4 v5, s[12:15], s26 offen lds
    s_add_u32 s26, s26, 32768
    s_mov_b32 m0, s35
    s_add_u32 s35, s35, 1024
    buffer_load_dwordx4 v5, s[12:15], s26 offen lds
    s_add_u32 s26, s26, 32768
    s_mov_b32 m0, s35
    s_add_u32 s35, s35, 1024
    buffer_load_dwordx4 v4, s[12:15], s26 offen lds
    s_add_u32 s26, s26, 32768
    s_mov_b32 m0, s35
    s_add_u32 s35, s35, 1024
    buffer_load_dwordx4 v4, s[12:15], s26 offen lds
    s_add_u32 s26, s26, 32768
    s_mov_b32 m0, s35
    s_add_u32 s35, s35, 1024
    buffer_load_dwordx4 v5, s[12:15], s26 offen lds
    s_add_u32 s26, s26, 32768
    s_mov_b32 m0, s35
    s_add_u32 s35, s35, 1024
    buffer_load_dwordx4 v5, s[12:15], s26 offen lds
    s_add_u32 s26, s26, 32768
    s_mov_b32 m0, s35
    s_add_u32 s35, s35, 1024
    buffer_load_dwordx4 v4, s[12:15], s26 offen lds
    s_add_u32 s26, s26, 32768
    s_mov_b32 m0, s35
    s_add_u32 s35, s35, 1024
    buffer_load_dwordx4 v4, s[12:15], s26 offen lds
    s_add_u32 s26, s26, 32768
    s_mov_b32 m0, s35
    s_add_u32 s35, s35, 1024
    buffer_load_dwordx4 v5, s[12:15], s26 offen lds
    s_add_u32 s26, s26, 32768
    s_mov_b32 m0, s35
    s_add_u32 s35, s35, 1024
    buffer_load_dwordx4 v5, s[12:15], s26 offen lds
    s_add_u32 s26, s26, 32768
    v_bfe_u32 v6, v255, 2, 2
    v_and_b32 v7, 1, v2
    v_lshl_add_u32 v7, v7, 2, v6
    v_lshlrev_b32 v7, 1, v7
    v_bfe_u32 v8, v255, 1, 1
    s_lshl_b32 s26, s22, 2
    v_add_u32 v8, s26, v8
    v_xor_b32 v8, v8, v7
    v_lshlrev_b32 v8, 4, v8
    v_lshl_add_u32 v9, v2, 3, v6
    v_lshl_add_u32 v8, v9, 8, v8
    v_and_b32 v9, 1, v255
    v_lshl_add_u32 v8, v9, 3, v8
    v_xor_b32 v9, 32, v8
    buffer_load_dword v10, off, s[16:19], 0 offset:96 sc1
    s_mul_i32 s27, s25, 96
    s_add_u32 s27, s27, s24
    v_lshl_add_u32 v15, v255, 5, s27
    v_lshlrev_b32 v15, 7, v15
    v_add_u32 v15, 90177536, v15
    s_mov_b32 s33, 1
    s_mov_b64 exec, 7
    s_mov_b32 s26, 0
L_pqm:
    buffer_load_dword v11, v15, s[8:11], 0 offen sc1
    s_add_u32 s26, s26, 1
    s_cmp_gt_u32 s26, 262144
    s_cbranch_scc1 L_fin
    s_waitcnt vmcnt(0)
    v_cmp_gt_i32 vcc, s33, v11
    s_cbranch_vccz L_pqm_ok
    s_sleep 2
    s_branch L_pqm
L_pqm_ok:
    s_mov_b64 exec, -1
    v_readlane_b32 s60, v11, 1
    v_readlane_b32 s26, v11, 2
    s_min_u32 s60, s60, s26
    v_readfirstlane_b32 s26, v10
    s_lshr_b32 s26, s26, 16
    s_cmp_gt_u32 s26, 32
    s_cselect_b32 s52, 8192, 0
    s_add_u32 s52, s52, 83886080
    s_barrier
    ds_read_b64_tr_b16 a[160:161], v8 offset:0
    ds_read_b64_tr_b16 a[162:163], v8 offset:1024
    ds_read_b64_tr_b16 a[164:165], v9 offset:0
    ds_read_b64_tr_b16 a[166:167], v9 offset:1024
    ds_read_b64_tr_b16 a[168:169], v8 offset:8192
    ds_read_b64_tr_b16 a[170:171], v8 offset:9216
    ds_read_b64_tr_b16 a[172:173], v9 offset:8192
    ds_read_b64_tr_b16 a[174:175], v9 offset:9216
    ds_read_b64_tr_b16 a[176:177], v8 offset:16384
    ds_read_b64_tr_b16 a[178:179], v8 offset:17408
    ds_read_b64_tr_b16 a[180:181], v9 offset:16384
    ds_read_b64_tr_b16 a[182:183], v9 offset:17408
    ds_read_b64_tr_b16 a[184:185], v8 offset:24576
    ds_read_b64_tr_b16 a[186:187], v8 offset:25600
    ds_read_b64_tr_b16 a[188:189], v9 offset:24576
    ds_read_b64_tr_b16 a[190:191], v9 offset:25600
    ds_read_b64_tr_b16 a[192:193], v8 offset:32768
    ds_read_b64_tr_b16 a[194:195], v8 offset:33792
    ds_read_b64_tr_b16 a[196:197], v9 offset:32768
    ds_read_b64_tr_b16 a[198:199], v9 offset:33792
    ds_read_b64_tr_b16 a[200:201], v8 offset:40960
    ds_read_b64_tr_b16 a[202:203], v8 offset:41984
    ds_read_b64_tr_b16 a[204:205], v9 offset:40960
    ds_read_b64_tr_b16 a[206:207], v9 offset:41984
    ds_read_b64_tr_b16 a[208:209], v8 offset:49152
    ds_read_b64_tr_b16 a[210:211], v8 offset:50176
    ds_read_b64_tr_b16 a[212:213], v9 offset:49152
    ds_read_b64_tr_b16 a[214:215], v9 offset:50176
    ds_read_b64_tr_b16 a[216:217], v8 offset:57344
    ds_read_b64_tr_b16 a[218:219], v8 offset:58368
    ds_read_b64_tr_b16 a[220:221], v9 offset:57344
    ds_read_b64_tr_b16 a[222:223], v9 offset:58368
    v_add_u32 v8, 0x10000, v8
    v_add_u32 v9, 0x10000, v9
    ds_read_b64_tr_b16 a[224:225], v8 offset:0
    ds_read_b64_tr_b16 a[226:227], v8 offset:1024
    ds_read_b64_tr_b16 a[228:229], v9 offset:0
    ds_read_b64_tr_b16 a[230:231], v9 offset:1024
    ds_read_b64_tr_b16 a[232:233], v8 offset:8192
    ds_read_b64_tr_b16 a[234:235], v8 offset:9216
    ds_read_b64_tr_b16 a[236:237], v9 offset:8192
    ds_read_b64_tr_b16 a[238:239], v9 offset:9216
    ds_read_b64_tr_b16 a[240:241], v8 offset:16384
    ds_read_b64_tr_b16 a[242:243], v8 offset:17408
    ds_read_b64_tr_b16 a[244:245], v9 offset:16384
    ds_read_b64_tr_b16 a[246:247], v9 offset:17408
    ds_read_b64_tr_b16 a[248:249], v8 offset:24576
    ds_read_b64_tr_b16 a[250:251], v8 offset:25600
    ds_read_b64_tr_b16 a[252:253], v9 offset:24576
    ds_read_b64_tr_b16 a[254:255], v9 offset:25600
    ds_read_b64_tr_b16 v[176:177], v8 offset:32768
    ds_read_b64_tr_b16 v[178:179], v8 offset:33792
    ds_read_b64_tr_b16 v[180:181], v9 offset:32768
    ds_read_b64_tr_b16 v[182:183], v9 offset:33792
    ds_read_b64_tr_b16 v[184:185], v8 offset:40960
    ds_read_b64_tr_b16 v[186:187], v8 offset:41984
    ds_read_b64_tr_b16 v[188:189], v9 offset:40960
    ds_read_b64_tr_b16 v[190:191], v9 offset:41984
    ds_read_b64_tr_b16 v[192:193], v8 offset:49152
    ds_read_b64_tr_b16 v[194:195], v8 offset:50176
    ds_read_b64_tr_b16 v[196:197], v9 offset:49152
    ds_read_b64_tr_b16 v[198:199], v9 offset:50176
    ds_read_b64_tr_b16 v[200:201], v8 offset:57344
    ds_read_b64_tr_b16 v[202:203], v8 offset:58368
    ds_read_b64_tr_b16 v[204:205], v9 offset:57344
    ds_read_b64_tr_b16 v[206:207], v9 offset:58368
    v_add_u32 v8, 0x10000, v8
    v_add_u32 v9, 0x10000, v9
    ds_read_b64_tr_b16 v[208:209], v8 offset:0
    ds_read_b64_tr_b16 v[210:211], v8 offset:1024
    ds_read_b64_tr_b16 v[212:213], v9 offset:0
    ds_read_b64_tr_b16 v[214:215], v9 offset:1024
    ds_read_b64_tr_b16 v[216:217], v8 offset:8192
    ds_read_b64_tr_b16 v[218:219], v8 offset:9216
    ds_read_b64_tr_b16 v[220:221], v9 offset:8192
    ds_read_b64_tr_b16 v[222:223], v9 offset:9216
    ds_read_b64_tr_b16 v[224:225], v8 offset:16384
    ds_read_b64_tr_b16 v[226:227], v8 offset:17408
    ds_read_b64_tr_b16 v[228:229], v9 offset:16384
    ds_read_b64_tr_b16 v[230:231], v9 offset:17408
    ds_read_b64_tr_b16 v[232:233], v8 offset:24576
    ds_read_b64_tr_b16 v[234:235], v8 offset:25600
    ds_read_b64_tr_b16 v[236:237], v9 offset:24576
    ds_read_b64_tr_b16 v[238:239], v9 offset:25600
    v_lshlrev_b32 v0, 4, v255
    v_lshlrev_b32 v3, 2, v2
    s_lshl_b32 s26, s53, 4
    v_add_u32 v10, s26, v1
    v_add_u32 v4, 0, v3
    v_cmp_le_u32 s[36:37], v4, v10
    v_add_u32 v4, 1, v3
    v_cmp_le_u32 s[38:39], v4, v10
    v_add_u32 v4, 2, v3
    v_cmp_le_u32 s[40:41], v4, v10
    v_add_u32 v4, 3, v3
    v_cmp_le_u32 s[42:43], v4, v10
    v_add_u32 v4, 16, v3
    v_cmp_le_u32 s[44:45], v4, v10
    v_add_u32 v4, 17, v3
    v_cmp_le_u32 s[46:47], v4, v10
    v_add_u32 v4, 18, v3
    v_cmp_le_u32 s[48:49], v4, v10
    v_add_u32 v4, 19, v3
    v_cmp_le_u32 s[50:51], v4, v10
    v_mov_b32 v5, 0xd028965f
    s_mov_b32 s32, 0x3e0293ee
    v_and_b32 v3, 13, v1
    v_lshlrev_b32 v3, 4, v3
    v_and_b32 v4, 1, v2
    v_lshrrev_b32 v10, 1, v2
    v_lshl_add_u32 v6, v4, 8, v3
    v_lshl_add_u32 v6, v10, 5, v6
    v_lshl_add_u32 v7, v10, 8, v3
    v_lshl_add_u32 v7, v4, 5, v7
    s_lshl_b32 s26, s22, 10
    v_add_u32 v3, s26, v0
    v_lshrrev_b32 v4, 2, v3
    v_lshrrev_b32 v12, 1, v3
    s_lshl_b32 s26, s54, 10
    v_lshrrev_b32 v13, 1, v0
    v_add_u32 v13, s26, v13
    v_mov_b32 v112, 0
    v_mov_b32 v113, 0
    v_mov_b32 v114, 0
    v_mov_b32 v115, 0
    v_mov_b32 v116, 0
    v_mov_b32 v117, 0
    v_mov_b32 v118, 0
    v_mov_b32 v119, 0
    v_mov_b32 v120, 0
    v_mov_b32 v121, 0
    v_mov_b32 v122, 0
    v_mov_b32 v123, 0
    s_lshl_b32 s34, s25, 5
    s_add_u32 s34, s34, s24
    s_lshl_b32 s34, s34, 7
    s_add_u32 s34, s34, 90218496
    s_lshl_b32 s55, s25, 5
    s_add_u32 s55, s55, s24
    s_lshl_b32 s55, s55, 7
    s_add_u32 s55, s55, 6316032
    s_add_u32 s55, s55, s52
    s_waitcnt lgkmcnt(0)
    s_mov_b32 s56, s25
    s_mov_b32 s57, 0
    v_mov_b32 v14, 0
    s_mul_i32 s28, s56, 540672
    s_lshl_b32 s26, s24, 14
    s_add_u32 s28, s28, s26
    s_lshl_b32 s26, s56, 5
    s_add_u32 s26, s26, s24
    s_lshl_b32 s58, s26, 13
    s_lshl_b32 s26, s53, 10
    s_add_u32 s58, s58, s26
    s_add_u32 s58, s58, 37748736
    s_lshl_b32 s59, s54, 13
    s_add_u32 s59, s59, s28
    buffer_load_dwordx4 v[32:35], v0, s[8:11], s28 offen offset:0 sc1
    buffer_load_dwordx4 v[36:39], v0, s[8:11], s28 offen offset:1024 sc1
    s_add_u32 s28, s28, 4096
    buffer_load_dwordx4 v[40:43], v0, s[8:11], s28 offen offset:0 sc1
    buffer_load_dwordx4 v[44:47], v0, s[8:11], s28 offen offset:1024 sc1
    s_add_u32 s28, s28, 4096
    buffer_load_dwordx4 v[48:51], v0, s[8:11], s28 offen offset:0 sc1
    buffer_load_dwordx4 v[52:55], v0, s[8:11], s28 offen offset:1024 sc1
    s_add_u32 s28, s28, 4096
    buffer_load_dwordx4 v[56:59], v0, s[8:11], s28 offen offset:0 sc1
    buffer_load_dwordx4 v[60:63], v0, s[8:11], s28 offen offset:1024 sc1
    s_add_u32 s28, s28, 4096
    buffer_load_dwordx4 v[16:19], v0, s[8:11], s58 offen offset:0 sc1
    buffer_load_dwordx4 v[20:23], v0, s[8:11], s58 offen offset:2048 sc1
    s_add_u32 s58, s58, 4096
    buffer_load_dwordx4 v[24:27], v0, s[8:11], s58 offen offset:0 sc1
    buffer_load_dwordx4 v[28:31], v0, s[8:11], s58 offen offset:2048 sc1
    buffer_load_dwordx4 v[64:67], v0, s[8:11], s59 offen offset:2048 sc1
    buffer_load_dwordx4 v[68:71], v0, s[8:11], s59 offen offset:3072 sc1
    s_add_u32 s59, s59, 4096
    buffer_load_dwordx4 v[72:75], v0, s[8:11], s59 offen offset:2048 sc1
    buffer_load_dwordx4 v[76:79], v0, s[8:11], s59 offen offset:3072 sc1
L_loopm:
    s_lshl_b32 s31, s25, 1
    s_add_u32 s31, s31, s53
    s_lshl_b32 s31, s31, 5
    s_add_u32 s31, s31, s24
    s_lshl_b32 s31, s31, 1
    s_add_u32 s31, s31, s54
    s_lshl_b32 s31, s31, 11
    s_add_u32 s31, s31, 67108864
    s_lshl_b32 s30, s25, 14
    s_add_u32 s30, s30, s52
    s_add_u32 s56, s25, 2
    s_cmp_lt_u32 s56, 64
    s_cselect_b32 s56, s56, s25
    s_mul_i32 s28, s56, 540672
    s_lshl_b32 s26, s24, 14
    s_add_u32 s28, s28, s26
    s_lshl_b32 s26, s56, 5
    s_add_u32 s26, s26, s24
    s_lshl_b32 s58, s26, 13
    s_lshl_b32 s26, s53, 10
    s_add_u32 s58, s58, s26
    s_add_u32 s58, s58, 37748736
    s_lshl_b32 s59, s54, 13
    s_add_u32 s59, s59, s28
    s_lshr_b32 s33, s56, 1
    s_add_u32 s33, s33, 1
    s_cmp_ge_u32 s60, s33
    s_cbranch_scc1 L_qokm
    s_mov_b64 exec, 7
    s_mov_b32 s26, 0
L_pq2m:
    buffer_load_dword v11, v15, s[8:11], 0 offen sc1
    s_add_u32 s26, s26, 1
    s_cmp_gt_u32 s26, 262144
    s_cbranch_scc1 L_fin
    s_waitcnt vmcnt(0)
    v_cmp_gt_i32 vcc, s33, v11
    s_cbranch_vccz L_pq2m_ok
    s_sleep 2
    s_branch L_pq2m
L_pq2m_ok:
    s_mov_b64 exec, -1
    v_readlane_b32 s60, v11, 1
    v_readlane_b32 s26, v11, 2
    s_min_u32 s60, s60, s26
L_qokm:
    s_cmp_lt_u32 s25, 58
    s_addc_u32 s33, s25, 0
    s_cmp_gt_u32 s57, s25
    s_cbranch_scc1 L_gom
    buffer_load_dword v10, off, s[8:11], s55 sc1
    s_waitcnt vmcnt(0)
    s_cmp_lg_u32 s22, 0
    s_cbranch_scc1 L_s1m
    s_mov_b64 exec, 1
    ds_write_b32 v14, v10 offset:16384
    s_mov_b64 exec, -1
    s_waitcnt lgkmcnt(0)
L_s1m:
    s_barrier
    ds_read_b32 v10, v14 offset:16384
    s_waitcnt lgkmcnt(0)
    v_readfirstlane_b32 s57, v10
    s_cmp_gt_u32 s57, s25
    s_cbranch_scc1 L_gom
    s_cmp_lg_u32 s22, 0
    s_cbranch_scc1 L_f1m
    s_lshr_b32 s26, s25, 1
    v_mov_b32 v10, s26
    v_lshlrev_b32 v11, 13, v255
    s_mov_b64 exec, 15
    buffer_store_dword v10, v11, s[8:11], s34 offen sc1
    s_mov_b64 exec, -1
L_f1m:
    s_cmp_lt_u32 s57, s33
    s_cbranch_scc1 L_wtm
    s_sleep 10
    s_branch L_gom
L_wtm:
    s_barrier
    s_cmp_lg_u32 s22, 0
    s_cbranch_scc1 L_s2m
    s_mov_b64 exec, 1
    s_mov_b32 s26, 0
L_pmm:
    buffer_load_dword v10, off, s[8:11], s55 sc1
    s_add_u32 s26, s26, 1
    s_cmp_gt_u32 s26, 262144
    s_cbranch_scc1 L_fin
    s_waitcnt vmcnt(0)
    v_cmp_gt_i32 vcc, s33, v10
    s_cbranch_vccz L_pmm_ok
    s_sleep 2
    s_branch L_pmm
L_pmm_ok:
    s_mov_b64 exec, -1
    s_cmp_lt_u32 s25, 58
    s_cbranch_scc1 L_nbm
    s_sleep 14
L_nbm:
    s_cmp_lg_u32 s22, 0
    s_cbranch_scc1 L_s2m
    s_mov_b64 exec, 1
    ds_write_b32 v14, v10 offset:16384
    s_mov_b64 exec, -1
    s_waitcnt lgkmcnt(0)
L_s2m:
    s_barrier
    ds_read_b32 v10, v14 offset:16384
    s_waitcnt lgkmcnt(0)
    v_readfirstlane_b32 s57, v10
L_gom:
    s_add_u32 s26, s30, 0x100000
    s_add_u32 s27, s30, 4096
    s_add_u32 s29, s26, 4096
    s_mov_b32 s33, 0
    buffer_load_dwordx4 v[144:147], v3, s[8:11], s30 offen sc1
    buffer_load_dwordx4 v[148:151], v3, s[8:11], s26 offen sc1
    buffer_load_dword v152, v4, s[8:11], s27 offen sc1
    buffer_load_dword v153, v4, s[8:11], s29 offen sc1
    s_waitcnt vmcnt(8)
    v_mfma_f32_16x16x32_bf16 v[104:107], v[32:35], v[16:19], 0
    v_mfma_f32_16x16x32_bf16 v[108:111], v[36:39], v[16:19], 0
    v_mfma_f32_16x16x32_bf16 v[104:107], v[40:43], v[20:23], v[104:107]
    v_mfma_f32_16x16x32_bf16 v[108:111], v[44:47], v[20:23], v[108:111]
    v_mfma_f32_16x16x32_bf16 v[104:107], v[48:51], v[24:27], v[104:107]
    v_mfma_f32_16x16x32_bf16 v[108:111], v[52:55], v[24:27], v[108:111]
    v_mfma_f32_16x16x32_bf16 v[104:107], v[56:59], v[28:31], v[104:107]
    v_mfma_f32_16x16x32_bf16 v[108:111], v[60:63], v[28:31], v[108:111]
L_ckm:
    s_waitcnt vmcnt(0)
    v_max3_u32 v10, v144, v145, v146
    v_max3_u32 v10, v10, v147, v148
    v_max3_u32 v10, v10, v149, v150
    v_max3_u32 v10, v10, v151, v152
    v_max_u32 v10, v10, v153
    v_cmp_eq_u32 vcc, -1, v10
    s_cbranch_vccz L_okmm
    buffer_load_dwordx4 v[144:147], v3, s[8:11], s30 offen sc1
    buffer_load_dwordx4 v[148:151], v3, s[8:11], s26 offen sc1
    buffer_load_dword v152, v4, s[8:11], s27 offen sc1
    buffer_load_dword v153, v4, s[8:11], s29 offen sc1
    s_add_u32 s33, s33, 1
    s_cmp_gt_u32 s33, 262144
    s_cbranch_scc1 L_fin
    s_branch L_ckm
L_okmm:
    ds_write_b128 v3, v[144:147]
    ds_write_b128 v3, v[148:151] offset:5120
    ds_write_b32 v4, v152 offset:4096
    ds_write_b32 v4, v153 offset:9216
    v_cndmask_b32 v104, v5, v104, s[36:37]
    v_cndmask_b32 v105, v5, v105, s[38:39]
    v_cndmask_b32 v106, v5, v106, s[40:41]
    v_cndmask_b32 v107, v5, v107, s[42:43]
    v_cndmask_b32 v108, v5, v108, s[44:45]
    v_cndmask_b32 v109, v5, v109, s[46:47]
    v_cndmask_b32 v110, v5, v110, s[48:49]
    v_cndmask_b32 v111, v5, v111, s[50:51]
    s_waitcnt lgkmcnt(0)
    s_barrier
    ds_read_b128 v[144:147], v6 offset:0
    ds_read_b128 v[148:151], v6 offset:512
    ds_read_b128 v[152:155], v6 offset:1024
    s_cmp_lg_u32 s22, 0
    s_cbranch_scc1 L_f2m
    s_lshr_b32 s26, s25, 1
    v_mov_b32 v10, s26
    v_lshlrev_b32 v11, 13, v255
    s_mov_b64 exec, 15
    buffer_store_dword v10, v11, s[8:11], s34 offen sc1
    s_mov_b64 exec, -1
L_f2m:
    s_waitcnt lgkmcnt(2)
    v_mfma_f32_16x16x32_bf16 v[160:163], a[0:3], v[144:147], 0
    ds_read_b128 v[156:159], v6 offset:1536
    v_mfma_f32_16x16x32_bf16 v[164:167], a[4:7], v[144:147], 0
    v_mfma_f32_16x16x32_bf16 v[168:171], v[144:147], a[160:163], 0
    buffer_load_dwordx4 v[32:35], v0, s[8:11], s28 offen offset:0 sc1
    v_mfma_f32_16x16x32_bf16 v[172:175], v[144:147], a[164:167], 0
    s_waitcnt lgkmcnt(2)
    v_mfma_f32_16x16x32_bf16 v[160:163], a[8:11], v[148:151], v[160:163]
    ds_read_b128 v[144:147], v6 offset:2048
    v_mfma_f32_16x16x32_bf16 v[164:167], a[12:15], v[148:151], v[164:167]
    v_mfma_f32_16x16x32_bf16 v[168:171], v[148:151], a[168:171], v[168:171]
    v_mfma_f32_16x16x32_bf16 v[172:175], v[148:151], a[172:175], v[172:175]
    s_waitcnt lgkmcnt(2)
    v_mfma_f32_16x16x32_bf16 v[160:163], a[16:19], v[152:155], v[160:163]
    ds_read_b128 v[148:151], v6 offset:2560
    v_mfma_f32_16x16x32_bf16 v[164:167], a[20:23], v[152:155], v[164:167]
    v_mfma_f32_16x16x32_bf16 v[168:171], v[152:155], a[176:179], v[168:171]
    buffer_load_dwordx4 v[36:39], v0, s[8:11], s28 offen offset:1024 sc1
    s_add_u32 s28, s28, 4096
    v_mfma_f32_16x16x32_bf16 v[172:175], v[152:155], a[180:183], v[172:175]
    s_waitcnt lgkmcnt(2)
    v_mfma_f32_16x16x32_bf16 v[160:163], a[24:27], v[156:159], v[160:163]
    ds_read_b128 v[152:155], v6 offset:3072
    v_mfma_f32_16x16x32_bf16 v[164:167], a[28:31], v[156:159], v[164:167]
    v_mfma_f32_16x16x32_bf16 v[168:171], v[156:159], a[184:187], v[168:171]
    v_mfma_f32_16x16x32_bf16 v[172:175], v[156:159], a[188:191], v[172:175]
    s_waitcnt lgkmcnt(2)
    v_mfma_f32_16x16x32_bf16 v[160:163], a[32:35], v[144:147], v[160:163]
    ds_read_b128 v[156:159], v6 offset:3584
    v_mfma_f32_16x16x32_bf16 v[164:167], a[36:39], v[144:147], v[164:167]
    v_mfma_f32_16x16x32_bf16 v[168:171], v[144:147], a[192:195], v[168:171]
    buffer_load_dwordx4 v[40:43], v0, s[8:11], s28 offen offset:0 sc1
    v_mfma_f32_16x16x32_bf16 v[172:175], v[144:147], a[196:199], v[172:175]
    s_waitcnt lgkmcnt(2)
    v_mfma_f32_16x16x32_bf16 v[160:163], a[40:43], v[148:151], v[160:163]
    ds_read_b128 v[144:147], v7 offset:4096
    v_mfma_f32_16x16x32_bf16 v[164:167], a[44:47], v[148:151], v[164:167]
    v_mfma_f32_16x16x32_bf16 v[168:171], v[148:151], a[200:203], v[168:171]
    v_mfma_f32_16x16x32_bf16 v[172:175], v[148:151], a[204:207], v[172:175]
    s_waitcnt lgkmcnt(2)
    v_mfma_f32_16x16x32_bf16 v[160:163], a[48:51], v[152:155], v[160:163]
    ds_read_b128 v[148:151], v7 offset:4608
    v_mfma_f32_16x16x32_bf16 v[164:167], a[52:55], v[152:155], v[164:167]
    v_mfma_f32_16x16x32_bf16 v[168:171], v[152:155], a[208:211], v[168:171]
    buffer_load_dwordx4 v[44:47], v0, s[8:11], s28 offen offset:1024 sc1
    s_add_u32 s28, s28, 4096
    v_mfma_f32_16x16x32_bf16 v[172:175], v[152:155], a[212:215], v[172:175]
    s_waitcnt lgkmcnt(2)
    v_mfma_f32_16x16x32_bf16 v[160:163], a[56:59], v[156:159], v[160:163]
    ds_read_b128 v[152:155], v6 offset:5120
    v_mfma_f32_16x16x32_bf16 v[164:167], a[60:63], v[156:159], v[164:167]
    v_mfma_f32_16x16x32_bf16 v[168:171], v[156:159], a[216:219], v[168:171]
    v_mfma_f32_16x16x32_bf16 v[172:175], v[156:159], a[220:223], v[172:175]
    s_waitcnt lgkmcnt(2)
    v_mfma_f32_16x16x32_bf16 v[160:163], a[64:67], v[144:147], v[160:163]
    ds_read_b128 v[156:159], v6 offset:5632
    v_mfma_f32_16x16x32_bf16 v[164:167], a[68:71], v[144:147], v[164:167]
    v_mfma_f32_16x16x32_bf16 v[168:171], v[144:147], a[224:227], v[168:171]
    buffer_load_dwordx4 v[48:51], v0, s[8:11], s28 offen offset:0 sc1
    v_mfma_f32_16x16x32_bf16 v[172:175], v[144:147], a[228:231], v[172:175]
    s_waitcnt lgkmcnt(2)
    v_mfma_f32_16x16x32_bf16 v[160:163], a[72:75], v[148:151], v[160:163]
    ds_read_b128 v[144:147], v6 offset:6144
    v_mfma_f32_16x16x32_bf16 v[164:167], a[76:79], v[148:151], v[164:167]
    v_mfma_f32_16x16x32_bf16 v[168:171], v[148:151], a[232:235], v[168:171]
    v_mfma_f32_16x16x32_bf16 v[172:175], v[148:151], a[236:239], v[172:175]
    s_waitcnt lgkmcnt(2)
    v_mfma_f32_16x16x32_bf16 v[160:163], a[80:83], v[152:155], v[160:163]
    ds_read_b128 v[148:151], v6 offset:6656
    v_mfma_f32_16x16x32_bf16 v[164:167], a[84:87], v[152:155], v[164:167]
    v_mfma_f32_16x16x32_bf16 v[168:171], v[152:155], a[240:243], v[168:171]
    buffer_load_dwordx4 v[52:55], v0, s[8:11], s28 offen offset:1024 sc1
    s_add_u32 s28, s28, 4096
    v_mfma_f32_16x16x32_bf16 v[172:175], v[152:155], a[244:247], v[172:175]
    s_waitcnt lgkmcnt(2)
    v_mfma_f32_16x16x32_bf16 v[160:163], a[88:91], v[156:159], v[160:163]
    ds_read_b128 v[152:155], v6 offset:7168
    v_mfma_f32_16x16x32_bf16 v[164:167], a[92:95], v[156:159], v[164:167]
    v_mfma_f32_16x16x32_bf16 v[168:171], v[156:159], a[248:251], v[168:171]
    v_mfma_f32_16x16x32_bf16 v[172:175], v[156:159], a[252:255], v[172:175]
    s_waitcnt lgkmcnt(2)
    v_mfma_f32_16x16x32_bf16 v[160:163], a[96:99], v[144:147], v[160:163]
    ds_read_b128 v[156:159], v6 offset:7680
    v_mfma_f32_16x16x32_bf16 v[164:167], a[100:103], v[144:147], v[164:167]
    v_mfma_f32_16x16x32_bf16 v[168:171], v[144:147], v[176:179], v[168:171]
    buffer_load_dwordx4 v[56:59], v0, s[8:11], s28 offen offset:0 sc1
    v_mfma_f32_16x16x32_bf16 v[172:175], v[144:147], v[180:183], v[172:175]
    s_waitcnt lgkmcnt(2)
    v_mfma_f32_16x16x32_bf16 v[160:163], a[104:107], v[148:151], v[160:163]
    ds_read_b128 v[144:147], v6 offset:8192
    v_mfma_f32_16x16x32_bf16 v[164:167], a[108:111], v[148:151], v[164:167]
    v_mfma_f32_16x16x32_bf16 v[168:171], v[148:151], v[184:187], v[168:171]
    v_mfma_f32_16x16x32_bf16 v[172:175], v[148:151], v[188:191], v[172:175]
    s_waitcnt lgkmcnt(2)
    v_mfma_f32_16x16x32_bf16 v[160:163], a[112:115], v[152:155], v[160:163]
    ds_read_b128 v[148:151], v6 offset:8704
    v_mfma_f32_16x16x32_bf16 v[164:167], a[116:119], v[152:155], v[164:167]
    v_mfma_f32_16x16x32_bf16 v[168:171], v[152:155], v[192:195], v[168:171]
    buffer_load_dwordx4 v[60:63], v0, s[8:11], s28 offen offset:1024 sc1
    s_add_u32 s28, s28, 4096
    v_mfma_f32_16x16x32_bf16 v[172:175], v[152:155], v[196:199], v[172:175]
    s_waitcnt lgkmcnt(2)
    v_mfma_f32_16x16x32_bf16 v[160:163], a[120:123], v[156:159], v[160:163]
    ds_read_b128 v[152:155], v7 offset:9216
    v_mfma_f32_16x16x32_bf16 v[164:167], a[124:127], v[156:159], v[164:167]
    v_mfma_f32_16x16x32_bf16 v[168:171], v[156:159], v[200:203], v[168:171]
    v_mfma_f32_16x16x32_bf16 v[172:175], v[156:159], v[204:207], v[172:175]
    s_waitcnt lgkmcnt(2)
    v_mfma_f32_16x16x32_bf16 v[160:163], a[128:131], v[144:147], v[160:163]
    ds_read_b128 v[156:159], v7 offset:9728
    v_mfma_f32_16x16x32_bf16 v[164:167], a[132:135], v[144:147], v[164:167]
    v_mfma_f32_16x16x32_bf16 v[168:171], v[144:147], v[208:211], v[168:171]
    v_mfma_f32_16x16x32_bf16 v[172:175], v[144:147], v[212:215], v[172:175]
    s_waitcnt lgkmcnt(2)
    v_mfma_f32_16x16x32_bf16 v[160:163], a[136:139], v[148:151], v[160:163]
    v_mfma_f32_16x16x32_bf16 v[164:167], a[140:143], v[148:151], v[164:167]
    v_mfma_f32_16x16x32_bf16 v[168:171], v[148:151], v[216:219], v[168:171]
    v_mfma_f32_16x16x32_bf16 v[172:175], v[148:151], v[220:223], v[172:175]
    s_waitcnt lgkmcnt(1)
    v_mfma_f32_16x16x32_bf16 v[160:163], a[144:147], v[152:155], v[160:163]
    v_mfma_f32_16x16x32_bf16 v[164:167], a[148:151], v[152:155], v[164:167]
    v_mfma_f32_16x16x32_bf16 v[168:171], v[152:155], v[224:227], v[168:171]
    v_mfma_f32_16x16x32_bf16 v[172:175], v[152:155], v[228:231], v[172:175]
    s_waitcnt lgkmcnt(0)
    v_mfma_f32_16x16x32_bf16 v[160:163], a[152:155], v[156:159], v[160:163]
    v_mfma_f32_16x16x32_bf16 v[164:167], a[156:159], v[156:159], v[164:167]
    v_mfma_f32_16x16x32_bf16 v[168:171], v[156:159], v[232:235], v[168:171]
    v_mfma_f32_16x16x32_bf16 v[172:175], v[156:159], v[236:239], v[172:175]
    s_nop 4
    v_cvt_pk_bf16_f32 v80, v160, v161
    v_cvt_pk_bf16_f32 v81, v162, v163
    v_cvt_pk_bf16_f32 v82, v164, v165
    v_cvt_pk_bf16_f32 v83, v166, v167
    ds_write_b128 v3, v[80:83] offset:10240
    v_cvt_pk_bf16_f32 v96, v168, v169
    v_cvt_pk_bf16_f32 v97, v172, v173
    ds_write_b64 v12, v[96:97] offset:14336
    s_waitcnt lgkmcnt(0)
    s_barrier
    ds_read_b128 v[80:83], v0 offset:10240
    ds_read_b128 v[84:87], v0 offset:11264
    ds_read_b128 v[88:91], v0 offset:12288
    ds_read_b128 v[92:95], v0 offset:13312
    ds_read_b64 v[96:97], v13 offset:14336
    ds_read_b64 v[98:99], v13 offset:14848
    s_waitcnt lgkmcnt(5)
    v_mfma_f32_16x16x32_bf16 v[100:103], v[80:83], v[16:19], 0
    s_waitcnt lgkmcnt(4)
    v_mfma_f32_16x16x32_bf16 v[100:103], v[84:87], v[20:23], v[100:103]
    s_waitcnt lgkmcnt(3)
    v_mfma_f32_16x16x32_bf16 v[100:103], v[88:91], v[24:27], v[100:103]
    s_waitcnt lgkmcnt(2)
    v_mfma_f32_16x16x32_bf16 v[100:103], v[92:95], v[28:31], v[100:103]
    buffer_load_dwordx4 v[16:19], v0, s[8:11], s58 offen offset:0 sc1
    buffer_load_dwordx4 v[20:23], v0, s[8:11], s58 offen offset:2048 sc1
    s_add_u32 s58, s58, 4096
    buffer_load_dwordx4 v[24:27], v0, s[8:11], s58 offen offset:0 sc1
    buffer_load_dwordx4 v[28:31], v0, s[8:11], s58 offen offset:2048 sc1
    v_max_f32 v10, v104, v105
    v_max3_f32 v10, v10, v106, v107
    v_max3_f32 v10, v10, v108, v109
    v_max3_f32 v10, v10, v110, v111
    s_nop 3
    v_max3_f32 v10, v10, v100, v101
    v_mov_b32 v11, v10
    s_nop 1
    v_permlane16_swap_b32 v10, v11
    v_max_f32 v10, v10, v11
    v_mov_b32 v11, v10
    s_nop 1
    v_permlane32_swap_b32 v10, v11
    v_max_f32 v10, v10, v11
    v_mul_f32 v10, s32, v10
    v_fma_f32 v104, v104, s32, -v10
    v_fma_f32 v105, v105, s32, -v10
    v_fma_f32 v106, v106, s32, -v10
    v_fma_f32 v107, v107, s32, -v10
    v_fma_f32 v108, v108, s32, -v10
    v_fma_f32 v109, v109, s32, -v10
    v_fma_f32 v110, v110, s32, -v10
    v_fma_f32 v111, v111, s32, -v10
    v_fma_f32 v100, v100, s32, -v10
    v_fma_f32 v101, v101, s32, -v10
    v_exp_f32 v104, v104
    v_exp_f32 v105, v105
    v_exp_f32 v106, v106
    v_exp_f32 v107, v107
    v_exp_f32 v108, v108
    v_exp_f32 v109, v109
    v_exp_f32 v110, v110
    v_exp_f32 v111, v111
    v_exp_f32 v100, v100
    v_exp_f32 v101, v101
    v_add_f32 v10, v104, v105
    v_add_f32 v10, v10, v106
    v_add_f32 v10, v10, v107
    v_add_f32 v10, v10, v108
    v_add_f32 v10, v10, v109
    v_add_f32 v10, v10, v110
    v_add_f32 v10, v10, v111
    v_add_f32 v10, v10, v100
    v_add_f32 v10, v10, v101
    v_mov_b32 v11, v10
    s_nop 1
    v_permlane16_swap_b32 v10, v11
    v_add_f32 v10, v10, v11
    v_mov_b32 v11, v10
    s_nop 1
    v_permlane32_swap_b32 v10, v11
    v_add_f32 v10, v10, v11
    v_rcp_f32 v10, v10
    s_nop 0
    v_pk_mul_f32 v[104:105], v[104:105], v[10:11] op_sel_hi:[1,0]
    v_pk_mul_f32 v[106:107], v[106:107], v[10:11] op_sel_hi:[1,0]
    v_pk_mul_f32 v[108:109], v[108:109], v[10:11] op_sel_hi:[1,0]
    v_pk_mul_f32 v[110:111], v[110:111], v[10:11] op_sel_hi:[1,0]
    v_pk_mul_f32 v[100:101], v[100:101], v[10:11] op_sel_hi:[1,0]
    v_cvt_pk_bf16_f32 v124, v104, v105
    v_cvt_pk_bf16_f32 v125, v106, v107
    v_cvt_pk_bf16_f32 v126, v108, v109
    v_cvt_pk_bf16_f32 v127, v110, v111
    v_cvt_pk_bf16_f32 v114, v100, v101
    v_cvt_pk_bf16_f32 v121, v100, v101
    s_waitcnt lgkmcnt(0)
    v_mfma_f32_16x16x32_bf16 v[128:131], v[64:67], v[124:127], 0
    v_mfma_f32_16x16x32_bf16 v[132:135], v[68:71], v[124:127], 0
    v_mfma_f32_16x16x32_bf16 v[136:139], v[72:75], v[124:127], 0
    v_mfma_f32_16x16x32_bf16 v[140:143], v[76:79], v[124:127], 0
    v_mfma_f32_16x16x32_bf16 v[128:131], v[96:99], v[114:117], v[128:131]
    v_mfma_f32_16x16x32_bf16 v[132:135], v[96:99], v[120:123], v[132:135]
    v_mfma_f32_16x16x32_bf16 v[136:139], v[96:99], v[112:115], v[136:139]
    v_mfma_f32_16x16x32_bf16 v[140:143], v[96:99], v[118:121], v[140:143]
    s_add_u32 s25, s25, 2
    s_nop 4
    v_cvt_pk_bf16_f32 v80, v128, v129
    v_cvt_pk_bf16_f32 v81, v130, v131
    v_cvt_pk_bf16_f32 v82, v132, v133
    v_cvt_pk_bf16_f32 v83, v134, v135
    buffer_store_dwordx4 v[80:83], v0, s[8:11], s31 offen offset:0 sc1
    v_cvt_pk_bf16_f32 v84, v136, v137
    v_cvt_pk_bf16_f32 v85, v138, v139
    v_cvt_pk_bf16_f32 v86, v140, v141
    v_cvt_pk_bf16_f32 v87, v142, v143
    buffer_store_dwordx4 v[84:87], v0, s[8:11], s31 offen offset:1024 sc1
    s_cmp_ge_u32 s25, 64
    s_cbranch_scc1 L_donem
    buffer_load_dwordx4 v[64:67], v0, s[8:11], s59 offen offset:2048 sc1
    buffer_load_dwordx4 v[68:71], v0, s[8:11], s59 offen offset:3072 sc1
    s_add_u32 s59, s59, 4096
    buffer_load_dwordx4 v[72:75], v0, s[8:11], s59 offen offset:2048 sc1
    buffer_load_dwordx4 v[76:79], v0, s[8:11], s59 offen offset:3072 sc1
    s_branch L_loopm
L_donem:
    s_barrier
    s_cmp_lg_u32 s22, 0
    s_cbranch_scc1 L_f4m
    s_lshr_b32 s26, s25, 1
    v_mov_b32 v10, s26
    v_lshlrev_b32 v11, 13, v255
    s_mov_b64 exec, 15
    buffer_store_dword v10, v11, s[8:11], s34 offen sc1
    s_mov_b64 exec, -1
L_f4m:
    s_add_u32 s25, s25, 2
    s_add_u32 s34, s34, 32768
    s_waitcnt vmcnt(0)
    s_barrier
    s_cmp_lg_u32 s22, 0
    s_cbranch_scc1 L_f3m
    s_lshr_b32 s26, s25, 1
    v_mov_b32 v10, s26
    v_lshlrev_b32 v11, 13, v255
    s_mov_b64 exec, 15
    buffer_store_dword v10, v11, s[8:11], s34 offen sc1
    s_mov_b64 exec, -1
L_f3m:
    s_branch L_fin
L_out:
    s_mul_i32 s24, s24, 20
    s_add_u32 s20, s24, s23
    s_mul_i32 s25, s20, 205
    s_lshr_b32 s25, s25, 12
    s_mul_i32 s26, s25, 20
    s_sub_u32 s24, s20, s26
    s_load_dwordx2 s[36:37], s[0:1], 40
    s_load_dwordx2 s[38:39], s[0:1], 128
    s_waitcnt lgkmcnt(0)
    s_mov_b32 s12, s36
    s_and_b32 s13, s37, 0xffff
    s_mov_b32 s14, 0x500000
    s_mov_b32 s15, 0x00020000
    v_lshrrev_b32 v1, 2, v255
    v_and_b32 v2, 3, v255
    v_mul_u32_u24 v3, 1280, v1
    v_lshl_add_u32 v3, v2, 4, v3
    s_mul_i32 s26, s22, 1310720
    s_lshl_b32 s27, s24, 6
    s_add_u32 s26, s26, s27
    s_lshl_b32 s27, s22, 15
    v_lshlrev_b32 v4, 4, v255
    v_add_u32 v4, s27, v4
    s_lshl_b32 s28, s22, 15
    s_mov_b32 s31, 0
L_ld0o:
    s_mov_b32 m0, s28
    s_add_u32 s28, s28, 1024
    buffer_load_dwordx4 v3, s[12:15], s26 offen lds
    s_add_u32 s26, s26, 20480
    s_cmp_ge_u32 s25, 2
    s_cbranch_scc1 L_nw0o
    s_waitcnt vmcnt(1)
L_nw0o:
    s_add_u32 s31, s31, 1
    s_cmp_lt_u32 s31, 32
    s_cbranch_scc1 L_ld0o
    s_waitcnt vmcnt(30)
    ds_read_b64_tr_b16 a[0:1], v4 offset:0
    ds_read_b64_tr_b16 a[2:3], v4 offset:1024
    ds_read_b64_tr_b16 a[4:5], v4 offset:8
    ds_read_b64_tr_b16 a[6:7], v4 offset:1032
    s_waitcnt vmcnt(28)
    ds_read_b64_tr_b16 a[8:9], v4 offset:2048
    ds_read_b64_tr_b16 a[10:11], v4 offset:3072
    ds_read_b64_tr_b16 a[12:13], v4 offset:2056
    ds_read_b64_tr_b16 a[14:15], v4 offset:3080
    s_waitcnt vmcnt(26)
    ds_read_b64_tr_b16 a[16:17], v4 offset:4096
    ds_read_b64_tr_b16 a[18:19], v4 offset:5120
    ds_read_b64_tr_b16 a[20:21], v4 offset:4104
    ds_read_b64_tr_b16 a[22:23], v4 offset:5128
    s_waitcnt vmcnt(24)
    ds_read_b64_tr_b16 a[24:25], v4 offset:6144
    ds_read_b64_tr_b16 a[26:27], v4 offset:7168
    ds_read_b64_tr_b16 a[28:29], v4 offset:6152
    ds_read_b64_tr_b16 a[30:31], v4 offset:7176
    s_waitcnt vmcnt(22)
    ds_read_b64_tr_b16 a[32:33], v4 offset:8192
    ds_read_b64_tr_b16 a[34:35], v4 offset:9216
    ds_read_b64_tr_b16 a[36:37], v4 offset:8200
    ds_read_b64_tr_b16 a[38:39], v4 offset:9224
    s_waitcnt vmcnt(20)
    ds_read_b64_tr_b16 a[40:41], v4 offset:10240
    ds_read_b64_tr_b16 a[42:43], v4 offset:11264
    ds_read_b64_tr_b16 a[44:45], v4 offset:10248
    ds_read_b64_tr_b16 a[46:47], v4 offset:11272
    s_waitcnt vmcnt(18)
    ds_read_b64_tr_b16 a[48:49], v4 offset:12288
    ds_read_b64_tr_b16 a[50:51], v4 offset:13312
    ds_read_b64_tr_b16 a[52:53], v4 offset:12296
    ds_read_b64_tr_b16 a[54:55], v4 offset:13320
    s_waitcnt vmcnt(16)
    ds_read_b64_tr_b16 a[56:57], v4 offset:14336
    ds_read_b64_tr_b16 a[58:59], v4 offset:15360
    ds_read_b64_tr_b16 a[60:61], v4 offset:14344
    ds_read_b64_tr_b16 a[62:63], v4 offset:15368
    s_waitcnt vmcnt(14)
    ds_read_b64_tr_b16 a[64:65], v4 offset:16384
    ds_read_b64_tr_b16 a[66:67], v4 offset:17408
    ds_read_b64_tr_b16 a[68:69], v4 offset:16392
    ds_read_b64_tr_b16 a[70:71], v4 offset:17416
    s_waitcnt vmcnt(12)
    ds_read_b64_tr_b16 a[72:73], v4 offset:18432
    ds_read_b64_tr_b16 a[74:75], v4 offset:19456
    ds_read_b64_tr_b16 a[76:77], v4 offset:18440
    ds_read_b64_tr_b16 a[78:79], v4 offset:19464
    s_waitcnt vmcnt(10)
    ds_read_b64_tr_b16 a[80:81], v4 offset:20480
    ds_read_b64_tr_b16 a[82:83], v4 offset:21504
    ds_read_b64_tr_b16 a[84:85], v4 offset:20488
    ds_read_b64_tr_b16 a[86:87], v4 offset:21512
    s_waitcnt vmcnt(8)
    ds_read_b64_tr_b16 a[88:89], v4 offset:22528
    ds_read_b64_tr_b16 a[90:91], v4 offset:23552
    ds_read_b64_tr_b16 a[92:93], v4 offset:22536
    ds_read_b64_tr_b16 a[94:95], v4 offset:23560
    s_waitcnt vmcnt(6)
    ds_read_b64_tr_b16 a[96:97], v4 offset:24576
    ds_read_b64_tr_b16 a[98:99], v4 offset:25600
    ds_read_b64_tr_b16 a[100:101], v4 offset:24584
    ds_read_b64_tr_b16 a[102:103], v4 offset:25608
    s_waitcnt vmcnt(4)
    ds_read_b64_tr_b16 a[104:105], v4 offset:26624
    ds_read_b64_tr_b16 a[106:107], v4 offset:27648
    ds_read_b64_tr_b16 a[108:109], v4 offset:26632
    ds_read_b64_tr_b16 a[110:111], v4 offset:27656
    s_waitcnt vmcnt(2)
    ds_read_b64_tr_b16 a[112:113], v4 offset:28672
    ds_read_b64_tr_b16 a[114:115], v4 offset:29696
    ds_read_b64_tr_b16 a[116:117], v4 offset:28680
    ds_read_b64_tr_b16 a[118:119], v4 offset:29704
    s_waitcnt vmcnt(0)
    ds_read_b64_tr_b16 a[120:121], v4 offset:30720
    ds_read_b64_tr_b16 a[122:123], v4 offset:31744
    ds_read_b64_tr_b16 a[124:125], v4 offset:30728
    ds_read_b64_tr_b16 a[126:127], v4 offset:31752
    s_waitcnt lgkmcnt(0)
    s_lshl_b32 s28, s22, 15
    s_mov_b32 s31, 0
L_ld1o:
    s_mov_b32 m0, s28
    s_add_u32 s28, s28, 1024
    buffer_load_dwordx4 v3, s[12:15], s26 offen lds
    s_add_u32 s26, s26, 20480
    s_cmp_ge_u32 s25, 2
    s_cbranch_scc1 L_nw1o
    s_waitcnt vmcnt(1)
L_nw1o:
    s_add_u32 s31, s31, 1
    s_cmp_lt_u32 s31, 32
    s_cbranch_scc1 L_ld1o
    s_waitcnt vmcnt(30)
    ds_read_b64_tr_b16 a[128:129], v4 offset:0
    ds_read_b64_tr_b16 a[130:131], v4 offset:1024
    ds_read_b64_tr_b16 a[132:133], v4 offset:8
    ds_read_b64_tr_b16 a[134:135], v4 offset:1032
    s_waitcnt vmcnt(28)
    ds_read_b64_tr_b16 a[136:137], v4 offset:2048
    ds_read_b64_tr_b16 a[138:139], v4 offset:3072
    ds_read_b64_tr_b16 a[140:141], v4 offset:2056
    ds_read_b64_tr_b16 a[142:143], v4 offset:3080
    s_waitcnt vmcnt(26)
    ds_read_b64_tr_b16 a[144:145], v4 offset:4096
    ds_read_b64_tr_b16 a[146:147], v4 offset:5120
    ds_read_b64_tr_b16 a[148:149], v4 offset:4104
    ds_read_b64_tr_b16 a[150:151], v4 offset:5128
    s_waitcnt vmcnt(24)
    ds_read_b64_tr_b16 a[152:153], v4 offset:6144
    ds_read_b64_tr_b16 a[154:155], v4 offset:7168
    ds_read_b64_tr_b16 a[156:157], v4 offset:6152
    ds_read_b64_tr_b16 a[158:159], v4 offset:7176
    s_waitcnt vmcnt(22)
    ds_read_b64_tr_b16 a[160:161], v4 offset:8192
    ds_read_b64_tr_b16 a[162:163], v4 offset:9216
    ds_read_b64_tr_b16 a[164:165], v4 offset:8200
    ds_read_b64_tr_b16 a[166:167], v4 offset:9224
    s_waitcnt vmcnt(20)
    ds_read_b64_tr_b16 a[168:169], v4 offset:10240
    ds_read_b64_tr_b16 a[170:171], v4 offset:11264
    ds_read_b64_tr_b16 a[172:173], v4 offset:10248
    ds_read_b64_tr_b16 a[174:175], v4 offset:11272
    s_waitcnt vmcnt(18)
    ds_read_b64_tr_b16 a[176:177], v4 offset:12288
    ds_read_b64_tr_b16 a[178:179], v4 offset:13312
    ds_read_b64_tr_b16 a[180:181], v4 offset:12296
    ds_read_b64_tr_b16 a[182:183], v4 offset:13320
    s_waitcnt vmcnt(16)
    ds_read_b64_tr_b16 a[184:185], v4 offset:14336
    ds_read_b64_tr_b16 a[186:187], v4 offset:15360
    ds_read_b64_tr_b16 a[188:189], v4 offset:14344
    ds_read_b64_tr_b16 a[190:191], v4 offset:15368
    s_waitcnt vmcnt(14)
    ds_read_b64_tr_b16 a[192:193], v4 offset:16384
    ds_read_b64_tr_b16 a[194:195], v4 offset:17408
    ds_read_b64_tr_b16 a[196:197], v4 offset:16392
    ds_read_b64_tr_b16 a[198:199], v4 offset:17416
    s_waitcnt vmcnt(12)
    ds_read_b64_tr_b16 a[200:201], v4 offset:18432
    ds_read_b64_tr_b16 a[202:203], v4 offset:19456
    ds_read_b64_tr_b16 a[204:205], v4 offset:18440
    ds_read_b64_tr_b16 a[206:207], v4 offset:19464
    s_waitcnt vmcnt(10)
    ds_read_b64_tr_b16 a[208:209], v4 offset:20480
    ds_read_b64_tr_b16 a[210:211], v4 offset:21504
    ds_read_b64_tr_b16 a[212:213], v4 offset:20488
    ds_read_b64_tr_b16 a[214:215], v4 offset:21512
    s_waitcnt vmcnt(8)
    ds_read_b64_tr_b16 a[216:217], v4 offset:22528
    ds_read_b64_tr_b16 a[218:219], v4 offset:23552
    ds_read_b64_tr_b16 a[220:221], v4 offset:22536
    ds_read_b64_tr_b16 a[222:223], v4 offset:23560
    s_waitcnt vmcnt(6)
    ds_read_b64_tr_b16 a[224:225], v4 offset:24576
    ds_read_b64_tr_b16 a[226:227], v4 offset:25600
    ds_read_b64_tr_b16 a[228:229], v4 offset:24584
    ds_read_b64_tr_b16 a[230:231], v4 offset:25608
    s_waitcnt vmcnt(4)
    ds_read_b64_tr_b16 a[232:233], v4 offset:26624
    ds_read_b64_tr_b16 a[234:235], v4 offset:27648
    ds_read_b64_tr_b16 a[236:237], v4 offset:26632
    ds_read_b64_tr_b16 a[238:239], v4 offset:27656
    s_waitcnt vmcnt(2)
    ds_read_b64_tr_b16 a[240:241], v4 offset:28672
    ds_read_b64_tr_b16 a[242:243], v4 offset:29696
    ds_read_b64_tr_b16 a[244:245], v4 offset:28680
    ds_read_b64_tr_b16 a[246:247], v4 offset:29704
    s_waitcnt vmcnt(0)
    ds_read_b64_tr_b16 a[248:249], v4 offset:30720
    ds_read_b64_tr_b16 a[250:251], v4 offset:31744
    ds_read_b64_tr_b16 a[252:253], v4 offset:30728
    ds_read_b64_tr_b16 a[254:255], v4 offset:31752
    s_waitcnt lgkmcnt(0)
    s_mov_b32 s12, s38
    s_and_b32 s13, s39, 0xffff
    s_mov_b32 s14, 0x500000
    s_mov_b32 s15, 0x00020000
    v_lshlrev_b32 v0, 4, v255
    v_and_b32 v1, 15, v255
    v_lshrrev_b32 v2, 4, v255
    v_mul_u32_u24 v1, 2560, v1
    v_lshl_add_u32 v1, v2, 4, v1
    s_lshl_b32 s26, s22, 11
    v_add_u32 v2, s26, v0
    s_mov_b32 s32, 0
    s_lshl_b32 s26, s22, 10
    s_mul_i32 s27, s25, 8192
    s_add_u32 s26, s26, s27
    v_lshl_add_u32 v5, v255, 7, s26
    s_barrier
    v_mov_b32 v9, 0
    v_mov_b32 v10, 0
    s_mov_b32 s35, 90218496
    s_mov_b32 s40, 90222592
L_loopo:
    s_lshl_b32 s29, s25, 17
    s_lshl_b32 s26, s22, 15
    s_add_u32 s29, s29, s26
    s_add_u32 s29, s29, 67108864
    s_lshr_b32 s31, s25, 2
    s_add_u32 s31, s31, 1
    s_bfe_u32 s27, s25, 0x10001
    s_lshl_b32 s27, s27, 12
    s_add_u32 s27, s27, 90218496
    s_cmp_eq_u32 s27, s35
    s_cselect_b64 vcc, -1, 0
    s_nop 0
    v_cndmask_b32 v7, v10, v9, vcc
    s_mov_b64 exec, 255
    v_cmp_gt_i32 vcc, s31, v7
    s_cbranch_vccz L_po_ok
    s_mov_b64 exec, 255
    s_mov_b32 s26, 0
L_po:
    buffer_load_dword v7, v5, s[8:11], s27 offen sc1
    s_add_u32 s26, s26, 1
    s_cmp_gt_u32 s26, 262144
    s_cbranch_scc1 L_fin
    s_waitcnt vmcnt(0)
    v_cmp_gt_i32 vcc, s31, v7
    s_cbranch_vccz L_po_ok
    s_sleep 2
    s_branch L_po
L_po_ok:
    s_mov_b64 exec, -1
    buffer_load_dwordx4 v[16:19], v0, s[8:11], s29 offen offset:0 sc1
    buffer_load_dwordx4 v[20:23], v0, s[8:11], s29 offen offset:1024 sc1
    buffer_load_dwordx4 v[24:27], v0, s[8:11], s29 offen offset:2048 sc1
    buffer_load_dwordx4 v[28:31], v0, s[8:11], s29 offen offset:3072 sc1
    s_add_u32 s29, s29, 4096
    buffer_load_dwordx4 v[32:35], v0, s[8:11], s29 offen offset:0 sc1
    buffer_load_dwordx4 v[36:39], v0, s[8:11], s29 offen offset:1024 sc1
    buffer_load_dwordx4 v[40:43], v0, s[8:11], s29 offen offset:2048 sc1
    buffer_load_dwordx4 v[44:47], v0, s[8:11], s29 offen offset:3072 sc1
    s_add_u32 s29, s29, 4096
    buffer_load_dwordx4 v[48:51], v0, s[8:11], s29 offen offset:0 sc1
    buffer_load_dwordx4 v[52:55], v0, s[8:11], s29 offen offset:1024 sc1
    buffer_load_dwordx4 v[56:59], v0, s[8:11], s29 offen offset:2048 sc1
    buffer_load_dwordx4 v[60:63], v0, s[8:11], s29 offen offset:3072 sc1
    s_add_u32 s29, s29, 4096
    buffer_load_dwordx4 v[64:67], v0, s[8:11], s29 offen offset:0 sc1
    buffer_load_dwordx4 v[68:71], v0, s[8:11], s29 offen offset:1024 sc1
    buffer_load_dwordx4 v[72:75], v0, s[8:11], s29 offen offset:2048 sc1
    buffer_load_dwordx4 v[76:79], v0, s[8:11], s29 offen offset:3072 sc1
    s_add_u32 s29, s29, 4096
    buffer_load_dwordx4 v[80:83], v0, s[8:11], s29 offen offset:0 sc1
    buffer_load_dwordx4 v[84:87], v0, s[8:11], s29 offen offset:1024 sc1
    buffer_load_dwordx4 v[88:91], v0, s[8:11], s29 offen offset:2048 sc1
    buffer_load_dwordx4 v[92:95], v0, s[8:11], s29 offen offset:3072 sc1
    s_add_u32 s29, s29, 4096
    buffer_load_dwordx4 v[96:99], v0, s[8:11], s29 offen offset:0 sc1
    buffer_load_dwordx4 v[100:103], v0, s[8:11], s29 offen offset:1024 sc1
    buffer_load_dwordx4 v[104:107], v0, s[8:11], s29 offen offset:2048 sc1
    buffer_load_dwordx4 v[108:111], v0, s[8:11], s29 offen offset:3072 sc1
    s_add_u32 s29, s29, 4096
    buffer_load_dwordx4 v[112:115], v0, s[8:11], s29 offen offset:0 sc1
    buffer_load_dwordx4 v[116:119], v0, s[8:11], s29 offen offset:1024 sc1
    buffer_load_dwordx4 v[120:123], v0, s[8:11], s29 offen offset:2048 sc1
    buffer_load_dwordx4 v[124:127], v0, s[8:11], s29 offen offset:3072 sc1
    s_add_u32 s29, s29, 4096
    buffer_load_dwordx4 v[128:131], v0, s[8:11], s29 offen offset:0 sc1
    buffer_load_dwordx4 v[132:135], v0, s[8:11], s29 offen offset:1024 sc1
    buffer_load_dwordx4 v[136:139], v0, s[8:11], s29 offen offset:2048 sc1
    buffer_load_dwordx4 v[140:143], v0, s[8:11], s29 offen offset:3072 sc1
    s_add_u32 s29, s29, 4096
    s_waitcnt vmcnt(31)
    v_mfma_f32_16x16x32_bf16 v[144:147], a[0:3], v[16:19], 0
    v_mfma_f32_16x16x32_bf16 v[148:151], a[4:7], v[16:19], 0
    s_waitcnt vmcnt(30)
    v_mfma_f32_16x16x32_bf16 v[144:147], a[8:11], v[20:23], v[144:147]
    v_mfma_f32_16x16x32_bf16 v[148:151], a[12:15], v[20:23], v[148:151]
    s_waitcnt vmcnt(29)
    v_mfma_f32_16x16x32_bf16 v[144:147], a[16:19], v[24:27], v[144:147]
    v_mfma_f32_16x16x32_bf16 v[148:151], a[20:23], v[24:27], v[148:151]
    s_waitcnt vmcnt(28)
    v_mfma_f32_16x16x32_bf16 v[144:147], a[24:27], v[28:31], v[144:147]
    v_mfma_f32_16x16x32_bf16 v[148:151], a[28:31], v[28:31], v[148:151]
    s_waitcnt vmcnt(27)
    v_mfma_f32_16x16x32_bf16 v[144:147], a[32:35], v[32:35], v[144:147]
    v_mfma_f32_16x16x32_bf16 v[148:151], a[36:39], v[32:35], v[148:151]
    s_waitcnt vmcnt(26)
    v_mfma_f32_16x16x32_bf16 v[144:147], a[40:43], v[36:39], v[144:147]
    v_mfma_f32_16x16x32_bf16 v[148:151], a[44:47], v[36:39], v[148:151]
    s_waitcnt vmcnt(25)
    v_mfma_f32_16x16x32_bf16 v[144:147], a[48:51], v[40:43], v[144:147]
    v_mfma_f32_16x16x32_bf16 v[148:151], a[52:55], v[40:43], v[148:151]
    s_waitcnt vmcnt(24)
    v_mfma_f32_16x16x32_bf16 v[144:147], a[56:59], v[44:47], v[144:147]
    v_mfma_f32_16x16x32_bf16 v[148:151], a[60:63], v[44:47], v[148:151]
    s_waitcnt vmcnt(23)
    v_mfma_f32_16x16x32_bf16 v[144:147], a[64:67], v[48:51], v[144:147]
    v_mfma_f32_16x16x32_bf16 v[148:151], a[68:71], v[48:51], v[148:151]
    s_waitcnt vmcnt(22)
    v_mfma_f32_16x16x32_bf16 v[144:147], a[72:75], v[52:55], v[144:147]
    v_mfma_f32_16x16x32_bf16 v[148:151], a[76:79], v[52:55], v[148:151]
    s_waitcnt vmcnt(21)
    v_mfma_f32_16x16x32_bf16 v[144:147], a[80:83], v[56:59], v[144:147]
    v_mfma_f32_16x16x32_bf16 v[148:151], a[84:87], v[56:59], v[148:151]
    s_waitcnt vmcnt(20)
    v_mfma_f32_16x16x32_bf16 v[144:147], a[88:91], v[60:63], v[144:147]
    v_mfma_f32_16x16x32_bf16 v[148:151], a[92:95], v[60:63], v[148:151]
    s_waitcnt vmcnt(19)
    v_mfma_f32_16x16x32_bf16 v[144:147], a[96:99], v[64:67], v[144:147]
    v_mfma_f32_16x16x32_bf16 v[148:151], a[100:103], v[64:67], v[148:151]
    s_waitcnt vmcnt(18)
    v_mfma_f32_16x16x32_bf16 v[144:147], a[104:107], v[68:71], v[144:147]
    v_mfma_f32_16x16x32_bf16 v[148:151], a[108:111], v[68:71], v[148:151]
    s_waitcnt vmcnt(17)
    v_mfma_f32_16x16x32_bf16 v[144:147], a[112:115], v[72:75], v[144:147]
    v_mfma_f32_16x16x32_bf16 v[148:151], a[116:119], v[72:75], v[148:151]
    s_waitcnt vmcnt(16)
    v_mfma_f32_16x16x32_bf16 v[144:147], a[120:123], v[76:79], v[144:147]
    v_mfma_f32_16x16x32_bf16 v[148:151], a[124:127], v[76:79], v[148:151]
    s_mov_b64 exec, 255
    buffer_load_dword v9, v5, s[8:11], s35 offen sc1
    buffer_load_dword v10, v5, s[8:11], s40 offen sc1
    s_mov_b64 exec, -1
    s_waitcnt vmcnt(17)
    v_mfma_f32_16x16x32_bf16 v[144:147], a[128:131], v[80:83], v[144:147]
    v_mfma_f32_16x16x32_bf16 v[148:151], a[132:135], v[80:83], v[148:151]
    s_waitcnt vmcnt(16)
    v_mfma_f32_16x16x32_bf16 v[144:147], a[136:139], v[84:87], v[144:147]
    v_mfma_f32_16x16x32_bf16 v[148:151], a[140:143], v[84:87], v[148:151]
    s_waitcnt vmcnt(15)
    v_mfma_f32_16x16x32_bf16 v[144:147], a[144:147], v[88:91], v[144:147]
    v_mfma_f32_16x16x32_bf16 v[148:151], a[148:151], v[88:91], v[148:151]
    s_waitcnt vmcnt(14)
    v_mfma_f32_16x16x32_bf16 v[144:147], a[152:155], v[92:95], v[144:147]
    v_mfma_f32_16x16x32_bf16 v[148:151], a[156:159], v[92:95], v[148:151]
    s_waitcnt vmcnt(13)
    v_mfma_f32_16x16x32_bf16 v[144:147], a[160:163], v[96:99], v[144:147]
    v_mfma_f32_16x16x32_bf16 v[148:151], a[164:167], v[96:99], v[148:151]
    s_waitcnt vmcnt(12)
    v_mfma_f32_16x16x32_bf16 v[144:147], a[168:171], v[100:103], v[144:147]
    v_mfma_f32_16x16x32_bf16 v[148:151], a[172:175], v[100:103], v[148:151]
    s_waitcnt vmcnt(11)
    v_mfma_f32_16x16x32_bf16 v[144:147], a[176:179], v[104:107], v[144:147]
    v_mfma_f32_16x16x32_bf16 v[148:151], a[180:183], v[104:107], v[148:151]
    s_waitcnt vmcnt(10)
    v_mfma_f32_16x16x32_bf16 v[144:147], a[184:187], v[108:111], v[144:147]
    v_mfma_f32_16x16x32_bf16 v[148:151], a[188:191], v[108:111], v[148:151]
    s_waitcnt vmcnt(9)
    v_mfma_f32_16x16x32_bf16 v[144:147], a[192:195], v[112:115], v[144:147]
    v_mfma_f32_16x16x32_bf16 v[148:151], a[196:199], v[112:115], v[148:151]
    s_waitcnt vmcnt(8)
    v_mfma_f32_16x16x32_bf16 v[144:147], a[200:203], v[116:119], v[144:147]
    v_mfma_f32_16x16x32_bf16 v[148:151], a[204:207], v[116:119], v[148:151]
    s_waitcnt vmcnt(7)
    v_mfma_f32_16x16x32_bf16 v[144:147], a[208:211], v[120:123], v[144:147]
    v_mfma_f32_16x16x32_bf16 v[148:151], a[212:215], v[120:123], v[148:151]
    s_waitcnt vmcnt(6)
    v_mfma_f32_16x16x32_bf16 v[144:147], a[216:219], v[124:127], v[144:147]
    v_mfma_f32_16x16x32_bf16 v[148:151], a[220:223], v[124:127], v[148:151]
    s_waitcnt vmcnt(5)
    v_mfma_f32_16x16x32_bf16 v[144:147], a[224:227], v[128:131], v[144:147]
    v_mfma_f32_16x16x32_bf16 v[148:151], a[228:231], v[128:131], v[148:151]
    s_waitcnt vmcnt(4)
    v_mfma_f32_16x16x32_bf16 v[144:147], a[232:235], v[132:135], v[144:147]
    v_mfma_f32_16x16x32_bf16 v[148:151], a[236:239], v[132:135], v[148:151]
    s_waitcnt vmcnt(3)
    v_mfma_f32_16x16x32_bf16 v[144:147], a[240:243], v[136:139], v[144:147]
    v_mfma_f32_16x16x32_bf16 v[148:151], a[244:247], v[136:139], v[148:151]
    s_waitcnt vmcnt(2)
    v_mfma_f32_16x16x32_bf16 v[144:147], a[248:251], v[140:143], v[144:147]
    v_mfma_f32_16x16x32_bf16 v[148:151], a[252:255], v[140:143], v[148:151]
    s_mul_i32 s30, s25, 40960
    s_add_u32 s25, s25, 4
L_fino:
    v_add_u32 v3, s32, v2
    v_add_u32 v4, s32, v0
    s_xor_b32 s32, s32, 8192
    s_lshl_b32 s26, s24, 6
    s_add_u32 s30, s30, s26
    s_cmp_eq_u32 s22, 0
    s_cbranch_scc1 L_redo
    ds_write_b128 v3, v[144:147]
    ds_write_b128 v3, v[148:151] offset:1024
    s_waitcnt lgkmcnt(0)
    s_barrier
    s_waitcnt vmcnt(0)
    s_branch L_nxo
L_redo:
    s_barrier
    ds_read_b128 v[24:27], v4 offset:2048
    ds_read_b128 v[28:31], v4 offset:3072
    ds_read_b128 v[32:35], v4 offset:4096
    ds_read_b128 v[36:39], v4 offset:5120
    ds_read_b128 v[40:43], v4 offset:6144
    ds_read_b128 v[44:47], v4 offset:7168
    s_waitcnt lgkmcnt(0)
    v_pk_add_f32 v[144:145], v[144:145], v[24:25]
    v_pk_add_f32 v[146:147], v[146:147], v[26:27]
    v_pk_add_f32 v[148:149], v[148:149], v[28:29]
    v_pk_add_f32 v[150:151], v[150:151], v[30:31]
    v_pk_add_f32 v[144:145], v[144:145], v[32:33]
    v_pk_add_f32 v[146:147], v[146:147], v[34:35]
    v_pk_add_f32 v[148:149], v[148:149], v[36:37]
    v_pk_add_f32 v[150:151], v[150:151], v[38:39]
    v_pk_add_f32 v[144:145], v[144:145], v[40:41]
    v_pk_add_f32 v[146:147], v[146:147], v[42:43]
    v_pk_add_f32 v[148:149], v[148:149], v[44:45]
    v_pk_add_f32 v[150:151], v[150:151], v[46:47]
    v_cvt_pk_bf16_f32 v152, v144, v145
    v_cvt_pk_bf16_f32 v153, v146, v147
    v_cvt_pk_bf16_f32 v154, v148, v149
    v_cvt_pk_bf16_f32 v155, v150, v151
    buffer_store_dwordx4 v[152:155], v1, s[12:15], s30 offen
    s_waitcnt vmcnt(1)
L_nxo:
    s_cmp_lt_u32 s25, 122
    s_cbranch_scc1 L_loopo
    s_cmp_ge_u32 s25, 319
    s_cbranch_scc1 L_byeo
    s_cmp_ge_u32 s25, 256
    s_cbranch_scc1 L_s63o
    s_and_b32 s25, s25, 3
    s_lshr_b32 s26, s25, 1
    s_lshl_b32 s29, s26, 17
    s_and_b32 s26, s25, 1
    s_lshl_b32 s26, s26, 7
    s_add_u32 s29, s29, s26
    s_lshl_b32 s26, s22, 15
    s_add_u32 s29, s29, s26
    s_add_u32 s33, s29, 82837504
    s_mul_i32 s34, s25, 20480
    s_add_u32 s34, s34, 4915200
    s_mov_b32 s25, 316
    v_and_b32 v6, 0x370, v0
    v_bfe_u32 v8, v255, 3, 1
    v_lshl_add_u32 v6, v8, 10, v6
    v_lshl_add_u32 v1, v8, 30, v1
L_s63o:
    s_add_u32 s33, s33, 0x40000
    s_add_u32 s34, s34, 81920
    s_mov_b32 s30, s34
    s_add_u32 s25, s25, 1
    s_and_b32 s27, s25, 1
    s_lshl_b32 s27, s27, 12
    s_add_u32 s27, s27, 90218496
    s_bfe_u32 s31, s25, 0x50001
    s_add_u32 s31, s31, 1
L_l8o:
    s_cmp_eq_u32 s27, s35
    s_cselect_b64 vcc, -1, 0
    s_nop 0
    v_cndmask_b32 v7, v10, v9, vcc
    s_mov_b64 exec, 255
    v_cmp_gt_i32 vcc, s31, v7
    s_cbranch_vccz L_p8o_ok
    s_mov_b64 exec, 255
    s_mov_b32 s26, 0
L_p8o:
    buffer_load_dword v7, v5, s[8:11], s27 offen sc1
    s_add_u32 s26, s26, 1
    s_cmp_gt_u32 s26, 262144
    s_cbranch_scc1 L_fin
    s_waitcnt vmcnt(0)
    v_cmp_gt_i32 vcc, s31, v7
    s_cbranch_vccz L_p8o_ok
    s_sleep 2
    s_branch L_p8o
L_p8o_ok:
    s_mov_b64 exec, -1
    s_mov_b32 s29, s33
    buffer_load_dwordx4 v[16:19], v6, s[8:11], s29 offen offset:0 sc1
    buffer_load_dwordx4 v[20:23], v6, s[8:11], s29 offen offset:2048 sc1
    s_add_u32 s29, s29, 4096
    buffer_load_dwordx4 v[24:27], v6, s[8:11], s29 offen offset:0 sc1
    buffer_load_dwordx4 v[28:31], v6, s[8:11], s29 offen offset:2048 sc1
    s_add_u32 s29, s29, 4096
    buffer_load_dwordx4 v[32:35], v6, s[8:11], s29 offen offset:0 sc1
    buffer_load_dwordx4 v[36:39], v6, s[8:11], s29 offen offset:2048 sc1
    s_add_u32 s29, s29, 4096
    buffer_load_dwordx4 v[40:43], v6, s[8:11], s29 offen offset:0 sc1
    buffer_load_dwordx4 v[44:47], v6, s[8:11], s29 offen offset:2048 sc1
    s_add_u32 s29, s29, 4096
    buffer_load_dwordx4 v[48:51], v6, s[8:11], s29 offen offset:0 sc1
    buffer_load_dwordx4 v[52:55], v6, s[8:11], s29 offen offset:2048 sc1
    s_add_u32 s29, s29, 4096
    buffer_load_dwordx4 v[56:59], v6, s[8:11], s29 offen offset:0 sc1
    buffer_load_dwordx4 v[60:63], v6, s[8:11], s29 offen offset:2048 sc1
    s_add_u32 s29, s29, 4096
    buffer_load_dwordx4 v[64:67], v6, s[8:11], s29 offen offset:0 sc1
    buffer_load_dwordx4 v[68:71], v6, s[8:11], s29 offen offset:2048 sc1
    s_add_u32 s29, s29, 4096
    buffer_load_dwordx4 v[72:75], v6, s[8:11], s29 offen offset:0 sc1
    buffer_load_dwordx4 v[76:79], v6, s[8:11], s29 offen offset:2048 sc1
    s_add_u32 s29, s29, 4096
    s_waitcnt vmcnt(15)
    v_mfma_f32_16x16x32_bf16 v[144:147], a[0:3], v[16:19], 0
    v_mfma_f32_16x16x32_bf16 v[148:151], a[4:7], v[16:19], 0
    v_mfma_f32_16x16x32_bf16 v[152:155], a[8:11], v[16:19], 0
    v_mfma_f32_16x16x32_bf16 v[156:159], a[12:15], v[16:19], 0
    s_waitcnt vmcnt(14)
    v_mfma_f32_16x16x32_bf16 v[144:147], a[16:19], v[20:23], v[144:147]
    v_mfma_f32_16x16x32_bf16 v[148:151], a[20:23], v[20:23], v[148:151]
    v_mfma_f32_16x16x32_bf16 v[152:155], a[24:27], v[20:23], v[152:155]
    v_mfma_f32_16x16x32_bf16 v[156:159], a[28:31], v[20:23], v[156:159]
    s_waitcnt vmcnt(13)
    v_mfma_f32_16x16x32_bf16 v[144:147], a[32:35], v[24:27], v[144:147]
    v_mfma_f32_16x16x32_bf16 v[148:151], a[36:39], v[24:27], v[148:151]
    v_mfma_f32_16x16x32_bf16 v[152:155], a[40:43], v[24:27], v[152:155]
    v_mfma_f32_16x16x32_bf16 v[156:159], a[44:47], v[24:27], v[156:159]
    s_waitcnt vmcnt(12)
    v_mfma_f32_16x16x32_bf16 v[144:147], a[48:51], v[28:31], v[144:147]
    v_mfma_f32_16x16x32_bf16 v[148:151], a[52:55], v[28:31], v[148:151]
    v_mfma_f32_16x16x32_bf16 v[152:155], a[56:59], v[28:31], v[152:155]
    v_mfma_f32_16x16x32_bf16 v[156:159], a[60:63], v[28:31], v[156:159]
    s_waitcnt vmcnt(11)
    v_mfma_f32_16x16x32_bf16 v[144:147], a[64:67], v[32:35], v[144:147]
    v_mfma_f32_16x16x32_bf16 v[148:151], a[68:71], v[32:35], v[148:151]
    v_mfma_f32_16x16x32_bf16 v[152:155], a[72:75], v[32:35], v[152:155]
    v_mfma_f32_16x16x32_bf16 v[156:159], a[76:79], v[32:35], v[156:159]
    s_waitcnt vmcnt(10)
    v_mfma_f32_16x16x32_bf16 v[144:147], a[80:83], v[36:39], v[144:147]
    v_mfma_f32_16x16x32_bf16 v[148:151], a[84:87], v[36:39], v[148:151]
    v_mfma_f32_16x16x32_bf16 v[152:155], a[88:91], v[36:39], v[152:155]
    v_mfma_f32_16x16x32_bf16 v[156:159], a[92:95], v[36:39], v[156:159]
    s_waitcnt vmcnt(9)
    v_mfma_f32_16x16x32_bf16 v[144:147], a[96:99], v[40:43], v[144:147]
    v_mfma_f32_16x16x32_bf16 v[148:151], a[100:103], v[40:43], v[148:151]
    v_mfma_f32_16x16x32_bf16 v[152:155], a[104:107], v[40:43], v[152:155]
    v_mfma_f32_16x16x32_bf16 v[156:159], a[108:111], v[40:43], v[156:159]
    s_waitcnt vmcnt(8)
    v_mfma_f32_16x16x32_bf16 v[144:147], a[112:115], v[44:47], v[144:147]
    v_mfma_f32_16x16x32_bf16 v[148:151], a[116:119], v[44:47], v[148:151]
    v_mfma_f32_16x16x32_bf16 v[152:155], a[120:123], v[44:47], v[152:155]
    v_mfma_f32_16x16x32_bf16 v[156:159], a[124:127], v[44:47], v[156:159]
    s_mov_b64 exec, 255
    buffer_load_dword v9, v5, s[8:11], s35 offen sc1
    buffer_load_dword v10, v5, s[8:11], s40 offen sc1
    s_mov_b64 exec, -1
    s_waitcnt vmcnt(9)
    v_mfma_f32_16x16x32_bf16 v[144:147], a[128:131], v[48:51], v[144:147]
    v_mfma_f32_16x16x32_bf16 v[148:151], a[132:135], v[48:51], v[148:151]
    v_mfma_f32_16x16x32_bf16 v[152:155], a[136:139], v[48:51], v[152:155]
    v_mfma_f32_16x16x32_bf16 v[156:159], a[140:143], v[48:51], v[156:159]
    s_waitcnt vmcnt(8)
    v_mfma_f32_16x16x32_bf16 v[144:147], a[144:147], v[52:55], v[144:147]
    v_mfma_f32_16x16x32_bf16 v[148:151], a[148:151], v[52:55], v[148:151]
    v_mfma_f32_16x16x32_bf16 v[152:155], a[152:155], v[52:55], v[152:155]
    v_mfma_f32_16x16x32_bf16 v[156:159], a[156:159], v[52:55], v[156:159]
    s_waitcnt vmcnt(7)
    v_mfma_f32_16x16x32_bf16 v[144:147], a[160:163], v[56:59], v[144:147]
    v_mfma_f32_16x16x32_bf16 v[148:151], a[164:167], v[56:59], v[148:151]
    v_mfma_f32_16x16x32_bf16 v[152:155], a[168:171], v[56:59], v[152:155]
    v_mfma_f32_16x16x32_bf16 v[156:159], a[172:175], v[56:59], v[156:159]
    s_waitcnt vmcnt(6)
    v_mfma_f32_16x16x32_bf16 v[144:147], a[176:179], v[60:63], v[144:147]
    v_mfma_f32_16x16x32_bf16 v[148:151], a[180:183], v[60:63], v[148:151]
    v_mfma_f32_16x16x32_bf16 v[152:155], a[184:187], v[60:63], v[152:155]
    v_mfma_f32_16x16x32_bf16 v[156:159], a[188:191], v[60:63], v[156:159]
    s_waitcnt vmcnt(5)
    v_mfma_f32_16x16x32_bf16 v[144:147], a[192:195], v[64:67], v[144:147]
    v_mfma_f32_16x16x32_bf16 v[148:151], a[196:199], v[64:67], v[148:151]
    v_mfma_f32_16x16x32_bf16 v[152:155], a[200:203], v[64:67], v[152:155]
    v_mfma_f32_16x16x32_bf16 v[156:159], a[204:207], v[64:67], v[156:159]
    s_waitcnt vmcnt(4)
    v_mfma_f32_16x16x32_bf16 v[144:147], a[208:211], v[68:71], v[144:147]
    v_mfma_f32_16x16x32_bf16 v[148:151], a[212:215], v[68:71], v[148:151]
    v_mfma_f32_16x16x32_bf16 v[152:155], a[216:219], v[68:71], v[152:155]
    v_mfma_f32_16x16x32_bf16 v[156:159], a[220:223], v[68:71], v[156:159]
    s_waitcnt vmcnt(3)
    v_mfma_f32_16x16x32_bf16 v[144:147], a[224:227], v[72:75], v[144:147]
    v_mfma_f32_16x16x32_bf16 v[148:151], a[228:231], v[72:75], v[148:151]
    v_mfma_f32_16x16x32_bf16 v[152:155], a[232:235], v[72:75], v[152:155]
    v_mfma_f32_16x16x32_bf16 v[156:159], a[236:239], v[72:75], v[156:159]
    s_waitcnt vmcnt(2)
    v_mfma_f32_16x16x32_bf16 v[144:147], a[240:243], v[76:79], v[144:147]
    v_mfma_f32_16x16x32_bf16 v[148:151], a[244:247], v[76:79], v[148:151]
    v_mfma_f32_16x16x32_bf16 v[152:155], a[248:251], v[76:79], v[152:155]
    v_mfma_f32_16x16x32_bf16 v[156:159], a[252:255], v[76:79], v[156:159]
    s_nop 6
    v_cmp_u_f32 vcc, v144, v144
    v_add_f32_dpp v144, v152, v144 row_ror:8 row_mask:0xf bank_mask:0xf
    v_add_f32_dpp v145, v153, v145 row_ror:8 row_mask:0xf bank_mask:0xf
    v_add_f32_dpp v146, v154, v146 row_ror:8 row_mask:0xf bank_mask:0xf
    v_add_f32_dpp v147, v155, v147 row_ror:8 row_mask:0xf bank_mask:0xf
    v_add_f32_dpp v148, v156, v148 row_ror:8 row_mask:0xf bank_mask:0xf
    v_add_f32_dpp v149, v157, v149 row_ror:8 row_mask:0xf bank_mask:0xf
    v_add_f32_dpp v150, v158, v150 row_ror:8 row_mask:0xf bank_mask:0xf
    v_add_f32_dpp v151, v159, v151 row_ror:8 row_mask:0xf bank_mask:0xf
    s_cbranch_vccz L_fino
    s_cmp_lg_u32 s31, 32
    s_cbranch_scc1 L_fino
    s_mov_b32 s31, 33
    s_add_u32 s27, s27, 32768
    s_waitcnt vmcnt(0)
    s_branch L_l8o
L_byeo:
    s_branch L_fin
L_chain:
    s_lshl_b32 s68, s21, 8
    s_mul_i32 s39, s20, 2621440
    s_add_u32 s69, s68, s39
    s_sub_u32 s70, s68, s39
    s_add_u32 s70, s70, 2621440
    s_mul_i32 s71, s21, 163840
    s_mul_i32 s39, s20, 640
    s_add_u32 s71, s71, s39
    s_waitcnt lgkmcnt(0)
    s_mov_b32 s12, s62
    s_and_b32 s13, s63, 0xffff
    s_mov_b32 s14, 0x500000
    s_mov_b32 s15, 0x00020000
    s_add_u32 m0, s57, 0
    s_add_u32 s39, s69, 1048576
    buffer_load_dwordx4 v60, s[12:15], s39 offen  lds
    s_add_u32 m0, s57, 1024
    s_add_u32 s39, s69, 1064960
    buffer_load_dwordx4 v60, s[12:15], s39 offen  lds
    s_add_u32 m0, s57, 2048
    s_add_u32 s39, s69, 1081344
    buffer_load_dwordx4 v61, s[12:15], s39 offen  lds
    s_add_u32 m0, s57, 3072
    s_add_u32 s39, s69, 1097728
    buffer_load_dwordx4 v61, s[12:15], s39 offen  lds
    s_add_u32 m0, s57, 4096
    s_add_u32 s39, s69, 1572864
    buffer_load_dwordx4 v60, s[12:15], s39 offen  lds
    s_add_u32 m0, s57, 5120
    s_add_u32 s39, s69, 1589248
    buffer_load_dwordx4 v60, s[12:15], s39 offen  lds
    s_add_u32 m0, s57, 6144
    s_add_u32 s39, s69, 1605632
    buffer_load_dwordx4 v61, s[12:15], s39 offen  lds
    s_add_u32 m0, s57, 7168
    s_add_u32 s39, s69, 1622016
    buffer_load_dwordx4 v61, s[12:15], s39 offen  lds
    s_add_u32 m0, s57, 8192
    s_add_u32 s39, s69, 0
    buffer_load_dwordx4 v60, s[12:15], s39 offen  lds
    s_add_u32 m0, s57, 9216
    s_add_u32 s39, s69, 16384
    buffer_load_dwordx4 v60, s[12:15], s39 offen  lds
    s_add_u32 m0, s57, 10240
    s_add_u32 s39, s69, 32768
    buffer_load_dwordx4 v61, s[12:15], s39 offen  lds
    s_add_u32 m0, s57, 11264
    s_add_u32 s39, s69, 49152
    buffer_load_dwordx4 v61, s[12:15], s39 offen  lds
    v_lshlrev_b32 v0, 4, v20
    s_mov_b32 s42, 0x33333333
    s_mov_b32 s43, 0x33333333
    s_mov_b32 s44, 0xcccccccc
    s_mov_b32 s45, 0xcccccccc
    v_mov_b32 v1, 0x4444
    v_mov_b32 v24, 0xeeee
    v_cndmask_b32 v1, v1, v24, s[44:45]
    v_lshrrev_b32 v24, 3, v20
    v_lshl_add_u32 v24, v21, 3, v24
    v_mul_u32_u24 v26, 0, v24
    v_add_u32 v26, s21, v26
    v_and_b32 v26, 31, v26
    v_lshlrev_b32 v24, 11, v24
    v_lshl_add_u32 v24, v26, 6, v24
    v_and_b32 v25, 7, v20
    v_lshl_add_u32 v2, v25, 3, v24
    v_lshl_add_u32 v24, v21, 2, v23
    v_add_u32 v24, 64, v24
    v_mul_u32_u24 v26, 0, v24
    v_add_u32 v26, s21, v26
    v_and_b32 v26, 31, v26
    v_lshlrev_b32 v24, 11, v24
    v_lshl_add_u32 v24, v26, 6, v24
    v_lshl_add_u32 v3, v22, 2, v24
    s_lshl_b32 s38, s22, 5
    s_add_u32 s38, s38, s21
    s_cmp_lt_u32 s38, 80
    s_cselect_b32 s36, 1, 0
    s_cselect_b32 s38, s38, 0
    s_lshl_b32 s32, s38, 11
    v_and_b32 v26, 3, v22
    v_lshrrev_b32 v27, 1, v23
    v_and_b32 v29, 1, v23
    s_cmp_lt_u32 s22, 2
    s_cbranch_scc0 L_segC
    s_lshr_b32 s50, s21, 3
    s_lshr_b32 s51, s21, 1
    s_and_b32 s51, s51, 3
    s_and_b32 s55, s21, 1
    s_and_b32 s52, s50, 1
    s_lshl_b32 s52, s52, 1
    s_add_u32 s52, s52, s55
    s_lshr_b32 s53, s50, 1
    s_lshl_b32 s56, s22, 1
    s_add_u32 s53, s53, s56
    s_lshl_b32 s54, s22, 7
    s_lshl_b32 s56, s50, 5
    s_add_u32 s54, s54, s56
    s_lshl_b32 s56, s55, 3
    s_add_u32 s54, s54, s56
    v_lshl_add_u32 v28, v29, 3, v26
    v_lshlrev_b32 v28, 1, v28
    v_lshl_add_u32 v24, v29, 1, v27
    v_lshlrev_b32 v24, 4, v24
    v_lshl_add_u32 v24, v26, 2, v24
    v_and_b32 v30, 1, v22
    v_bfe_u32 v31, v22, 2, 1
    v_lshl_add_u32 v30, v30, 1, v31
    s_branch L_segD
L_segC:
    s_lshr_b32 s50, s21, 2
    s_and_b32 s50, s50, 3
    s_and_b32 s51, s21, 3
    s_mov_b32 s52, s50
    s_mov_b32 s53, 4
    s_lshl_b32 s54, s50, 4
    s_add_u32 s54, s54, 256
    v_lshl_add_u32 v28, v26, 1, v29
    v_lshlrev_b32 v28, 1, v28
    v_lshrrev_b32 v24, 1, v26
    v_lshl_add_u32 v24, v24, 1, v27
    v_lshlrev_b32 v24, 4, v24
    v_and_b32 v25, 1, v26
    v_lshl_add_u32 v24, v25, 3, v24
    v_lshl_add_u32 v24, v29, 2, v24
    v_and_b32 v30, 1, v22
    v_bfe_u32 v31, v22, 2, 1
    v_lshl_add_u32 v30, v31, 1, v30
L_segD:
    s_lshl_b32 s53, s53, 10
    s_lshl_b32 s52, s52, 8
    s_add_u32 s53, s53, s52
    s_lshl_b32 s56, s51, 6
    s_add_u32 s53, s53, s56
    v_add_u32 v24, s53, v24
    v_cmp_gt_u32 vcc, 4, v22
    v_mov_b32 v25, 0x40000000
    v_add_u32 v31, 4194304, v24
    v_cndmask_b32 v4, v25, v24, vcc
    v_cndmask_b32 v31, v31, v24, vcc
    s_mul_i32 s56, s20, 320
    s_add_u32 s54, s54, s56
    s_mul_i32 s56, s51, 1280
    s_add_u32 s54, s54, s56
    v_mul_u32_u24 v24, 640, v27
    v_add3_u32 v28, v24, v28, s54
    v_lshlrev_b32 v28, 1, v28
    s_lshl_b32 s39, s21, 14
    s_lshl_b32 s40, s22, 12
    s_add_u32 s30, s39, s40
    v_lshlrev_b32 v24, 7, v20
    v_add_u32 v26, s30, v24
    s_lshl_b32 s39, s20, 13
    s_add_u32 s23, s39, 524288
    s_mul_i32 s40, s22, 1280
    s_add_u32 s39, s23, s40
    s_sub_u32 s39, s39, 4096
    v_add_u32 v24, s39, v24
    v_cmp_gt_u32 vcc, 32, v20
    s_nop 1
    v_cndmask_b32 v24, v24, v26, vcc
    v_cmp_gt_u32 vcc, 42, v20
    s_nop 1
    v_cndmask_b32 v5, v25, v24, vcc
    v_lshl_add_u32 v6, v21, 10, v0
    s_lshl_b32 s48, s22, 2
    v_lshrrev_b32 v24, 1, v21
    v_lshlrev_b32 v24, 10, v24
    v_and_b32 v25, 1, v21
    v_lshl_add_u32 v24, v25, 5, v24
    v_add_u32 v24, 5120, v24
    v_add_u32 v8, v24, v0
    v_add_u32 v9, s57, v0
    v_lshrrev_b32 v24, 3, v22
    v_lshlrev_b32 v24, 4, v24
    v_mov_b32 v25, 0x3f80
    v_lshlrev_b32 v24, v24, v25
    v_and_b32 v26, 2, v22
    v_lshl_add_u32 v26, v26, 2, v30
    v_cmp_eq_u32 vcc, 0, v26
    s_nop 1
    v_cndmask_b32 v100, 0, v24, vcc
    v_cmp_eq_u32 vcc, 1, v26
    s_nop 1
    v_cndmask_b32 v101, 0, v24, vcc
    v_cmp_eq_u32 vcc, 2, v26
    s_nop 1
    v_cndmask_b32 v102, 0, v24, vcc
    v_cmp_eq_u32 vcc, 3, v26
    s_nop 1
    v_cndmask_b32 v103, 0, v24, vcc
    v_and_b32 v24, 1, v22
    v_lshlrev_b32 v24, 4, v24
    v_lshlrev_b32 v24, v24, v25
    v_lshrrev_b32 v26, 1, v22
    v_lshlrev_b32 v27, 1, v23
    v_sub_u32 v26, v26, v27
    v_cmp_eq_u32 vcc, 0, v26
    s_nop 1
    v_cndmask_b32 v10, 0, v24, vcc
    v_cmp_eq_u32 vcc, 1, v26
    s_nop 1
    v_cndmask_b32 v11, 0, v24, vcc
    s_add_u32 s24, s23, 4096
    s_lshl_b32 s39, s20, 20
    s_add_u32 s27, s39, 83886080
    s_mul_i32 s39, s20, 327680
    s_add_u32 s28, s39, 85983232
    s_add_u32 s40, s28, 163840
    s_xor_b32 s35, s28, s40
    s_add_u32 s39, s32, s28
    s_add_u32 s32, s32, s40
    s_xor_b32 s41, s32, s39
    s_mov_b32 s31, 540672
    s_mov_b32 s33, 0
    s_mov_b32 s34, 0
    s_mov_b32 s47, 0
    s_mov_b32 s37, 0x3e0293ee
    s_lshl_b32 s39, s20, 5
    s_add_u32 s38, s39, s21
    s_lshl_b32 s49, s38, 7
    s_add_u32 s49, s49, 90202112
    s_mov_b32 s12, s58
    s_and_b32 s13, s59, 0xffff
    s_mov_b32 s14, 0x2800
    s_mov_b32 s15, 0x00020000
    buffer_load_dword v35, v28, s[12:15], 0 offen
    s_and_b32 s73, s21, 3
    s_xor_b32 s73, s73, 1
    s_cmp_eq_u32 s21, 31
    s_cselect_b32 vcc_lo, 0, s73
    s_mov_b32 vcc_hi, 0
    s_waitcnt vmcnt(9) lgkmcnt(0)
    s_barrier
    s_mov_b32 s12, s62
    s_and_b32 s13, s63, 0xffff
    s_mov_b32 s14, 0x500000
    s_mov_b32 s15, 0x00020000
    s_cbranch_vccz L_sw3_0
    s_waitcnt vmcnt(6)
L_sw3_0:
    s_add_u32 m0, s57, 12288
    s_add_u32 s39, s69, 524288
    buffer_load_dwordx4 v60, s[12:15], s39 offen  lds
    s_cbranch_vccz L_sw3_1
    s_waitcnt vmcnt(6)
L_sw3_1:
    s_add_u32 m0, s57, 13312
    s_add_u32 s39, s69, 540672
    buffer_load_dwordx4 v60, s[12:15], s39 offen  lds
    s_cbranch_vccz L_sw3_2
    s_waitcnt vmcnt(6)
L_sw3_2:
    s_add_u32 m0, s57, 14336
    s_add_u32 s39, s69, 557056
    buffer_load_dwordx4 v61, s[12:15], s39 offen  lds
    s_cbranch_vccz L_sw3_3
    s_waitcnt vmcnt(6)
L_sw3_3:
    s_add_u32 m0, s57, 15360
    s_add_u32 s39, s69, 573440
    buffer_load_dwordx4 v61, s[12:15], s39 offen  lds
    ds_read_b64_tr_b16 a[88:89], v68 offset:0
    ds_read_b64_tr_b16 a[90:91], v68 offset:1024
    ds_read_b64_tr_b16 a[92:93], v70 offset:0
    ds_read_b64_tr_b16 a[94:95], v70 offset:1024
    ds_read_b64_tr_b16 a[96:97], v69 offset:0
    ds_read_b64_tr_b16 a[98:99], v69 offset:1024
    ds_read_b64_tr_b16 a[100:101], v71 offset:0
    ds_read_b64_tr_b16 a[102:103], v71 offset:1024
    s_waitcnt vmcnt(9) lgkmcnt(0)
    s_barrier
    s_cbranch_vccz L_sw4_0
    s_waitcnt vmcnt(6)
L_sw4_0:
    s_add_u32 m0, s57, 16384
    s_add_u32 s39, s69, 2097152
    buffer_load_dwordx4 v62, s[12:15], s39 offen  lds
    s_cbranch_vccz L_sw4_1
    s_waitcnt vmcnt(6)
L_sw4_1:
    s_add_u32 m0, s57, 17408
    s_add_u32 s39, s69, 2113536
    buffer_load_dwordx4 v62, s[12:15], s39 offen  lds
    s_cbranch_vccz L_sw4_2
    s_waitcnt vmcnt(6)
L_sw4_2:
    s_add_u32 m0, s57, 18432
    s_add_u32 s39, s69, 2129920
    buffer_load_dwordx4 v63, s[12:15], s39 offen  lds
    s_cbranch_vccz L_sw4_3
    s_waitcnt vmcnt(6)
L_sw4_3:
    s_add_u32 m0, s57, 19456
    s_add_u32 s39, s69, 2146304
    buffer_load_dwordx4 v63, s[12:15], s39 offen  lds
    ds_read_b64_tr_b16 a[104:105], v68 offset:4096
    ds_read_b64_tr_b16 a[106:107], v68 offset:5120
    ds_read_b64_tr_b16 a[108:109], v70 offset:4096
    ds_read_b64_tr_b16 a[110:111], v70 offset:5120
    ds_read_b64_tr_b16 a[112:113], v69 offset:4096
    ds_read_b64_tr_b16 a[114:115], v69 offset:5120
    ds_read_b64_tr_b16 a[116:117], v71 offset:4096
    ds_read_b64_tr_b16 a[118:119], v71 offset:5120
    s_waitcnt vmcnt(9) lgkmcnt(0)
    s_barrier
    s_cbranch_vccz L_sw5_0
    s_waitcnt vmcnt(6)
L_sw5_0:
    s_add_u32 m0, s57, 20480
    s_add_u32 s39, s70, 1048576
    buffer_load_dwordx4 v60, s[12:15], s39 offen  lds
    s_cbranch_vccz L_sw5_1
    s_waitcnt vmcnt(6)
L_sw5_1:
    s_add_u32 m0, s57, 21504
    s_add_u32 s39, s70, 1064960
    buffer_load_dwordx4 v60, s[12:15], s39 offen  lds
    s_cbranch_vccz L_sw5_2
    s_waitcnt vmcnt(6)
L_sw5_2:
    s_add_u32 m0, s57, 22528
    s_add_u32 s39, s70, 1081344
    buffer_load_dwordx4 v61, s[12:15], s39 offen  lds
    s_cbranch_vccz L_sw5_3
    s_waitcnt vmcnt(6)
L_sw5_3:
    s_add_u32 m0, s57, 23552
    s_add_u32 s39, s70, 1097728
    buffer_load_dwordx4 v61, s[12:15], s39 offen  lds
    ds_read_b64_tr_b16 a[120:121], v68 offset:8192
    ds_read_b64_tr_b16 a[122:123], v68 offset:9216
    ds_read_b64_tr_b16 a[124:125], v70 offset:8192
    ds_read_b64_tr_b16 a[126:127], v70 offset:9216
    ds_read_b64_tr_b16 a[128:129], v69 offset:8192
    ds_read_b64_tr_b16 a[130:131], v69 offset:9216
    ds_read_b64_tr_b16 a[132:133], v71 offset:8192
    ds_read_b64_tr_b16 a[134:135], v71 offset:9216
    s_waitcnt vmcnt(8) lgkmcnt(0)
    s_barrier
    v_min_u32 v14, -2, v35
    s_cbranch_vccz L_sw6_0
    s_waitcnt vmcnt(6)
L_sw6_0:
    s_add_u32 m0, s57, 24576
    s_add_u32 s39, s70, 1572864
    buffer_load_dwordx4 v60, s[12:15], s39 offen  lds
    s_cbranch_vccz L_sw6_1
    s_waitcnt vmcnt(6)
L_sw6_1:
    s_add_u32 m0, s57, 25600
    s_add_u32 s39, s70, 1589248
    buffer_load_dwordx4 v60, s[12:15], s39 offen  lds
    s_cbranch_vccz L_sw6_2
    s_waitcnt vmcnt(6)
L_sw6_2:
    s_add_u32 m0, s57, 26624
    s_add_u32 s39, s70, 1605632
    buffer_load_dwordx4 v61, s[12:15], s39 offen  lds
    s_cbranch_vccz L_sw6_3
    s_waitcnt vmcnt(6)
L_sw6_3:
    s_add_u32 m0, s57, 27648
    s_add_u32 s39, s70, 1622016
    buffer_load_dwordx4 v61, s[12:15], s39 offen  lds
    ds_read_b64_tr_b16 a[136:137], v68 offset:12288
    ds_read_b64_tr_b16 a[138:139], v68 offset:13312
    ds_read_b64_tr_b16 a[140:141], v70 offset:12288
    ds_read_b64_tr_b16 a[142:143], v70 offset:13312
    ds_read_b64_tr_b16 a[144:145], v69 offset:12288
    ds_read_b64_tr_b16 a[146:147], v69 offset:13312
    ds_read_b64_tr_b16 a[148:149], v71 offset:12288
    ds_read_b64_tr_b16 a[150:151], v71 offset:13312
    s_waitcnt vmcnt(8) lgkmcnt(0)
    s_barrier
    s_cbranch_vccz L_sw7_0
    s_waitcnt vmcnt(6)
L_sw7_0:
    s_add_u32 m0, s57, 28672
    s_add_u32 s39, s70, 0
    buffer_load_dwordx4 v60, s[12:15], s39 offen  lds
    s_cbranch_vccz L_sw7_1
    s_waitcnt vmcnt(6)
L_sw7_1:
    s_add_u32 m0, s57, 29696
    s_add_u32 s39, s70, 16384
    buffer_load_dwordx4 v60, s[12:15], s39 offen  lds
    s_cbranch_vccz L_sw7_2
    s_waitcnt vmcnt(6)
L_sw7_2:
    s_add_u32 m0, s57, 30720
    s_add_u32 s39, s70, 32768
    buffer_load_dwordx4 v61, s[12:15], s39 offen  lds
    s_cbranch_vccz L_sw7_3
    s_waitcnt vmcnt(6)
L_sw7_3:
    s_add_u32 m0, s57, 31744
    s_add_u32 s39, s70, 49152
    buffer_load_dwordx4 v61, s[12:15], s39 offen  lds
    ds_read_b64_tr_b16 a[152:153], v68 offset:16384
    ds_read_b64_tr_b16 a[154:155], v68 offset:17408
    ds_read_b64_tr_b16 a[156:157], v70 offset:16384
    ds_read_b64_tr_b16 a[158:159], v70 offset:17408
    ds_read_b64_tr_b16 a[160:161], v69 offset:16384
    ds_read_b64_tr_b16 a[162:163], v69 offset:17408
    ds_read_b64_tr_b16 a[164:165], v71 offset:16384
    ds_read_b64_tr_b16 a[166:167], v71 offset:17408
    s_waitcnt vmcnt(8) lgkmcnt(0)
    s_barrier
    s_cbranch_vccz L_sw8_0
    s_waitcnt vmcnt(6)
L_sw8_0:
    s_add_u32 m0, s57, 32768
    s_add_u32 s39, s70, 524288
    buffer_load_dwordx4 v60, s[12:15], s39 offen  lds
    s_cbranch_vccz L_sw8_1
    s_waitcnt vmcnt(6)
L_sw8_1:
    s_add_u32 m0, s57, 33792
    s_add_u32 s39, s70, 540672
    buffer_load_dwordx4 v60, s[12:15], s39 offen  lds
    s_cbranch_vccz L_sw8_2
    s_waitcnt vmcnt(6)
L_sw8_2:
    s_add_u32 m0, s57, 34816
    s_add_u32 s39, s70, 557056
    buffer_load_dwordx4 v61, s[12:15], s39 offen  lds
    s_cbranch_vccz L_sw8_3
    s_waitcnt vmcnt(6)
L_sw8_3:
    s_add_u32 m0, s57, 35840
    s_add_u32 s39, s70, 573440
    buffer_load_dwordx4 v61, s[12:15], s39 offen  lds
    ds_read_b64_tr_b16 a[168:169], v68 offset:20480
    ds_read_b64_tr_b16 a[170:171], v68 offset:21504
    ds_read_b64_tr_b16 a[172:173], v70 offset:20480
    ds_read_b64_tr_b16 a[174:175], v70 offset:21504
    ds_read_b64_tr_b16 a[176:177], v69 offset:20480
    ds_read_b64_tr_b16 a[178:179], v69 offset:21504
    ds_read_b64_tr_b16 a[180:181], v71 offset:20480
    ds_read_b64_tr_b16 a[182:183], v71 offset:21504
    s_waitcnt vmcnt(8) lgkmcnt(0)
    s_barrier
    s_cbranch_vccz L_sw9_0
    s_waitcnt vmcnt(6)
L_sw9_0:
    s_add_u32 m0, s57, 0
    s_add_u32 s39, s70, 2097152
    buffer_load_dwordx4 v62, s[12:15], s39 offen  lds
    s_cbranch_vccz L_sw9_1
    s_waitcnt vmcnt(6)
L_sw9_1:
    s_add_u32 m0, s57, 1024
    s_add_u32 s39, s70, 2113536
    buffer_load_dwordx4 v62, s[12:15], s39 offen  lds
    s_cbranch_vccz L_sw9_2
    s_waitcnt vmcnt(6)
L_sw9_2:
    s_add_u32 m0, s57, 2048
    s_add_u32 s39, s70, 2129920
    buffer_load_dwordx4 v63, s[12:15], s39 offen  lds
    s_cbranch_vccz L_sw9_3
    s_waitcnt vmcnt(6)
L_sw9_3:
    s_add_u32 m0, s57, 3072
    s_add_u32 s39, s70, 2146304
    buffer_load_dwordx4 v63, s[12:15], s39 offen  lds
    ds_read_b64_tr_b16 a[184:185], v68 offset:24576
    ds_read_b64_tr_b16 a[186:187], v68 offset:25600
    ds_read_b64_tr_b16 a[188:189], v70 offset:24576
    ds_read_b64_tr_b16 a[190:191], v70 offset:25600
    ds_read_b64_tr_b16 a[192:193], v69 offset:24576
    ds_read_b64_tr_b16 a[194:195], v69 offset:25600
    ds_read_b64_tr_b16 a[196:197], v71 offset:24576
    ds_read_b64_tr_b16 a[198:199], v71 offset:25600
    s_waitcnt vmcnt(8) lgkmcnt(0)
    s_barrier
    s_mov_b32 s12, s64
    s_and_b32 s13, s65, 0xffff
    s_mov_b32 s14, 0x500000
    s_mov_b32 s15, 0x00020000
    s_cbranch_vccz L_sw10_0
    s_waitcnt vmcnt(6)
L_sw10_0:
    s_add_u32 m0, s57, 4096
    s_add_u32 s39, s70, 1048576
    buffer_load_dwordx4 v60, s[12:15], s39 offen  lds
    s_cbranch_vccz L_sw10_1
    s_waitcnt vmcnt(6)
L_sw10_1:
    s_add_u32 m0, s57, 5120
    s_add_u32 s39, s70, 1064960
    buffer_load_dwordx4 v60, s[12:15], s39 offen  lds
    s_cbranch_vccz L_sw10_2
    s_waitcnt vmcnt(6)
L_sw10_2:
    s_add_u32 m0, s57, 6144
    s_add_u32 s39, s70, 1081344
    buffer_load_dwordx4 v61, s[12:15], s39 offen  lds
    s_cbranch_vccz L_sw10_3
    s_waitcnt vmcnt(6)
L_sw10_3:
    s_add_u32 m0, s57, 7168
    s_add_u32 s39, s70, 1097728
    buffer_load_dwordx4 v61, s[12:15], s39 offen  lds
    ds_read_b64_tr_b16 a[200:201], v68 offset:28672
    ds_read_b64_tr_b16 a[202:203], v68 offset:29696
    ds_read_b64_tr_b16 a[204:205], v70 offset:28672
    ds_read_b64_tr_b16 a[206:207], v70 offset:29696
    ds_read_b64_tr_b16 a[208:209], v69 offset:28672
    ds_read_b64_tr_b16 a[210:211], v69 offset:29696
    ds_read_b64_tr_b16 a[212:213], v71 offset:28672
    ds_read_b64_tr_b16 a[214:215], v71 offset:29696
    s_waitcnt vmcnt(8) lgkmcnt(0)
    s_barrier
    s_cbranch_vccz L_sw11_0
    s_waitcnt vmcnt(6)
L_sw11_0:
    s_add_u32 m0, s57, 8192
    s_add_u32 s39, s70, 1572864
    buffer_load_dwordx4 v60, s[12:15], s39 offen  lds
    s_cbranch_vccz L_sw11_1
    s_waitcnt vmcnt(6)
L_sw11_1:
    s_add_u32 m0, s57, 9216
    s_add_u32 s39, s70, 1589248
    buffer_load_dwordx4 v60, s[12:15], s39 offen  lds
    s_cbranch_vccz L_sw11_2
    s_waitcnt vmcnt(6)
L_sw11_2:
    s_add_u32 m0, s57, 10240
    s_add_u32 s39, s70, 1605632
    buffer_load_dwordx4 v61, s[12:15], s39 offen  lds
    s_cbranch_vccz L_sw11_3
    s_waitcnt vmcnt(6)
L_sw11_3:
    s_add_u32 m0, s57, 11264
    s_add_u32 s39, s70, 1622016
    buffer_load_dwordx4 v61, s[12:15], s39 offen  lds
    ds_read_b64_tr_b16 a[216:217], v68 offset:32768
    ds_read_b64_tr_b16 a[218:219], v68 offset:33792
    ds_read_b64_tr_b16 a[220:221], v70 offset:32768
    ds_read_b64_tr_b16 a[222:223], v70 offset:33792
    ds_read_b64_tr_b16 a[224:225], v69 offset:32768
    ds_read_b64_tr_b16 a[226:227], v69 offset:33792
    ds_read_b64_tr_b16 a[228:229], v71 offset:32768
    ds_read_b64_tr_b16 a[230:231], v71 offset:33792
    s_waitcnt vmcnt(8) lgkmcnt(0)
    s_barrier
    s_cbranch_vccz L_sw12_0
    s_waitcnt vmcnt(6)
L_sw12_0:
    s_add_u32 m0, s57, 12288
    s_add_u32 s39, s70, 0
    buffer_load_dwordx4 v60, s[12:15], s39 offen  lds
    s_cbranch_vccz L_sw12_1
    s_waitcnt vmcnt(6)
L_sw12_1:
    s_add_u32 m0, s57, 13312
    s_add_u32 s39, s70, 16384
    buffer_load_dwordx4 v60, s[12:15], s39 offen  lds
    s_cbranch_vccz L_sw12_2
    s_waitcnt vmcnt(6)
L_sw12_2:
    s_add_u32 m0, s57, 14336
    s_add_u32 s39, s70, 32768
    buffer_load_dwordx4 v61, s[12:15], s39 offen  lds
    s_cbranch_vccz L_sw12_3
    s_waitcnt vmcnt(6)
L_sw12_3:
    s_add_u32 m0, s57, 15360
    s_add_u32 s39, s70, 49152
    buffer_load_dwordx4 v61, s[12:15], s39 offen  lds
    ds_read_b64_tr_b16 a[232:233], v68 offset:0
    ds_read_b64_tr_b16 a[234:235], v68 offset:1024
    ds_read_b64_tr_b16 a[236:237], v70 offset:0
    ds_read_b64_tr_b16 a[238:239], v70 offset:1024
    ds_read_b64_tr_b16 a[240:241], v69 offset:0
    ds_read_b64_tr_b16 a[242:243], v69 offset:1024
    ds_read_b64_tr_b16 a[244:245], v71 offset:0
    ds_read_b64_tr_b16 a[246:247], v71 offset:1024
    s_waitcnt vmcnt(8) lgkmcnt(0)
    s_barrier
    s_cbranch_vccz L_sw13_0
    s_waitcnt vmcnt(6)
L_sw13_0:
    s_add_u32 m0, s57, 16384
    s_add_u32 s39, s70, 524288
    buffer_load_dwordx4 v60, s[12:15], s39 offen  lds
    s_cbranch_vccz L_sw13_1
    s_waitcnt vmcnt(6)
L_sw13_1:
    s_add_u32 m0, s57, 17408
    s_add_u32 s39, s70, 540672
    buffer_load_dwordx4 v60, s[12:15], s39 offen  lds
    s_cbranch_vccz L_sw13_2
    s_waitcnt vmcnt(6)
L_sw13_2:
    s_add_u32 m0, s57, 18432
    s_add_u32 s39, s70, 557056
    buffer_load_dwordx4 v61, s[12:15], s39 offen  lds
    s_cbranch_vccz L_sw13_3
    s_waitcnt vmcnt(6)
L_sw13_3:
    s_add_u32 m0, s57, 19456
    s_add_u32 s39, s70, 573440
    buffer_load_dwordx4 v61, s[12:15], s39 offen  lds
    ds_read_b64_tr_b16 a[248:249], v68 offset:4096
    ds_read_b64_tr_b16 a[250:251], v68 offset:5120
    ds_read_b64_tr_b16 a[252:253], v70 offset:4096
    ds_read_b64_tr_b16 a[254:255], v70 offset:5120
    ds_read_b64_tr_b16 v[104:105], v69 offset:4096
    ds_read_b64_tr_b16 v[106:107], v69 offset:5120
    ds_read_b64_tr_b16 v[108:109], v71 offset:4096
    ds_read_b64_tr_b16 v[110:111], v71 offset:5120
    s_waitcnt vmcnt(8) lgkmcnt(0)
    s_barrier
    s_cbranch_vccz L_sw14_0
    s_waitcnt vmcnt(6)
L_sw14_0:
    s_add_u32 m0, s57, 20480
    s_add_u32 s39, s70, 2097152
    buffer_load_dwordx4 v62, s[12:15], s39 offen  lds
    s_cbranch_vccz L_sw14_1
    s_waitcnt vmcnt(6)
L_sw14_1:
    s_add_u32 m0, s57, 21504
    s_add_u32 s39, s70, 2113536
    buffer_load_dwordx4 v62, s[12:15], s39 offen  lds
    s_cbranch_vccz L_sw14_2
    s_waitcnt vmcnt(6)
L_sw14_2:
    s_add_u32 m0, s57, 22528
    s_add_u32 s39, s70, 2129920
    buffer_load_dwordx4 v63, s[12:15], s39 offen  lds
    s_cbranch_vccz L_sw14_3
    s_waitcnt vmcnt(6)
L_sw14_3:
    s_add_u32 m0, s57, 23552
    s_add_u32 s39, s70, 2146304
    buffer_load_dwordx4 v63, s[12:15], s39 offen  lds
    ds_read_b64_tr_b16 v[112:113], v68 offset:8192
    ds_read_b64_tr_b16 v[114:115], v68 offset:9216
    ds_read_b64_tr_b16 v[116:117], v70 offset:8192
    ds_read_b64_tr_b16 v[118:119], v70 offset:9216
    ds_read_b64_tr_b16 v[120:121], v69 offset:8192
    ds_read_b64_tr_b16 v[122:123], v69 offset:9216
    ds_read_b64_tr_b16 v[124:125], v71 offset:8192
    ds_read_b64_tr_b16 v[126:127], v71 offset:9216
    s_waitcnt vmcnt(8) lgkmcnt(0)
    s_barrier
    s_mov_b32 s12, s60
    s_and_b32 s13, s61, 0xffff
    s_mov_b32 s14, 0x500000
    s_mov_b32 s15, 0x00020000
    s_cbranch_vccz L_sw15_0
    s_waitcnt vmcnt(6)
L_sw15_0:
    s_add_u32 m0, s57, 24576
    s_add_u32 s39, s69, 1048576
    buffer_load_dwordx4 v60, s[12:15], s39 offen  lds
    s_cbranch_vccz L_sw15_1
    s_waitcnt vmcnt(6)
L_sw15_1:
    s_add_u32 m0, s57, 25600
    s_add_u32 s39, s69, 1064960
    buffer_load_dwordx4 v60, s[12:15], s39 offen  lds
    s_cbranch_vccz L_sw15_2
    s_waitcnt vmcnt(6)
L_sw15_2:
    s_add_u32 m0, s57, 26624
    s_add_u32 s39, s69, 1081344
    buffer_load_dwordx4 v61, s[12:15], s39 offen  lds
    s_cbranch_vccz L_sw15_3
    s_waitcnt vmcnt(6)
L_sw15_3:
    s_add_u32 m0, s57, 27648
    s_add_u32 s39, s69, 1097728
    buffer_load_dwordx4 v61, s[12:15], s39 offen  lds
    ds_read_b64_tr_b16 v[128:129], v68 offset:12288
    ds_read_b64_tr_b16 v[130:131], v68 offset:13312
    ds_read_b64_tr_b16 v[132:133], v70 offset:12288
    ds_read_b64_tr_b16 v[134:135], v70 offset:13312
    ds_read_b64_tr_b16 v[136:137], v69 offset:12288
    ds_read_b64_tr_b16 v[138:139], v69 offset:13312
    ds_read_b64_tr_b16 v[140:141], v71 offset:12288
    ds_read_b64_tr_b16 v[142:143], v71 offset:13312
    s_waitcnt vmcnt(8) lgkmcnt(0)
    s_barrier
    s_cbranch_vccz L_sw16_0
    s_waitcnt vmcnt(6)
L_sw16_0:
    s_add_u32 m0, s57, 28672
    s_add_u32 s39, s69, 0
    buffer_load_dwordx4 v60, s[12:15], s39 offen  lds
    s_cbranch_vccz L_sw16_1
    s_waitcnt vmcnt(6)
L_sw16_1:
    s_add_u32 m0, s57, 29696
    s_add_u32 s39, s69, 16384
    buffer_load_dwordx4 v60, s[12:15], s39 offen  lds
    s_cbranch_vccz L_sw16_2
    s_waitcnt vmcnt(6)
L_sw16_2:
    s_add_u32 m0, s57, 30720
    s_add_u32 s39, s69, 32768
    buffer_load_dwordx4 v61, s[12:15], s39 offen  lds
    s_cbranch_vccz L_sw16_3
    s_waitcnt vmcnt(6)
L_sw16_3:
    s_add_u32 m0, s57, 31744
    s_add_u32 s39, s69, 49152
    buffer_load_dwordx4 v61, s[12:15], s39 offen  lds
    ds_read_b64_tr_b16 v[144:145], v68 offset:16384
    ds_read_b64_tr_b16 v[146:147], v68 offset:17408
    ds_read_b64_tr_b16 v[148:149], v70 offset:16384
    ds_read_b64_tr_b16 v[150:151], v70 offset:17408
    ds_read_b64_tr_b16 v[152:153], v69 offset:16384
    ds_read_b64_tr_b16 v[154:155], v69 offset:17408
    ds_read_b64_tr_b16 v[156:157], v71 offset:16384
    ds_read_b64_tr_b16 v[158:159], v71 offset:17408
    s_waitcnt vmcnt(8) lgkmcnt(0)
    s_barrier
    s_cbranch_vccz L_sw17_0
    s_waitcnt vmcnt(6)
L_sw17_0:
    s_add_u32 m0, s57, 32768
    s_add_u32 s39, s69, 524288
    buffer_load_dwordx4 v60, s[12:15], s39 offen  lds
    s_cbranch_vccz L_sw17_1
    s_waitcnt vmcnt(6)
L_sw17_1:
    s_add_u32 m0, s57, 33792
    s_add_u32 s39, s69, 540672
    buffer_load_dwordx4 v60, s[12:15], s39 offen  lds
    s_cbranch_vccz L_sw17_2
    s_waitcnt vmcnt(6)
L_sw17_2:
    s_add_u32 m0, s57, 34816
    s_add_u32 s39, s69, 557056
    buffer_load_dwordx4 v61, s[12:15], s39 offen  lds
    s_cbranch_vccz L_sw17_3
    s_waitcnt vmcnt(6)
L_sw17_3:
    s_add_u32 m0, s57, 35840
    s_add_u32 s39, s69, 573440
    buffer_load_dwordx4 v61, s[12:15], s39 offen  lds
    ds_read_b64_tr_b16 v[160:161], v68 offset:20480
    ds_read_b64_tr_b16 v[162:163], v68 offset:21504
    ds_read_b64_tr_b16 v[164:165], v70 offset:20480
    ds_read_b64_tr_b16 v[166:167], v70 offset:21504
    ds_read_b64_tr_b16 v[168:169], v69 offset:20480
    ds_read_b64_tr_b16 v[170:171], v69 offset:21504
    ds_read_b64_tr_b16 v[172:173], v71 offset:20480
    ds_read_b64_tr_b16 v[174:175], v71 offset:21504
    s_waitcnt vmcnt(8) lgkmcnt(0)
    s_barrier
    s_cbranch_vccz L_sw18_0
    s_waitcnt vmcnt(6)
L_sw18_0:
    s_add_u32 m0, s57, 0
    s_add_u32 s39, s69, 2097152
    buffer_load_dwordx4 v62, s[12:15], s39 offen  lds
    s_cbranch_vccz L_sw18_1
    s_waitcnt vmcnt(6)
L_sw18_1:
    s_add_u32 m0, s57, 1024
    s_add_u32 s39, s69, 2113536
    buffer_load_dwordx4 v62, s[12:15], s39 offen  lds
    s_cbranch_vccz L_sw18_2
    s_waitcnt vmcnt(6)
L_sw18_2:
    s_add_u32 m0, s57, 2048
    s_add_u32 s39, s69, 2129920
    buffer_load_dwordx4 v63, s[12:15], s39 offen  lds
    s_cbranch_vccz L_sw18_3
    s_waitcnt vmcnt(6)
L_sw18_3:
    s_add_u32 m0, s57, 3072
    s_add_u32 s39, s69, 2146304
    buffer_load_dwordx4 v63, s[12:15], s39 offen  lds
    ds_read_b64_tr_b16 a[0:1], v68 offset:24576
    ds_read_b64_tr_b16 a[2:3], v68 offset:25600
    ds_read_b64_tr_b16 a[4:5], v70 offset:24576
    ds_read_b64_tr_b16 a[6:7], v70 offset:25600
    ds_read_b64_tr_b16 a[8:9], v69 offset:24576
    ds_read_b64_tr_b16 a[10:11], v69 offset:25600
    ds_read_b64_tr_b16 a[12:13], v71 offset:24576
    ds_read_b64_tr_b16 a[14:15], v71 offset:25600
    s_waitcnt vmcnt(8) lgkmcnt(0)
    s_barrier
    s_cbranch_vccz L_sw19_0
    s_waitcnt vmcnt(6)
L_sw19_0:
    s_add_u32 m0, s57, 4096
    s_add_u32 s39, s70, 1572864
    buffer_load_dwordx4 v60, s[12:15], s39 offen  lds
    s_cbranch_vccz L_sw19_1
    s_waitcnt vmcnt(6)
L_sw19_1:
    s_add_u32 m0, s57, 5120
    s_add_u32 s39, s70, 1589248
    buffer_load_dwordx4 v60, s[12:15], s39 offen  lds
    s_cbranch_vccz L_sw19_2
    s_waitcnt vmcnt(6)
L_sw19_2:
    s_add_u32 m0, s57, 6144
    s_add_u32 s39, s70, 1605632
    buffer_load_dwordx4 v61, s[12:15], s39 offen  lds
    s_cbranch_vccz L_sw19_3
    s_waitcnt vmcnt(6)
L_sw19_3:
    s_add_u32 m0, s57, 7168
    s_add_u32 s39, s70, 1622016
    buffer_load_dwordx4 v61, s[12:15], s39 offen  lds
    ds_read_b64_tr_b16 a[16:17], v68 offset:28672
    ds_read_b64_tr_b16 a[18:19], v68 offset:29696
    ds_read_b64_tr_b16 a[20:21], v70 offset:28672
    ds_read_b64_tr_b16 a[22:23], v70 offset:29696
    ds_read_b64_tr_b16 a[24:25], v69 offset:28672
    ds_read_b64_tr_b16 a[26:27], v69 offset:29696
    ds_read_b64_tr_b16 a[28:29], v71 offset:28672
    ds_read_b64_tr_b16 a[30:31], v71 offset:29696
    s_waitcnt vmcnt(8) lgkmcnt(0)
    s_barrier
    s_cbranch_vccz L_sw20_0
    s_waitcnt vmcnt(6)
L_sw20_0:
    s_add_u32 m0, s57, 8192
    s_add_u32 s39, s70, 524288
    buffer_load_dwordx4 v60, s[12:15], s39 offen  lds
    s_cbranch_vccz L_sw20_1
    s_waitcnt vmcnt(6)
L_sw20_1:
    s_add_u32 m0, s57, 9216
    s_add_u32 s39, s70, 540672
    buffer_load_dwordx4 v60, s[12:15], s39 offen  lds
    s_cbranch_vccz L_sw20_2
    s_waitcnt vmcnt(6)
L_sw20_2:
    s_add_u32 m0, s57, 10240
    s_add_u32 s39, s70, 557056
    buffer_load_dwordx4 v61, s[12:15], s39 offen  lds
    s_cbranch_vccz L_sw20_3
    s_waitcnt vmcnt(6)
L_sw20_3:
    s_add_u32 m0, s57, 11264
    s_add_u32 s39, s70, 573440
    buffer_load_dwordx4 v61, s[12:15], s39 offen  lds
    ds_read_b64_tr_b16 a[32:33], v68 offset:32768
    ds_read_b64_tr_b16 a[34:35], v68 offset:33792
    ds_read_b64_tr_b16 a[36:37], v70 offset:32768
    ds_read_b64_tr_b16 a[38:39], v70 offset:33792
    ds_read_b64_tr_b16 a[40:41], v69 offset:32768
    ds_read_b64_tr_b16 a[42:43], v69 offset:33792
    ds_read_b64_tr_b16 a[44:45], v71 offset:32768
    ds_read_b64_tr_b16 a[46:47], v71 offset:33792
    s_waitcnt vmcnt(8) lgkmcnt(0)
    s_barrier
    s_mov_b32 s12, s66
    s_and_b32 s13, s67, 0xffff
    s_mov_b32 s14, 0x500000
    s_mov_b32 s15, 0x00020000
    s_cbranch_vccz L_sw21_0
    s_waitcnt vmcnt(6)
L_sw21_0:
    s_add_u32 m0, s57, 12288
    s_add_u32 s39, s71, 0
    buffer_load_dwordx4 v64, s[12:15], s39 offen  lds
    s_cbranch_vccz L_sw21_1
    s_waitcnt vmcnt(6)
L_sw21_1:
    s_add_u32 m0, s57, 13312
    s_add_u32 s39, s71, 2560
    buffer_load_dwordx4 v64, s[12:15], s39 offen  lds
    s_cbranch_vccz L_sw21_2
    s_waitcnt vmcnt(6)
L_sw21_2:
    s_add_u32 m0, s57, 14336
    s_add_u32 s39, s71, 20480
    buffer_load_dwordx4 v65, s[12:15], s39 offen  lds
    s_cbranch_vccz L_sw21_3
    s_waitcnt vmcnt(6)
L_sw21_3:
    s_add_u32 m0, s57, 15360
    s_add_u32 s39, s71, 23040
    buffer_load_dwordx4 v65, s[12:15], s39 offen  lds
    ds_read_b64_tr_b16 a[48:49], v68 offset:0
    ds_read_b64_tr_b16 a[50:51], v68 offset:1024
    ds_read_b64_tr_b16 a[52:53], v70 offset:0
    ds_read_b64_tr_b16 a[54:55], v70 offset:1024
    ds_read_b64_tr_b16 a[56:57], v69 offset:0
    ds_read_b64_tr_b16 a[58:59], v69 offset:1024
    ds_read_b64_tr_b16 a[60:61], v71 offset:0
    ds_read_b64_tr_b16 a[62:63], v71 offset:1024
    s_waitcnt vmcnt(8) lgkmcnt(0)
    s_barrier
    s_cbranch_vccz L_sw22_0
    s_waitcnt vmcnt(6)
L_sw22_0:
    s_add_u32 m0, s57, 16384
    s_add_u32 s39, s71, 81920
    buffer_load_dwordx4 v64, s[12:15], s39 offen  lds
    s_cbranch_vccz L_sw22_1
    s_waitcnt vmcnt(6)
L_sw22_1:
    s_add_u32 m0, s57, 17408
    s_add_u32 s39, s71, 84480
    buffer_load_dwordx4 v64, s[12:15], s39 offen  lds
    s_cbranch_vccz L_sw22_2
    s_waitcnt vmcnt(6)
L_sw22_2:
    s_add_u32 m0, s57, 18432
    s_add_u32 s39, s71, 102400
    buffer_load_dwordx4 v65, s[12:15], s39 offen  lds
    s_cbranch_vccz L_sw22_3
    s_waitcnt vmcnt(6)
L_sw22_3:
    s_add_u32 m0, s57, 19456
    s_add_u32 s39, s71, 104960
    buffer_load_dwordx4 v65, s[12:15], s39 offen  lds
    ds_read_b64_tr_b16 v[84:85], v68 offset:4096
    ds_read_b64_tr_b16 v[86:87], v68 offset:5120
    ds_read_b64_tr_b16 v[88:89], v70 offset:4096
    ds_read_b64_tr_b16 v[90:91], v70 offset:5120
    ds_read_b64_tr_b16 a[64:65], v69 offset:4096
    ds_read_b64_tr_b16 a[66:67], v69 offset:5120
    ds_read_b64_tr_b16 a[68:69], v71 offset:4096
    ds_read_b64_tr_b16 a[70:71], v71 offset:5120
    s_waitcnt vmcnt(8) lgkmcnt(0)
    s_barrier
    s_cbranch_vccz L_sw23_0
    s_waitcnt vmcnt(6)
L_sw23_0:
    s_add_u32 m0, s57, 20480
    s_add_u32 s39, s71, 256
    buffer_load_dwordx4 v64, s[12:15], s39 offen  lds
    s_cbranch_vccz L_sw23_1
    s_waitcnt vmcnt(6)
L_sw23_1:
    s_add_u32 m0, s57, 21504
    s_add_u32 s39, s71, 2816
    buffer_load_dwordx4 v64, s[12:15], s39 offen  lds
    s_cbranch_vccz L_sw23_2
    s_waitcnt vmcnt(6)
L_sw23_2:
    s_add_u32 m0, s57, 22528
    s_add_u32 s39, s71, 20736
    buffer_load_dwordx4 v65, s[12:15], s39 offen  lds
    s_cbranch_vccz L_sw23_3
    s_waitcnt vmcnt(6)
L_sw23_3:
    s_add_u32 m0, s57, 23552
    s_add_u32 s39, s71, 23296
    buffer_load_dwordx4 v65, s[12:15], s39 offen  lds
    ds_write_b128 v9, v[84:87] offset:36864
    ds_write_b128 v9, v[88:91] offset:37888
    ds_read_b64_tr_b16 a[72:73], v68 offset:8192
    ds_read_b64_tr_b16 a[74:75], v68 offset:9216
    ds_read_b64_tr_b16 a[76:77], v70 offset:8192
    ds_read_b64_tr_b16 a[78:79], v70 offset:9216
    ds_read_b64_tr_b16 a[80:81], v69 offset:8192
    ds_read_b64_tr_b16 a[82:83], v69 offset:9216
    ds_read_b64_tr_b16 a[84:85], v71 offset:8192
    ds_read_b64_tr_b16 a[86:87], v71 offset:9216
    s_waitcnt vmcnt(8) lgkmcnt(0)
    s_barrier
    s_cbranch_vccz L_sw24_0
    s_waitcnt vmcnt(6)
L_sw24_0:
    s_add_u32 m0, s57, 24576
    s_add_u32 s39, s71, 82176
    buffer_load_dwordx4 v64, s[12:15], s39 offen  lds
    s_cbranch_vccz L_sw24_1
    s_waitcnt vmcnt(6)
L_sw24_1:
    s_add_u32 m0, s57, 25600
    s_add_u32 s39, s71, 84736
    buffer_load_dwordx4 v64, s[12:15], s39 offen  lds
    s_cbranch_vccz L_sw24_2
    s_waitcnt vmcnt(6)
L_sw24_2:
    s_add_u32 m0, s57, 26624
    s_add_u32 s39, s71, 102656
    buffer_load_dwordx4 v65, s[12:15], s39 offen  lds
    s_cbranch_vccz L_sw24_3
    s_waitcnt vmcnt(6)
L_sw24_3:
    s_add_u32 m0, s57, 27648
    s_add_u32 s39, s71, 105216
    buffer_load_dwordx4 v65, s[12:15], s39 offen  lds
    ds_read_b64_tr_b16 v[176:177], v68 offset:12288
    ds_read_b64_tr_b16 v[178:179], v68 offset:13312
    ds_read_b64_tr_b16 v[180:181], v70 offset:12288
    ds_read_b64_tr_b16 v[182:183], v70 offset:13312
    ds_read_b64_tr_b16 v[184:185], v69 offset:12288
    ds_read_b64_tr_b16 v[186:187], v69 offset:13312
    ds_read_b64_tr_b16 v[188:189], v71 offset:12288
    ds_read_b64_tr_b16 v[190:191], v71 offset:13312
    s_waitcnt vmcnt(8) lgkmcnt(0)
    s_barrier
    s_cbranch_vccz L_sw25_0
    s_waitcnt vmcnt(6)
L_sw25_0:
    s_add_u32 m0, s57, 28672
    s_add_u32 s39, s71, 512
    buffer_load_dwordx4 v66, s[12:15], s39 offen  lds
    s_cbranch_vccz L_sw25_1
    s_waitcnt vmcnt(6)
L_sw25_1:
    s_add_u32 m0, s57, 29696
    s_add_u32 s39, s71, 3072
    buffer_load_dwordx4 v66, s[12:15], s39 offen  lds
    s_cbranch_vccz L_sw25_2
    s_waitcnt vmcnt(6)
L_sw25_2:
    s_add_u32 m0, s57, 30720
    s_add_u32 s39, s71, 20992
    buffer_load_dwordx4 v67, s[12:15], s39 offen  lds
    s_cbranch_vccz L_sw25_3
    s_waitcnt vmcnt(6)
L_sw25_3:
    s_add_u32 m0, s57, 31744
    s_add_u32 s39, s71, 23552
    buffer_load_dwordx4 v67, s[12:15], s39 offen  lds
    ds_read_b64_tr_b16 v[192:193], v68 offset:16384
    ds_read_b64_tr_b16 v[194:195], v68 offset:17408
    ds_read_b64_tr_b16 v[196:197], v70 offset:16384
    ds_read_b64_tr_b16 v[198:199], v70 offset:17408
    ds_read_b64_tr_b16 v[200:201], v69 offset:16384
    ds_read_b64_tr_b16 v[202:203], v69 offset:17408
    ds_read_b64_tr_b16 v[204:205], v71 offset:16384
    ds_read_b64_tr_b16 v[206:207], v71 offset:17408
    s_waitcnt vmcnt(8) lgkmcnt(0)
    s_barrier
    s_mov_b32 s12, s60
    s_and_b32 s13, s61, 0xffff
    s_mov_b32 s14, 0x500000
    s_mov_b32 s15, 0x00020000
    s_cbranch_vccz L_sw26_0
    s_waitcnt vmcnt(6)
L_sw26_0:
    s_add_u32 m0, s57, 32768
    s_add_u32 s39, s69, 1572864
    buffer_load_dwordx4 v60, s[12:15], s39 offen  lds
    s_cbranch_vccz L_sw26_1
    s_waitcnt vmcnt(6)
L_sw26_1:
    s_add_u32 m0, s57, 33792
    s_add_u32 s39, s69, 1589248
    buffer_load_dwordx4 v60, s[12:15], s39 offen  lds
    s_cbranch_vccz L_sw26_2
    s_waitcnt vmcnt(6)
L_sw26_2:
    s_add_u32 m0, s57, 34816
    s_add_u32 s39, s69, 1605632
    buffer_load_dwordx4 v61, s[12:15], s39 offen  lds
    s_cbranch_vccz L_sw26_3
    s_waitcnt vmcnt(6)
L_sw26_3:
    s_add_u32 m0, s57, 35840
    s_add_u32 s39, s69, 1622016
    buffer_load_dwordx4 v61, s[12:15], s39 offen  lds
    ds_read_b64_tr_b16 v[208:209], v68 offset:20480
    ds_read_b64_tr_b16 v[210:211], v68 offset:21504
    ds_read_b64_tr_b16 v[212:213], v70 offset:20480
    ds_read_b64_tr_b16 v[214:215], v70 offset:21504
    ds_read_b64_tr_b16 v[216:217], v69 offset:20480
    ds_read_b64_tr_b16 v[218:219], v69 offset:21504
    ds_read_b64_tr_b16 v[220:221], v71 offset:20480
    ds_read_b64_tr_b16 v[222:223], v71 offset:21504
    s_waitcnt vmcnt(8) lgkmcnt(0)
    s_barrier
    buffer_load_dword v72, off, s[16:19], 0 offset:96 sc1
    buffer_load_dword v73, off, s[16:19], 0 offset:0 sc1
    buffer_load_dword v74, off, s[16:19], 0 offset:64 sc1
    s_cbranch_vccz L_sw27_0
    s_waitcnt vmcnt(6)
L_sw27_0:
    s_add_u32 m0, s57, 0
    s_add_u32 s39, s70, 1048576
    buffer_load_dwordx4 v60, s[12:15], s39 offen  lds
    s_cbranch_vccz L_sw27_1
    s_waitcnt vmcnt(6)
L_sw27_1:
    s_add_u32 m0, s57, 1024
    s_add_u32 s39, s70, 1064960
    buffer_load_dwordx4 v60, s[12:15], s39 offen  lds
    s_cbranch_vccz L_sw27_2
    s_waitcnt vmcnt(6)
L_sw27_2:
    s_add_u32 m0, s57, 2048
    s_add_u32 s39, s70, 1081344
    buffer_load_dwordx4 v61, s[12:15], s39 offen  lds
    s_cbranch_vccz L_sw27_3
    s_waitcnt vmcnt(6)
L_sw27_3:
    s_add_u32 m0, s57, 3072
    s_add_u32 s39, s70, 1097728
    buffer_load_dwordx4 v61, s[12:15], s39 offen  lds
    ds_read_b64_tr_b16 v[224:225], v68 offset:24576
    ds_read_b64_tr_b16 v[226:227], v68 offset:25600
    ds_read_b64_tr_b16 v[228:229], v70 offset:24576
    ds_read_b64_tr_b16 v[230:231], v70 offset:25600
    ds_read_b64_tr_b16 v[232:233], v69 offset:24576
    ds_read_b64_tr_b16 v[234:235], v69 offset:25600
    ds_read_b64_tr_b16 v[236:237], v71 offset:24576
    ds_read_b64_tr_b16 v[238:239], v71 offset:25600
    s_waitcnt vmcnt(11) lgkmcnt(0)
    s_barrier
    s_cbranch_vccz L_sw28_0
    s_waitcnt vmcnt(6)
L_sw28_0:
    s_add_u32 m0, s57, 4096
    s_add_u32 s39, s70, 0
    buffer_load_dwordx4 v60, s[12:15], s39 offen  lds
    s_cbranch_vccz L_sw28_1
    s_waitcnt vmcnt(6)
L_sw28_1:
    s_add_u32 m0, s57, 5120
    s_add_u32 s39, s70, 16384
    buffer_load_dwordx4 v60, s[12:15], s39 offen  lds
    s_cbranch_vccz L_sw28_2
    s_waitcnt vmcnt(6)
L_sw28_2:
    s_add_u32 m0, s57, 6144
    s_add_u32 s39, s70, 32768
    buffer_load_dwordx4 v61, s[12:15], s39 offen  lds
    s_cbranch_vccz L_sw28_3
    s_waitcnt vmcnt(6)
L_sw28_3:
    s_add_u32 m0, s57, 7168
    s_add_u32 s39, s70, 49152
    buffer_load_dwordx4 v61, s[12:15], s39 offen  lds
    ds_read_b64_tr_b16 v[240:241], v68 offset:28672
    ds_read_b64_tr_b16 v[242:243], v68 offset:29696
    ds_read_b64_tr_b16 v[244:245], v70 offset:28672
    ds_read_b64_tr_b16 v[246:247], v70 offset:29696
    ds_read_b64_tr_b16 v[248:249], v69 offset:28672
    ds_read_b64_tr_b16 v[250:251], v69 offset:29696
    ds_read_b64_tr_b16 v[252:253], v71 offset:28672
    ds_read_b64_tr_b16 v[254:255], v71 offset:29696
    s_waitcnt vmcnt(11) lgkmcnt(0)
    s_barrier
    s_cbranch_vccz L_sw29_0
    s_waitcnt vmcnt(6)
L_sw29_0:
    s_add_u32 m0, s57, 8192
    s_add_u32 s39, s70, 2097152
    buffer_load_dwordx4 v62, s[12:15], s39 offen  lds
    s_cbranch_vccz L_sw29_1
    s_waitcnt vmcnt(6)
L_sw29_1:
    s_add_u32 m0, s57, 9216
    s_add_u32 s39, s70, 2113536
    buffer_load_dwordx4 v62, s[12:15], s39 offen  lds
    s_cbranch_vccz L_sw29_2
    s_waitcnt vmcnt(6)
L_sw29_2:
    s_add_u32 m0, s57, 10240
    s_add_u32 s39, s70, 2129920
    buffer_load_dwordx4 v63, s[12:15], s39 offen  lds
    s_cbranch_vccz L_sw29_3
    s_waitcnt vmcnt(6)
L_sw29_3:
    s_add_u32 m0, s57, 11264
    s_add_u32 s39, s70, 2146304
    buffer_load_dwordx4 v63, s[12:15], s39 offen  lds
    ds_read_b64_tr_b16 v[40:41], v68 offset:32768
    ds_read_b64_tr_b16 v[42:43], v68 offset:33792
    ds_read_b64_tr_b16 v[44:45], v70 offset:32768
    ds_read_b64_tr_b16 v[46:47], v70 offset:33792
    ds_read_b64_tr_b16 v[48:49], v69 offset:32768
    ds_read_b64_tr_b16 v[50:51], v69 offset:33792
    ds_read_b64_tr_b16 v[52:53], v71 offset:32768
    ds_read_b64_tr_b16 v[54:55], v71 offset:33792
    s_waitcnt vmcnt(8) lgkmcnt(0)
    s_barrier
    s_mov_b32 s12, s64
    s_and_b32 s13, s65, 0xffff
    s_mov_b32 s14, 0x500000
    s_mov_b32 s15, 0x00020000
    s_cbranch_vccz L_sw30_0
    s_waitcnt vmcnt(6)
L_sw30_0:
    s_add_u32 m0, s57, 12288
    s_add_u32 s39, s69, 1048576
    buffer_load_dwordx4 v60, s[12:15], s39 offen  lds
    s_cbranch_vccz L_sw30_1
    s_waitcnt vmcnt(6)
L_sw30_1:
    s_add_u32 m0, s57, 13312
    s_add_u32 s39, s69, 1064960
    buffer_load_dwordx4 v60, s[12:15], s39 offen  lds
    s_cbranch_vccz L_sw30_2
    s_waitcnt vmcnt(6)
L_sw30_2:
    s_add_u32 m0, s57, 14336
    s_add_u32 s39, s69, 1081344
    buffer_load_dwordx4 v61, s[12:15], s39 offen  lds
    s_cbranch_vccz L_sw30_3
    s_waitcnt vmcnt(6)
L_sw30_3:
    s_add_u32 m0, s57, 15360
    s_add_u32 s39, s69, 1097728
    buffer_load_dwordx4 v61, s[12:15], s39 offen  lds
    ds_write_b128 v9, v[40:43] offset:32768
    ds_write_b128 v9, v[44:47] offset:33792
    ds_write_b128 v9, v[48:51] offset:34816
    ds_write_b128 v9, v[52:55] offset:35840
    ds_read_b64_tr_b16 v[84:85], v68 offset:0
    ds_read_b64_tr_b16 v[86:87], v68 offset:1024
    ds_read_b64_tr_b16 v[88:89], v70 offset:0
    ds_read_b64_tr_b16 v[90:91], v70 offset:1024
    ds_read_b64_tr_b16 v[92:93], v69 offset:0
    ds_read_b64_tr_b16 v[94:95], v69 offset:1024
    ds_read_b64_tr_b16 v[96:97], v71 offset:0
    ds_read_b64_tr_b16 v[98:99], v71 offset:1024
    s_waitcnt vmcnt(8) lgkmcnt(0)
    s_barrier
    s_branch L_ic
L_iw:
    buffer_load_dword v72, off, s[16:19], 0 offset:96 sc1
    s_add_u32 s34, s34, 1
    s_cmp_gt_u32 s34, 400000
    s_cbranch_scc1 L_fail
    s_waitcnt vmcnt(0)
L_ic:
    v_readfirstlane_b32 s38, v72
    s_and_b32 s39, s38, 0xffff
    s_cmp_lt_u32 s39, 64
    s_cbranch_scc1 L_iw
    s_lshr_b32 s38, s38, 16
    s_cmp_gt_u32 s38, 32
    s_cselect_b32 s38, 8192, 0
    s_add_u32 s49, s49, s38
    s_add_u32 s27, s27, s38
    s_xor_b32 s25, s27, 0x100000
    s_add_u32 s26, s25, 4096
    s_cmp_eq_u32 s36, 0
    s_cbranch_scc1 L_np0
    s_xor_b32 s40, s32, s41
    buffer_store_dword v14, v4, s[8:11], s23 offen sc1
    buffer_store_dword v14, v4, s[8:11], s27 offen sc1
    buffer_load_dwordx4 v[16:19], v0, s[8:11], s32 offen offset:0 sc1
    buffer_load_dwordx4 v[16:19], v0, s[8:11], s32 offen offset:1024 sc1
    buffer_load_dwordx4 v[16:19], v0, s[8:11], s40 offen offset:0 sc1
    buffer_load_dwordx4 v[16:19], v0, s[8:11], s40 offen offset:1024 sc1
L_np0:
    s_cbranch_vccz L_sw31_0
    s_waitcnt vmcnt(6)
L_sw31_0:
    s_add_u32 m0, s57, 16384
    s_add_u32 s39, s69, 1572864
    buffer_load_dwordx4 v60, s[12:15], s39 offen  lds
    s_cbranch_vccz L_sw31_1
    s_waitcnt vmcnt(6)
L_sw31_1:
    s_add_u32 m0, s57, 17408
    s_add_u32 s39, s69, 1589248
    buffer_load_dwordx4 v60, s[12:15], s39 offen  lds
    s_cbranch_vccz L_sw31_2
    s_waitcnt vmcnt(6)
L_sw31_2:
    s_add_u32 m0, s57, 18432
    s_add_u32 s39, s69, 1605632
    buffer_load_dwordx4 v61, s[12:15], s39 offen  lds
    s_cbranch_vccz L_sw31_3
    s_waitcnt vmcnt(6)
L_sw31_3:
    s_add_u32 m0, s57, 19456
    s_add_u32 s39, s69, 1622016
    buffer_load_dwordx4 v61, s[12:15], s39 offen  lds
    ds_write_b128 v9, v[84:87] offset:0
    ds_write_b128 v9, v[88:91] offset:1024
    ds_write_b128 v9, v[92:95] offset:2048
    ds_write_b128 v9, v[96:99] offset:3072
    ds_read_b64_tr_b16 v[40:41], v68 offset:4096
    ds_read_b64_tr_b16 v[42:43], v68 offset:5120
    ds_read_b64_tr_b16 v[44:45], v70 offset:4096
    ds_read_b64_tr_b16 v[46:47], v70 offset:5120
    ds_read_b64_tr_b16 v[48:49], v69 offset:4096
    ds_read_b64_tr_b16 v[50:51], v69 offset:5120
    ds_read_b64_tr_b16 v[52:53], v71 offset:4096
    ds_read_b64_tr_b16 v[54:55], v71 offset:5120
    s_waitcnt vmcnt(8) lgkmcnt(0)
    s_barrier
    s_cbranch_vccz L_sw32_0
    s_waitcnt vmcnt(6)
L_sw32_0:
    s_add_u32 m0, s57, 20480
    s_add_u32 s39, s69, 0
    buffer_load_dwordx4 v60, s[12:15], s39 offen  lds
    s_cbranch_vccz L_sw32_1
    s_waitcnt vmcnt(6)
L_sw32_1:
    s_add_u32 m0, s57, 21504
    s_add_u32 s39, s69, 16384
    buffer_load_dwordx4 v60, s[12:15], s39 offen  lds
    s_cbranch_vccz L_sw32_2
    s_waitcnt vmcnt(6)
L_sw32_2:
    s_add_u32 m0, s57, 22528
    s_add_u32 s39, s69, 32768
    buffer_load_dwordx4 v61, s[12:15], s39 offen  lds
    s_cbranch_vccz L_sw32_3
    s_waitcnt vmcnt(6)
L_sw32_3:
    s_add_u32 m0, s57, 23552
    s_add_u32 s39, s69, 49152
    buffer_load_dwordx4 v61, s[12:15], s39 offen  lds
    ds_write_b128 v9, v[40:43] offset:4096
    ds_write_b128 v9, v[44:47] offset:5120
    ds_write_b128 v9, v[48:51] offset:6144
    ds_write_b128 v9, v[52:55] offset:7168
    ds_read_b64_tr_b16 v[84:85], v68 offset:8192
    ds_read_b64_tr_b16 v[86:87], v68 offset:9216
    ds_read_b64_tr_b16 v[88:89], v70 offset:8192
    ds_read_b64_tr_b16 v[90:91], v70 offset:9216
    ds_read_b64_tr_b16 v[92:93], v69 offset:8192
    ds_read_b64_tr_b16 v[94:95], v69 offset:9216
    ds_read_b64_tr_b16 v[96:97], v71 offset:8192
    ds_read_b64_tr_b16 v[98:99], v71 offset:9216
    s_waitcnt vmcnt(8) lgkmcnt(0)
    s_barrier
    s_cbranch_vccz L_sw33_0
    s_waitcnt vmcnt(6)
L_sw33_0:
    s_add_u32 m0, s57, 24576
    s_add_u32 s39, s69, 524288
    buffer_load_dwordx4 v60, s[12:15], s39 offen  lds
    s_cbranch_vccz L_sw33_1
    s_waitcnt vmcnt(6)
L_sw33_1:
    s_add_u32 m0, s57, 25600
    s_add_u32 s39, s69, 540672
    buffer_load_dwordx4 v60, s[12:15], s39 offen  lds
    s_cbranch_vccz L_sw33_2
    s_waitcnt vmcnt(6)
L_sw33_2:
    s_add_u32 m0, s57, 26624
    s_add_u32 s39, s69, 557056
    buffer_load_dwordx4 v61, s[12:15], s39 offen  lds
    s_cbranch_vccz L_sw33_3
    s_waitcnt vmcnt(6)
L_sw33_3:
    s_add_u32 m0, s57, 27648
    s_add_u32 s39, s69, 573440
    buffer_load_dwordx4 v61, s[12:15], s39 offen  lds
    s_getpc_b64 s[74:75]
    v_lshlrev_b32 v24, 3, v0
    v_min_u32 v24, L_done-.-16, v24
    global_load_dword v25, v24, s[74:75]
    ds_write_b128 v9, v[84:87] offset:8192
    ds_write_b128 v9, v[88:91] offset:9216
    ds_write_b128 v9, v[92:95] offset:10240
    ds_write_b128 v9, v[96:99] offset:11264
    ds_read_b64_tr_b16 v[40:41], v68 offset:12288
    ds_read_b64_tr_b16 v[42:43], v68 offset:13312
    ds_read_b64_tr_b16 v[44:45], v70 offset:12288
    ds_read_b64_tr_b16 v[46:47], v70 offset:13312
    ds_read_b64_tr_b16 v[48:49], v69 offset:12288
    ds_read_b64_tr_b16 v[50:51], v69 offset:13312
    ds_read_b64_tr_b16 v[52:53], v71 offset:12288
    ds_read_b64_tr_b16 v[54:55], v71 offset:13312
    s_waitcnt vmcnt(9) lgkmcnt(0)
    s_barrier
    s_lshl_b32 s38, s21, 7
    s_add_u32 s38, s38, 90177536
    s_add_u32 s84, s8, s38
    s_addc_u32 s85, s9, 0
    s_add_u32 s39, s38, 0
    buffer_load_dword v76, off, s[8:11], s39 sc1
    s_add_u32 s39, s38, 4096
    buffer_load_dword v77, off, s[8:11], s39 sc1
    s_add_u32 s39, s38, 12288
    buffer_load_dword v78, off, s[8:11], s39 sc1
    s_add_u32 s39, s38, 16384
    buffer_load_dword v79, off, s[8:11], s39 sc1
    s_cbranch_vccz L_sw34_0
    s_waitcnt vmcnt(6)
L_sw34_0:
    s_add_u32 m0, s57, 28672
    s_add_u32 s39, s69, 2097152
    buffer_load_dwordx4 v62, s[12:15], s39 offen  lds
    s_cbranch_vccz L_sw34_1
    s_waitcnt vmcnt(6)
L_sw34_1:
    s_add_u32 m0, s57, 29696
    s_add_u32 s39, s69, 2113536
    buffer_load_dwordx4 v62, s[12:15], s39 offen  lds
    s_cbranch_vccz L_sw34_2
    s_waitcnt vmcnt(6)
L_sw34_2:
    s_add_u32 m0, s57, 30720
    s_add_u32 s39, s69, 2129920
    buffer_load_dwordx4 v63, s[12:15], s39 offen  lds
    s_cbranch_vccz L_sw34_3
    s_waitcnt vmcnt(6)
L_sw34_3:
    s_add_u32 m0, s57, 31744
    s_add_u32 s39, s69, 2146304
    buffer_load_dwordx4 v63, s[12:15], s39 offen  lds
    ds_write_b128 v9, v[40:43] offset:12288
    ds_write_b128 v9, v[44:47] offset:13312
    ds_write_b128 v9, v[48:51] offset:14336
    ds_write_b128 v9, v[52:55] offset:15360
    ds_read_b64_tr_b16 v[84:85], v68 offset:16384
    ds_read_b64_tr_b16 v[86:87], v68 offset:17408
    ds_read_b64_tr_b16 v[88:89], v70 offset:16384
    ds_read_b64_tr_b16 v[90:91], v70 offset:17408
    ds_read_b64_tr_b16 v[92:93], v69 offset:16384
    ds_read_b64_tr_b16 v[94:95], v69 offset:17408
    ds_read_b64_tr_b16 v[96:97], v71 offset:16384
    ds_read_b64_tr_b16 v[98:99], v71 offset:17408
    s_waitcnt vmcnt(13) lgkmcnt(0)
    s_barrier
    ds_write_b128 v9, v[84:87] offset:16384
    ds_write_b128 v9, v[88:91] offset:17408
    ds_write_b128 v9, v[92:95] offset:18432
    ds_write_b128 v9, v[96:99] offset:19456
    ds_read_b64_tr_b16 v[40:41], v68 offset:20480
    ds_read_b64_tr_b16 v[42:43], v68 offset:21504
    ds_read_b64_tr_b16 v[44:45], v70 offset:20480
    ds_read_b64_tr_b16 v[46:47], v70 offset:21504
    ds_read_b64_tr_b16 v[48:49], v69 offset:20480
    ds_read_b64_tr_b16 v[50:51], v69 offset:21504
    ds_read_b64_tr_b16 v[52:53], v71 offset:20480
    ds_read_b64_tr_b16 v[54:55], v71 offset:21504
    s_waitcnt vmcnt(9) lgkmcnt(0)
    s_barrier
    ds_write_b128 v9, v[40:43] offset:20480
    ds_write_b128 v9, v[44:47] offset:21504
    ds_write_b128 v9, v[48:51] offset:22528
    ds_write_b128 v9, v[52:55] offset:23552
    ds_read_b64_tr_b16 v[84:85], v68 offset:24576
    ds_read_b64_tr_b16 v[86:87], v68 offset:25600
    ds_read_b64_tr_b16 v[88:89], v70 offset:24576
    ds_read_b64_tr_b16 v[90:91], v70 offset:25600
    ds_read_b64_tr_b16 v[92:93], v69 offset:24576
    ds_read_b64_tr_b16 v[94:95], v69 offset:25600
    ds_read_b64_tr_b16 v[96:97], v71 offset:24576
    ds_read_b64_tr_b16 v[98:99], v71 offset:25600
    s_waitcnt vmcnt(0) lgkmcnt(0)
    s_barrier
    ds_write_b128 v9, v[84:87] offset:24576
    ds_write_b128 v9, v[88:91] offset:25600
    ds_write_b128 v9, v[92:95] offset:26624
    ds_write_b128 v9, v[96:99] offset:27648
    ds_read_b64_tr_b16 v[40:41], v68 offset:28672
    ds_read_b64_tr_b16 v[42:43], v68 offset:29696
    ds_read_b64_tr_b16 v[44:45], v70 offset:28672
    ds_read_b64_tr_b16 v[46:47], v70 offset:29696
    ds_read_b64_tr_b16 v[48:49], v69 offset:28672
    ds_read_b64_tr_b16 v[50:51], v69 offset:29696
    ds_read_b64_tr_b16 v[52:53], v71 offset:28672
    ds_read_b64_tr_b16 v[54:55], v71 offset:29696
    s_waitcnt lgkmcnt(0)
    s_barrier
    ds_write_b128 v9, v[40:43] offset:28672
    ds_write_b128 v9, v[44:47] offset:29696
    ds_write_b128 v9, v[48:51] offset:30720
    ds_write_b128 v9, v[52:55] offset:31744
    s_mov_b32 s12, s8
    s_mov_b32 s13, s9
    s_cmp_eq_u32 s36, 1
    s_cselect_b32 s14, 0x10000000, 0
    v_readfirstlane_b32 s86, v76
    v_readfirstlane_b32 s87, v77
    v_readfirstlane_b32 s88, v78
    v_readfirstlane_b32 s89, v79
L_kv0a:
    s_min_u32 s38, s86, s87
    s_min_u32 s39, s88, s89
    s_lshl_b32 s38, s38, 1
    s_lshl_b32 s39, s39, 1
    s_add_u32 s39, s39, 1
    s_min_u32 s47, s38, s39
    s_add_u32 s38, s33, 1
    s_min_u32 s38, s38, 63
    s_cmp_gt_u32 s47, s38
    s_cbranch_scc1 L_kv0d
L_kv0b:
    s_load_dword s86, s[84:85], 0 glc
    s_load_dword s87, s[84:85], 4096 glc
    s_load_dword s88, s[84:85], 12288 glc
    s_load_dword s89, s[84:85], 16384 glc
    s_add_u32 s34, s34, 1
    s_cmp_gt_u32 s34, 400000
    s_cbranch_scc1 L_fail
    s_waitcnt lgkmcnt(0)
    s_branch L_kv0a
L_kv0d:
L_kv0e:
    s_waitcnt lgkmcnt(0)
    s_mov_b32 s16, s8
    s_mov_b32 s17, s9
    s_cmp_eq_u32 s22, 3
    s_cselect_b32 s18, 0x10000000, 0
    s_lshl_b32 s39, s21, 2
    s_add_u32 s39, s39, s22
    s_cmp_ge_u32 s39, 80
    s_cselect_b32 s40, 80, 0
    s_sub_u32 s39, s39, s40
    s_lshl_b32 s82, s39, 6
    s_xor_b32 s40, s32, s41
    buffer_load_dwordx4 v[16:19], v0, s[12:15], s32 offen offset:0 sc1
    buffer_load_dwordx4 v[16:19], v0, s[12:15], s32 offen offset:1024 sc1
    buffer_load_dwordx4 v[16:19], v0, s[12:15], s40 offen offset:0 sc1
    buffer_load_dwordx4 v[16:19], v0, s[12:15], s40 offen offset:1024 sc1
    v_min_u32 v73, v73, v74
    s_nop 0
    v_readfirstlane_b32 s38, v73
    s_cmp_lt_u32 s38, 32
    s_cbranch_scc1 L_slowmode
    v_mov_b32 v41, 0
    v_mov_b32 v42, 0
    v_mov_b32 v43, 0
    v_mov_b32 v44, 0
    v_mov_b32 v45, 0
    v_mov_b32 v46, 0
    v_mov_b32 v47, 0
    v_mov_b32 v48, 0
    v_mov_b32 v49, 0
    v_mov_b32 v50, 0
    v_mov_b32 v51, 0
    v_mov_b32 v52, 0
    v_mov_b32 v53, 0
    v_mov_b32 v54, 0
    v_mov_b32 v55, 0
    v_mov_b32 v56, 0
    v_mov_b32 v57, 0
    v_mov_b32 v58, 0
    v_mov_b32 v59, 0
    v_mov_b32 v36, 0
    v_mov_b32 v37, 0
    v_mov_b32 v38, 0
    v_mov_b32 v39, 0
    v_mov_b32 v40, 0
    ds_read_b128 v[60:63], v9 offset:12288
    ds_read_b128 v[64:67], v9 offset:13312
    ds_read_b128 v[68:71], v9 offset:14336
    ds_read_b128 v[72:75], v9 offset:15360
    ds_read_b128 v[76:79], v9 offset:16384
    ds_read_b128 v[80:83], v9 offset:17408
    v_mov_b32 v12, -1
    v_mov_b32 v13, -1
    v_mov_b32 v14, -1
    v_mov_b32 v15, -1
    s_branch L_ent
    .p2align 6
L_top:
    s_barrier
    v_mov_b32 v12, -1
    v_mov_b32 v13, -1
    v_mov_b32 v14, -1
    v_mov_b32 v15, -1
    s_nop 15
    s_nop 15
    s_nop 15
    s_nop 1
L_ent:
    buffer_load_dwordx4 v[32:35], v0, s[8:11], s23 offen offset:2048
    s_nop 5
    buffer_load_dwordx4 v[84:87], v0, s[8:11], s23 offen offset:3072
    s_nop 5
    buffer_load_dwordx4 v[88:91], v0, s[8:11], s23 offen offset:0
    s_nop 9
    buffer_load_dwordx4 v[92:95], v0, s[8:11], s23 offen offset:1024
    s_nop 5
    buffer_load_dwordx4 v[96:99], v0, s[8:11], s24 offen offset:0
    buffer_store_dwordx4 v[12:15], v0, s[12:15], s32 offen offset:0
    s_waitcnt vmcnt(5)
    v_cmp_u_f32 vcc, v32, v35
    s_cbranch_vccnz L_rt0
L_ok0:
    s_waitcnt lgkmcnt(4)
    v_smfmac_f32_16x16x64_bf16 v[52:55], v[32:35], v[60:67], v1
    ds_read_b128 v[60:63], v9 offset:18432
    v_smfmac_f32_16x16x64_bf16 v[36:39], v[32:35], a[0:7], v1
    ds_read_b128 v[64:67], v9 offset:19456
    buffer_load_dwordx4 v[16:19], v0, s[8:11], s25 offen offset:2048
    v_smfmac_f32_16x16x64_bf16 v[44:47], v[32:35], a[88:95], v1
    s_waitcnt lgkmcnt(4) vmcnt(5)
    v_cmp_u_f32 vcc, v84, v87
    v_smfmac_f32_16x16x64_bf16 v[56:59], v[32:35], v[68:75], v1
    ds_read_b128 v[68:71], v9 offset:32768
    buffer_load_dwordx4 v[20:23], v0, s[8:11], s25 offen offset:3072
    v_smfmac_f32_16x16x64_bf16 v[40:43], v[32:35], a[8:15], v1
    s_cbranch_vccnz L_rt1
L_ok1:
    ds_read_b128 v[72:75], v9 offset:33792
    s_waitcnt lgkmcnt(4)
    v_smfmac_f32_16x16x64_bf16 v[52:55], v[84:87], v[76:83], v1
    ds_read_b128 v[76:79], v9 offset:34816
    v_smfmac_f32_16x16x64_bf16 v[48:51], v[32:35], a[96:103], v1
    ds_read_b128 v[80:83], v9 offset:35840
    v_smfmac_f32_16x16x64_bf16 v[44:47], v[84:87], a[104:111], v1
    buffer_load_dwordx4 v[24:27], v0, s[8:11], s25 offen offset:0
    s_waitcnt lgkmcnt(4)
    v_smfmac_f32_16x16x64_bf16 v[56:59], v[84:87], v[60:67], v1
    ds_read_b128 v[60:63], v9 offset:20480
    s_waitcnt vmcnt(6)
    v_cmp_u_f32 vcc, v88, v91
    v_smfmac_f32_16x16x64_bf16 v[48:51], v[84:87], a[112:119], v1
    ds_read_b128 v[64:67], v9 offset:21504
    s_waitcnt lgkmcnt(4)
    v_smfmac_f32_16x16x64_bf16 v[36:39], v[84:87], v[68:75], v1
    s_cbranch_vccnz L_rt2
L_ok2:
    ds_read_b128 v[68:71], v9 offset:22528
    v_smfmac_f32_16x16x64_bf16 v[36:39], v[88:91], a[16:23], v1
    ds_read_b128 v[72:75], v9 offset:23552
    buffer_load_dwordx4 v[28:31], v0, s[8:11], s25 offen offset:1024
    v_smfmac_f32_16x16x64_bf16 v[44:47], v[88:91], a[120:127], v1
    s_waitcnt lgkmcnt(4)
    v_smfmac_f32_16x16x64_bf16 v[40:43], v[84:87], v[76:83], v1
    ds_read_b128 v[76:79], v9 offset:24576
    s_waitcnt vmcnt(6)
    v_cmp_u_f32 vcc, v92, v95
    v_smfmac_f32_16x16x64_bf16 v[40:43], v[88:91], a[24:31], v1
    ds_read_b128 v[80:83], v9 offset:25600
    s_waitcnt lgkmcnt(4)
    v_smfmac_f32_16x16x64_bf16 v[52:55], v[88:91], v[60:67], v1
    ds_read_b128 v[60:63], v9 offset:26624
    buffer_load_dwordx4 v[32:35], v0, s[8:11], s26 offen offset:0
    v_smfmac_f32_16x16x64_bf16 v[48:51], v[88:91], a[128:135], v1
    s_cbranch_vccnz L_rt3
L_ok3:
    ds_read_b128 v[64:67], v9 offset:27648
    v_smfmac_f32_16x16x64_bf16 v[36:39], v[92:95], a[32:39], v1
    s_waitcnt lgkmcnt(4)
    v_smfmac_f32_16x16x64_bf16 v[56:59], v[88:91], v[68:75], v1
    ds_read_b128 v[68:71], v9 offset:28672
    buffer_load_dwordx4 v[84:87], v0, s[8:11], s30 offen offset:0 sc1
    v_smfmac_f32_16x16x64_bf16 v[44:47], v[92:95], a[136:143], v1
    ds_read_b128 v[72:75], v9 offset:29696
    buffer_load_dwordx4 v[88:91], v0, s[8:11], s30 offen offset:1024 sc1
    s_waitcnt lgkmcnt(4)
    v_smfmac_f32_16x16x64_bf16 v[52:55], v[92:95], v[76:83], v1
    ds_read_b128 v[76:79], v9 offset:30720
    v_smfmac_f32_16x16x64_bf16 v[40:43], v[92:95], a[40:47], v1
    ds_read_b128 v[80:83], v9 offset:31744
    v_smfmac_f32_16x16x64_bf16 v[48:51], v[92:95], a[144:151], v1
    s_waitcnt lgkmcnt(4)
    v_smfmac_f32_16x16x64_bf16 v[56:59], v[92:95], v[60:67], v1
    ds_read_b128 v[60:63], v9 offset:0
    s_waitcnt vmcnt(8)
    v_smfmac_f32_16x16x64_bf16 v[36:39], v[96:99], a[48:55], v1
    ds_read_b128 v[64:67], v9 offset:1024
    s_waitcnt lgkmcnt(4)
    v_smfmac_f32_16x16x64_bf16 v[52:55], v[96:99], v[68:75], v1
    ds_read_b128 v[68:71], v9 offset:2048
    v_smfmac_f32_16x16x64_bf16 v[44:47], v[96:99], a[152:159], v1
    ds_read_b128 v[72:75], v9 offset:3072
    buffer_load_dwordx4 v[92:95], v0, s[8:11], s30 offen offset:2048 sc1
    v_smfmac_f32_16x16x64_bf16 v[40:43], v[96:99], a[56:63], v1
    s_waitcnt lgkmcnt(4) vmcnt(7)
    v_cmp_u_f32 vcc, v16, v19
    v_smfmac_f32_16x16x64_bf16 v[56:59], v[96:99], v[76:83], v1
    ds_read_b128 v[76:79], v9 offset:36864
    v_smfmac_f32_16x16x64_bf16 v[48:51], v[96:99], a[160:167], v1
    s_cbranch_vccnz L_rt5
L_ok5:
    ds_read_b128 v[80:83], v9 offset:37888
    buffer_load_dwordx4 v[96:99], v0, s[8:11], s30 offen offset:3072 sc1
    v_smfmac_f32_16x16x64_bf16 v[44:47], v[16:19], a[168:175], v1
    s_waitcnt lgkmcnt(4)
    v_smfmac_f32_16x16x64_bf16 v[36:39], v[16:19], v[60:67], v1
    ds_read_b128 v[60:63], v9 offset:4096
    s_waitcnt vmcnt(7)
    v_cmp_u_f32 vcc, v20, v23
    v_smfmac_f32_16x16x64_bf16 v[48:51], v[16:19], a[176:183], v1
    ds_read_b128 v[64:67], v9 offset:5120
    s_waitcnt lgkmcnt(4)
    v_smfmac_f32_16x16x64_bf16 v[40:43], v[16:19], v[68:75], v1
    s_cbranch_vccnz L_rt6
L_ok6:
    ds_read_b128 v[68:71], v9 offset:6144
    v_smfmac_f32_16x16x64_bf16 v[44:47], v[20:23], a[184:191], v1
    ds_read_b128 v[72:75], v9 offset:7168
    v_smfmac_f32_16x16x64_bf16 v[40:43], v[20:23], a[64:71], v1
    buffer_store_dwordx4 v[12:15], v0, s[12:15], s32 offen offset:1024
    s_waitcnt lgkmcnt(4)
    v_smfmac_f32_16x16x64_bf16 v[36:39], v[20:23], v[76:83], v1
    ds_read_b128 v[76:79], v9 offset:8192
    v_smfmac_f32_16x16x64_bf16 v[48:51], v[20:23], a[192:199], v1
    ds_read_b128 v[80:83], v9 offset:9216
    s_waitcnt vmcnt(7)
    v_smfmac_f32_16x16x64_bf16 v[44:47], v[24:27], a[200:207], v1
    s_waitcnt lgkmcnt(4)
    v_smfmac_f32_16x16x64_bf16 v[36:39], v[24:27], v[60:67], v1
    ds_read_b128 v[60:63], v9 offset:10240
    v_smfmac_f32_16x16x64_bf16 v[48:51], v[24:27], a[208:215], v1
    ds_read_b128 v[64:67], v9 offset:11264
    s_waitcnt lgkmcnt(4)
    v_smfmac_f32_16x16x64_bf16 v[40:43], v[24:27], v[68:75], v1
    s_waitcnt vmcnt(6)
    v_smfmac_f32_16x16x64_bf16 v[36:39], v[28:31], a[72:79], v1
    v_smfmac_f32_16x16x64_bf16 v[44:47], v[28:31], a[216:223], v1
    v_smfmac_f32_16x16x64_bf16 v[40:43], v[28:31], a[80:87], v1
    buffer_load_dword v7, v5, s[8:11], s31 offen sc1
    v_smfmac_f32_16x16x64_bf16 v[48:51], v[28:31], a[224:231], v1
    s_add_u32 s31, s31, 540672
    s_waitcnt vmcnt(6) lgkmcnt(2)
    v_smfmac_f32_16x16x64_bf16 v[36:39], v[32:35], v[76:83], v1
    s_add_u32 s33, s33, 1
    v_smfmac_f32_16x16x64_bf16 v[44:47], v[32:35], a[232:239], v1
    s_waitcnt lgkmcnt(0)
    v_mov_b32 v15, s33
    v_smfmac_f32_16x16x64_bf16 v[40:43], v[32:35], v[60:67], v1
    buffer_store_dword v15, off, s[16:19], s49 sc1
    s_nop 0
    v_smfmac_f32_16x16x64_bf16 v[48:51], v[32:35], a[240:247], v1
    s_add_u32 s29, s28, 65536
    s_nop 2
    s_mov_b64 s[4:5], -1
L_again:
    v_pk_add_f32 v[36:37], v[36:37], v[38:39]
    v_pk_add_f32 v[44:45], v[44:45], v[46:47]
    v_pk_add_f32 v[40:41], v[40:41], v[42:43]
    v_pk_add_f32 v[48:49], v[48:49], v[50:51]
    v_cvt_pk_bf16_f32 v44, v44, v45
    v_cvt_pk_bf16_f32 v45, v36, v37
    v_cvt_pk_bf16_f32 v46, v48, v49
    v_cvt_pk_bf16_f32 v47, v40, v41
    v_mfma_f32_16x16x16_bf16 v[36:39], v[44:45], v[10:11], 0
    s_mov_b64 vcc, s[44:45]
    v_mfma_f32_16x16x16_bf16 v[40:43], v[46:47], v[10:11], 0
    v_cmp_u_f32 s[6:7], v48, v49
    v_mov_b32 v66, 0
    v_mov_b32 v67, 0
    v_mov_b32 v68, 0x3f803f80
    v_mov_b32 v69, 0x3f803f80
    s_waitcnt vmcnt(5)
    v_cvt_pk_bf16_f32 v48, v36, v37
    v_cvt_pk_bf16_f32 v49, v38, v39
    v_cvt_pk_bf16_f32 v50, v40, v41
    v_cvt_pk_bf16_f32 v51, v42, v43
    s_and_b64 s[6:7], s[6:7], s[4:5]
    s_cbranch_scc1 L_net
    v_mfma_f32_16x16x32_bf16 v[36:39], v[84:87], v[48:51], 0
    v_add_u32 v76, s48, v0
    v_mfma_f32_16x16x32_bf16 v[40:43], v[88:91], v[48:51], 0
    v_mov_b32 v63, 0
    v_mov_b32 v64, 0
    v_mfma_f32_16x16x32_bf16 v[44:47], v[48:51], v[48:51], 0
    v_xor_b32 v12, 1024, v6
    v_xor_b32 v13, 2048, v6
    v_smfmac_f32_16x16x64_bf16 v[52:55], v[16:19], a[248:255], v1
    s_add_u32 s30, s30, 540672
    s_nop 0
    v_cndmask_b32_dpp v48, v36, v40, vcc quad_perm:[2,3,0,1] row_mask:0xf bank_mask:0xf
    v_cndmask_b32_dpp v49, v37, v41, vcc quad_perm:[2,3,0,1] row_mask:0xf bank_mask:0xf
    v_cndmask_b32_dpp v50, v38, v42, vcc quad_perm:[2,3,0,1] row_mask:0xf bank_mask:0xf
    v_cndmask_b32_dpp v51, v39, v43, vcc quad_perm:[2,3,0,1] row_mask:0xf bank_mask:0xf
    ds_write_b128 v6, v[48:51]
    v_cndmask_b32_dpp v46, v44, v45, vcc quad_perm:[2,3,0,1] row_mask:0xf bank_mask:0xf
    ds_write_b32 v76, v46 offset:4096
    v_smfmac_f32_16x16x64_bf16 v[56:59], v[16:19], v[104:111], v1
    v_xor_b32 v14, 3072, v6
    v_smfmac_f32_16x16x64_bf16 v[52:55], v[20:23], v[112:119], v1
    v_smfmac_f32_16x16x64_bf16 v[56:59], v[20:23], v[120:127], v1
    v_smfmac_f32_16x16x64_bf16 v[52:55], v[24:27], v[128:135], v1
    s_waitcnt lgkmcnt(0)
    s_barrier
    ds_read_b128 v[84:87], v0 offset:4096
    ds_read_b128 v[36:39], v12
    ds_read_b128 v[40:43], v13
    ds_read_b128 v[44:47], v14
    v_smfmac_f32_16x16x64_bf16 v[56:59], v[24:27], v[136:143], v1
    v_smfmac_f32_16x16x64_bf16 v[52:55], v[28:31], v[144:151], v1
    v_smfmac_f32_16x16x64_bf16 v[56:59], v[28:31], v[152:159], v1
    v_smfmac_f32_16x16x64_bf16 v[52:55], v[32:35], v[160:167], v1
    v_smfmac_f32_16x16x64_bf16 v[56:59], v[32:35], v[168:175], v1
    s_waitcnt lgkmcnt(0)
    v_add_f32 v84, v84, v86
    v_add_f32 v85, v85, v87
    v_pk_add_f32 v[36:37], v[36:37], v[40:41]
    v_pk_add_f32 v[38:39], v[38:39], v[42:43]
    v_pk_add_f32 v[44:45], v[44:45], v[48:49]
    v_pk_add_f32 v[46:47], v[46:47], v[50:51]
    v_add_f32 v40, v84, v85
    v_pk_add_f32 v[36:37], v[36:37], v[44:45]
    v_pk_add_f32 v[38:39], v[38:39], v[46:47]
    v_max3_f32 v41, v36, v37, v40
    v_max3_f32 v41, v41, v38, v39
    v_pk_add_f32 v[52:53], v[52:53], v[54:55]
    v_pk_add_f32 v[56:57], v[56:57], v[58:59]
    v_max_f32_dpp v41, v41, v41 quad_perm:[2,3,0,1] row_mask:0xf bank_mask:0xf
    v_mov_b32 v42, v41
    v_cvt_pk_bf16_f32 v60, v52, v53
    v_cvt_pk_bf16_f32 v61, v56, v57
    v_permlane16_swap_b32 v41, v42
    v_max_f32 v41, v41, v42
    v_mov_b32 v42, v41
    s_waitcnt vmcnt(3)
    s_nop 0
    v_permlane32_swap_b32 v41, v42
    v_max_f32 v41, v41, v42
    v_mul_f32 v41, s37, v41
    v_fma_f32 v40, v40, s37, -v41
    v_fma_f32 v36, v36, s37, -v41
    v_fma_f32 v37, v37, s37, -v41
    v_fma_f32 v38, v38, s37, -v41
    v_fma_f32 v39, v39, s37, -v41
    v_exp_f32 v40, v40
    v_exp_f32 v36, v36
    v_exp_f32 v37, v37
    v_mov_b32_dpp v42, v40 quad_perm:[2,3,0,1] row_mask:0xf bank_mask:0xf
    v_exp_f32 v38, v38
    v_exp_f32 v39, v39
    v_cvt_pk_bf16_f32 v62, v40, v42
    v_cvt_pk_bf16_f32 v65, v40, v42
    v_cvt_pk_bf16_f32 v72, v36, v37
    v_cvt_pk_bf16_f32 v73, v38, v39
    v_mfma_f32_16x16x32_bf16 v[44:47], v[60:63], v[62:65], 0
    v_mov_b32_dpp v74, v72 quad_perm:[2,3,0,1] row_mask:0xf bank_mask:0xf
    v_mov_b32_dpp v75, v73 quad_perm:[2,3,0,1] row_mask:0xf bank_mask:0xf
    v_mfma_f32_16x16x32_bf16 v[48:51], v[60:63], v[64:67], 0
    v_mov_b32 v70, 0x3f803f80
    v_mfma_f32_16x16x32_bf16 v[44:47], v[92:95], v[72:75], v[44:47]
    v_mov_b32 v71, 0x3f803f80
    v_mfma_f32_16x16x32_bf16 v[48:51], v[96:99], v[72:75], v[48:51]
    s_nop 4
    s_mov_b64 exec, s[42:43]
    v_cvt_pk_bf16_f32 v36, v44, v45
    v_cvt_pk_bf16_f32 v37, v46, v47
    v_cvt_pk_bf16_f32 v38, v48, v49
    v_cvt_pk_bf16_f32 v39, v50, v51
    ds_write_b128 v8, v[36:39]
    s_mov_b64 exec, -1
    v_mfma_f32_16x16x32_bf16 v[80:83], v[72:75], v[68:71], 0
    v_mfma_f32_16x16x32_bf16 v[80:83], v[64:67], v[68:71], v[80:83]
    v_mfma_f32_32x32x16_bf16 v[16:31], v[64:67], v[62:65], 0
    s_nop 0
    s_waitcnt lgkmcnt(0)
    s_barrier
    ds_read_b128 v[52:55], v0 offset:5120
    ds_read_b128 v[56:59], v0 offset:6144
    v_mfma_f32_16x16x32_bf16 v[32:35], v[64:67], v[62:65], 0
    s_add_u32 s23, s23, 540672
    v_rcp_f32 v80, v80
    v_rcp_f32 v81, v81
    s_nop 0
    s_add_u32 s24, s24, 540672
    s_waitcnt lgkmcnt(1)
    v_smfmac_f32_16x16x64_bf16 v[32:35], v[52:55], v[240:247], v1
    v_smfmac_f32_16x16x64_bf16 v[16:19], v[52:55], v[176:183], v1
    s_waitcnt lgkmcnt(0)
    v_smfmac_f32_16x16x64_bf16 v[32:35], v[56:59], v[248:255], v1
    s_add_u32 s25, s25, 16384
    s_add_u32 s26, s26, 16384
    v_smfmac_f32_16x16x64_bf16 v[20:23], v[52:55], v[184:191], v1
    s_add_u32 s27, s27, 16384
    s_xor_b32 s32, s32, s41
    v_smfmac_f32_16x16x64_bf16 v[16:19], v[56:59], v[192:199], v1
    s_nop 1
    v_add_f32 v32, v32, v34
    v_smfmac_f32_16x16x64_bf16 v[20:23], v[56:59], v[200:207], v1
    v_add_f32 v33, v33, v35
    v_smfmac_f32_16x16x64_bf16 v[24:27], v[52:55], v[208:215], v1
    v_mul_f32 v32, v32, v80
    v_smfmac_f32_16x16x64_bf16 v[28:31], v[52:55], v[216:223], v1
    v_mul_f32 v33, v33, v81
    v_smfmac_f32_16x16x64_bf16 v[24:27], v[56:59], v[224:231], v1
    v_cvt_pk_bf16_f32 v40, v32, v33
    v_smfmac_f32_16x16x64_bf16 v[28:31], v[56:59], v[232:239], v1
    buffer_store_dword v40, v3, s[8:11], s28 offen
    v_pk_add_f32 v[16:17], v[16:17], v[18:19]
    v_pk_add_f32 v[20:21], v[20:21], v[22:23]
    v_pk_mul_f32 v[16:17], v[16:17], v[80:81]
    v_pk_mul_f32 v[20:21], v[20:21], v[80:81]
    v_cvt_pk_bf16_f32 v36, v16, v17
    v_cvt_pk_bf16_f32 v37, v20, v21
    buffer_store_dwordx2 v[36:37], v2, s[8:11], s28 offen
    v_pk_add_f32 v[24:25], v[24:25], v[26:27]
    v_pk_add_f32 v[28:29], v[28:29], v[30:31]
    v_pk_mul_f32 v[24:25], v[24:25], v[80:81]
    v_pk_mul_f32 v[28:29], v[28:29], v[80:81]
    v_cvt_pk_bf16_f32 v38, v24, v25
    v_cvt_pk_bf16_f32 v39, v28, v29
    buffer_store_dwordx2 v[38:39], v2, s[8:11], s29 offen
    v_mov_b32 v41, 0
    v_mov_b32 v42, 0
    v_mov_b32 v43, 0
    v_mov_b32 v44, 0
    v_mov_b32 v45, 0
    v_mov_b32 v46, 0
    v_mov_b32 v47, 0
    v_mov_b32 v48, 0
    v_mov_b32 v49, 0
    v_mov_b32 v50, 0
    v_mov_b32 v51, 0
    v_mov_b32 v52, 0
    v_mov_b32 v53, 0
    v_mov_b32 v54, 0
    v_mov_b32 v55, 0
    v_mov_b32 v56, 0
    v_mov_b32 v57, 0
    v_mov_b32 v58, 0
    v_mov_b32 v59, 0
    v_mov_b32 v36, 0
    v_mov_b32 v37, 0
    v_mov_b32 v38, 0
    v_mov_b32 v39, 0
    v_mov_b32 v40, 0
    s_xor_b32 s28, s28, s35
    s_cmp_eq_u32 s36, 0
    s_cbranch_scc1 L_nred
    s_cmp_lg_u32 s22, 1
    s_cbranch_scc1 L_rsE
    ds_read_b128 v[60:63], v9 offset:12288
    ds_read_b128 v[64:67], v9 offset:13312
    ds_read_b128 v[68:71], v9 offset:14336
    ds_read_b128 v[72:75], v9 offset:15360
    ds_read_b128 v[76:79], v9 offset:16384
    ds_read_b128 v[80:83], v9 offset:17408
    s_nop 4
    buffer_load_dwordx4 v[16:19], v0, s[8:11], s32 offen offset:0 sc1
    buffer_load_dwordx4 v[20:23], v0, s[8:11], s32 offen offset:1024 sc1
    s_nop 15
    s_nop 3
    buffer_load_dwordx4 v[24:27], v0, s[8:11], s32 offen offset:0 sc1
    buffer_load_dwordx4 v[28:31], v0, s[8:11], s32 offen offset:1024 sc1
    s_nop 5
    buffer_load_dwordx4 v[84:87], v0, s[8:11], s32 offen offset:0 sc1
    buffer_load_dwordx4 v[88:91], v0, s[8:11], s32 offen offset:1024 sc1
    s_nop 13
    buffer_load_dwordx4 v[92:95], v0, s[8:11], s32 offen offset:0 sc1
    buffer_load_dwordx4 v[96:99], v0, s[8:11], s32 offen offset:1024 sc1
    s_mov_b32 s38, 0
    s_cmp_lt_u32 s33, 63
L_rB0:
    s_waitcnt vmcnt(7)
    v_mfma_f32_16x16x32_bf16 v[32:35], v[100:103], v[16:19], 0
    s_waitcnt vmcnt(6)
    v_cmp_u_f32 vcc, v19, v23
    v_mfma_f32_16x16x32_bf16 v[32:35], v[100:103], v[20:23], v[32:35]
    s_nop 6
    s_cbranch_vccnz L_rB1
    v_cmp_u_f32 vcc, v32, v32
    v_add_f32_dpp v34, v32, v32 row_ror:4 row_mask:0xf bank_mask:0xf
    v_add_f32_dpp v35, v33, v33 row_ror:4 row_mask:0xf bank_mask:0xf
    s_nop 0
    v_add_f32_dpp v32, v34, v34 row_ror:8 row_mask:0xf bank_mask:0xf
    v_add_f32_dpp v33, v35, v35 row_ror:8 row_mask:0xf bank_mask:0xf
    v_cvt_pk_bf16_f32 v14, v32, v33
    s_cbranch_vccnz L_rs_0
    buffer_store_dword v14, v4, s[8:11], s23 offen
    buffer_store_dword v14, v4, s[12:15], s27 offen sc1
    s_cbranch_scc1 L_top
    s_branch L_done
    .p2align 5
    s_nop 0
    s_nop 0
    s_nop 0
    s_nop 0
L_rB1:
    s_waitcnt vmcnt(5)
    v_mfma_f32_16x16x32_bf16 v[32:35], v[100:103], v[24:27], 0
    s_waitcnt vmcnt(4)
    v_cmp_u_f32 vcc, v27, v31
    v_mfma_f32_16x16x32_bf16 v[32:35], v[100:103], v[28:31], v[32:35]
    buffer_load_dwordx4 v[16:19], v0, s[8:11], s32 offen offset:0 sc1
    buffer_load_dwordx4 v[20:23], v0, s[8:11], s32 offen offset:1024 sc1
    s_nop 4
    s_cbranch_vccnz L_rB2
    v_cmp_u_f32 vcc, v32, v32
    v_add_f32_dpp v34, v32, v32 row_ror:4 row_mask:0xf bank_mask:0xf
    v_add_f32_dpp v35, v33, v33 row_ror:4 row_mask:0xf bank_mask:0xf
    s_nop 0
    v_add_f32_dpp v32, v34, v34 row_ror:8 row_mask:0xf bank_mask:0xf
    v_add_f32_dpp v33, v35, v35 row_ror:8 row_mask:0xf bank_mask:0xf
    v_cvt_pk_bf16_f32 v14, v32, v33
    s_cbranch_vccnz L_rs_0
    buffer_store_dword v14, v4, s[8:11], s23 offen
    buffer_store_dword v14, v4, s[12:15], s27 offen sc1
    s_cbranch_scc1 L_top
    s_branch L_done
    .p2align 5
    s_nop 0
    s_nop 0
    s_nop 0
    s_nop 0
L_rB2:
    s_waitcnt vmcnt(5)
    v_mfma_f32_16x16x32_bf16 v[32:35], v[100:103], v[84:87], 0
    s_waitcnt vmcnt(4)
    v_cmp_u_f32 vcc, v87, v91
    v_mfma_f32_16x16x32_bf16 v[32:35], v[100:103], v[88:91], v[32:35]
    buffer_load_dwordx4 v[24:27], v0, s[8:11], s32 offen offset:0 sc1
    buffer_load_dwordx4 v[28:31], v0, s[8:11], s32 offen offset:1024 sc1
    s_nop 4
    s_cbranch_vccnz L_rB3
    v_cmp_u_f32 vcc, v32, v32
    v_add_f32_dpp v34, v32, v32 row_ror:4 row_mask:0xf bank_mask:0xf
    v_add_f32_dpp v35, v33, v33 row_ror:4 row_mask:0xf bank_mask:0xf
    s_nop 0
    v_add_f32_dpp v32, v34, v34 row_ror:8 row_mask:0xf bank_mask:0xf
    v_add_f32_dpp v33, v35, v35 row_ror:8 row_mask:0xf bank_mask:0xf
    v_cvt_pk_bf16_f32 v14, v32, v33
    s_cbranch_vccnz L_rs_0
    buffer_store_dword v14, v4, s[8:11], s23 offen
    buffer_store_dword v14, v4, s[12:15], s27 offen sc1
    s_cbranch_scc1 L_top
    s_branch L_done
    .p2align 5
    s_nop 0
    s_nop 0
    s_nop 0
    s_nop 0
L_rB3:
    s_waitcnt vmcnt(5)
    v_mfma_f32_16x16x32_bf16 v[32:35], v[100:103], v[92:95], 0
    s_waitcnt vmcnt(4)
    v_cmp_u_f32 vcc, v95, v99
    v_mfma_f32_16x16x32_bf16 v[32:35], v[100:103], v[96:99], v[32:35]
    buffer_load_dwordx4 v[84:87], v0, s[8:11], s32 offen offset:0 sc1
    buffer_load_dwordx4 v[88:91], v0, s[8:11], s32 offen offset:1024 sc1
    s_nop 4
    s_cbranch_vccnz L_rB4
    v_cmp_u_f32 vcc, v32, v32
    v_add_f32_dpp v34, v32, v32 row_ror:4 row_mask:0xf bank_mask:0xf
    v_add_f32_dpp v35, v33, v33 row_ror:4 row_mask:0xf bank_mask:0xf
    s_nop 0
    v_add_f32_dpp v32, v34, v34 row_ror:8 row_mask:0xf bank_mask:0xf
    v_add_f32_dpp v33, v35, v35 row_ror:8 row_mask:0xf bank_mask:0xf
    v_cvt_pk_bf16_f32 v14, v32, v33
    s_cbranch_vccnz L_rs_0
    buffer_store_dword v14, v4, s[8:11], s23 offen
    buffer_store_dword v14, v4, s[12:15], s27 offen sc1
    s_cbranch_scc1 L_top
    s_branch L_done
    .p2align 5
    s_nop 0
    s_nop 0
    s_nop 0
    s_nop 0
L_rB4:
    s_waitcnt vmcnt(5)
    v_mfma_f32_16x16x32_bf16 v[32:35], v[100:103], v[16:19], 0
    s_waitcnt vmcnt(4)
    v_cmp_u_f32 vcc, v19, v23
    v_mfma_f32_16x16x32_bf16 v[32:35], v[100:103], v[20:23], v[32:35]
    buffer_load_dwordx4 v[92:95], v0, s[8:11], s32 offen offset:0 sc1
    buffer_load_dwordx4 v[96:99], v0, s[8:11], s32 offen offset:1024 sc1
    s_nop 4
    s_cbranch_vccnz L_rB5
    v_cmp_u_f32 vcc, v32, v32
    v_add_f32_dpp v34, v32, v32 row_ror:4 row_mask:0xf bank_mask:0xf
    v_add_f32_dpp v35, v33, v33 row_ror:4 row_mask:0xf bank_mask:0xf
    s_nop 0
    v_add_f32_dpp v32, v34, v34 row_ror:8 row_mask:0xf bank_mask:0xf
    v_add_f32_dpp v33, v35, v35 row_ror:8 row_mask:0xf bank_mask:0xf
    v_cvt_pk_bf16_f32 v14, v32, v33
    s_cbranch_vccnz L_rs_0
    buffer_store_dword v14, v4, s[8:11], s23 offen
    buffer_store_dword v14, v4, s[12:15], s27 offen sc1
    s_cbranch_scc1 L_top
    s_branch L_done
L_rB5:
    s_add_u32 s38, s38, 1
    s_and_b32 s39, s38, 15
    s_cbranch_scc0 L_rs_0
    s_cmp_lt_u32 s33, 63
    s_branch L_rB1
    .p2align 5
L_rsE:
    ds_read_b128 v[60:63], v9 offset:12288
    ds_read_b128 v[64:67], v9 offset:13312
    ds_read_b128 v[68:71], v9 offset:14336
    ds_read_b128 v[72:75], v9 offset:15360
    ds_read_b128 v[76:79], v9 offset:16384
    ds_read_b128 v[80:83], v9 offset:17408
    buffer_load_dwordx4 v[16:19], v0, s[8:11], s32 offen offset:0 sc1
    buffer_load_dwordx4 v[20:23], v0, s[8:11], s32 offen offset:1024 sc1
    s_nop 15
    s_nop 15
    buffer_load_dwordx4 v[24:27], v0, s[8:11], s32 offen offset:0 sc1
    buffer_load_dwordx4 v[28:31], v0, s[8:11], s32 offen offset:1024 sc1
    s_mov_b32 s38, 0
    s_cmp_lt_u32 s33, 63
L_rE0:
    s_waitcnt vmcnt(3)
    v_mfma_f32_16x16x32_bf16 v[32:35], v[100:103], v[16:19], 0
    s_waitcnt vmcnt(2)
    v_cmp_u_f32 vcc, v19, v23
    v_mfma_f32_16x16x32_bf16 v[32:35], v[100:103], v[20:23], v[32:35]
    s_nop 6
    s_cbranch_vccnz L_rE1
    v_cmp_u_f32 vcc, v32, v32
    v_add_f32_dpp v34, v32, v32 row_ror:4 row_mask:0xf bank_mask:0xf
    v_add_f32_dpp v35, v33, v33 row_ror:4 row_mask:0xf bank_mask:0xf
    s_nop 0
    v_add_f32_dpp v32, v34, v34 row_ror:8 row_mask:0xf bank_mask:0xf
    v_add_f32_dpp v33, v35, v35 row_ror:8 row_mask:0xf bank_mask:0xf
    v_cvt_pk_bf16_f32 v14, v32, v33
    s_cbranch_vccnz L_rs_0
    buffer_store_dword v14, v4, s[8:11], s23 offen
    buffer_store_dword v14, v4, s[12:15], s27 offen sc1
    s_cbranch_scc1 L_top
    s_branch L_done
    .p2align 5
    s_nop 0
    s_nop 0
    s_nop 0
    s_nop 0
L_rE1:
    s_waitcnt vmcnt(1)
    v_mfma_f32_16x16x32_bf16 v[32:35], v[100:103], v[24:27], 0
    s_waitcnt vmcnt(0)
    v_cmp_u_f32 vcc, v27, v31
    v_mfma_f32_16x16x32_bf16 v[32:35], v[100:103], v[28:31], v[32:35]
    buffer_load_dwordx4 v[16:19], v0, s[8:11], s32 offen offset:0 sc1
    buffer_load_dwordx4 v[20:23], v0, s[8:11], s32 offen offset:1024 sc1
    s_nop 4
    s_cbranch_vccnz L_rE2
    v_cmp_u_f32 vcc, v32, v32
    v_add_f32_dpp v34, v32, v32 row_ror:4 row_mask:0xf bank_mask:0xf
    v_add_f32_dpp v35, v33, v33 row_ror:4 row_mask:0xf bank_mask:0xf
    s_nop 0
    v_add_f32_dpp v32, v34, v34 row_ror:8 row_mask:0xf bank_mask:0xf
    v_add_f32_dpp v33, v35, v35 row_ror:8 row_mask:0xf bank_mask:0xf
    v_cvt_pk_bf16_f32 v14, v32, v33
    s_cbranch_vccnz L_rs_0
    buffer_store_dword v14, v4, s[8:11], s23 offen
    buffer_store_dword v14, v4, s[12:15], s27 offen sc1
    s_cbranch_scc1 L_top
    s_branch L_done
    .p2align 5
    s_nop 0
    s_nop 0
    s_nop 0
    s_nop 0
L_rE2:
    s_waitcnt vmcnt(1)
    v_mfma_f32_16x16x32_bf16 v[32:35], v[100:103], v[16:19], 0
    s_waitcnt vmcnt(0)
    v_cmp_u_f32 vcc, v19, v23
    v_mfma_f32_16x16x32_bf16 v[32:35], v[100:103], v[20:23], v[32:35]
    buffer_load_dwordx4 v[24:27], v0, s[8:11], s32 offen offset:0 sc1
    buffer_load_dwordx4 v[28:31], v0, s[8:11], s32 offen offset:1024 sc1
    s_nop 4
    s_cbranch_vccnz L_rE3
    v_cmp_u_f32 vcc, v32, v32
    v_add_f32_dpp v34, v32, v32 row_ror:4 row_mask:0xf bank_mask:0xf
    v_add_f32_dpp v35, v33, v33 row_ror:4 row_mask:0xf bank_mask:0xf
    s_nop 0
    v_add_f32_dpp v32, v34, v34 row_ror:8 row_mask:0xf bank_mask:0xf
    v_add_f32_dpp v33, v35, v35 row_ror:8 row_mask:0xf bank_mask:0xf
    v_cvt_pk_bf16_f32 v14, v32, v33
    s_cbranch_vccnz L_rs_0
    buffer_store_dword v14, v4, s[8:11], s23 offen
    buffer_store_dword v14, v4, s[12:15], s27 offen sc1
    s_cbranch_scc1 L_top
    s_branch L_done
L_rE3:
    s_add_u32 s38, s38, 1
    s_and_b32 s39, s38, 15
    s_cbranch_scc0 L_rs_0
    s_cmp_lt_u32 s33, 63
    s_branch L_rE1
L_rs_0:
    buffer_load_dwordx4 v[16:19], v0, s[8:11], s32 offen offset:0 sc1
    buffer_load_dwordx4 v[20:23], v0, s[8:11], s32 offen offset:1024 sc1
    s_nop 7
    buffer_load_dwordx4 v[24:27], v0, s[8:11], s32 offen offset:0 sc1
    buffer_load_dwordx4 v[28:31], v0, s[8:11], s32 offen offset:1024 sc1
    s_nop 7
    buffer_load_dwordx4 v[84:87], v0, s[8:11], s32 offen offset:0 sc1
    buffer_load_dwordx4 v[88:91], v0, s[8:11], s32 offen offset:1024 sc1
    s_waitcnt vmcnt(5)
    v_mfma_f32_16x16x32_bf16 v[32:35], v[100:103], v[16:19], 0
    v_max3_u32 v13, v16, v17, v18
    s_waitcnt vmcnt(4)
    v_mfma_f32_16x16x32_bf16 v[32:35], v[100:103], v[20:23], v[32:35]
    v_max3_u32 v12, v20, v21, v22
    v_max3_u32 v13, v13, v19, v23
    v_max_u32 v13, v13, v12
    v_cmp_eq_u32 vcc, -1, v13
    s_nop 3
    v_add_f32_dpp v34, v32, v32 row_ror:4 row_mask:0xf bank_mask:0xf
    v_add_f32_dpp v35, v33, v33 row_ror:4 row_mask:0xf bank_mask:0xf
    s_nop 0
    v_add_f32_dpp v32, v34, v34 row_ror:8 row_mask:0xf bank_mask:0xf
    v_add_f32_dpp v33, v35, v35 row_ror:8 row_mask:0xf bank_mask:0xf
    v_cvt_pk_bf16_f32 v14, v32, v33
    s_cbranch_vccnz L_rs_1
L_pub2:
    buffer_store_dword v14, v4, s[8:11], s23 offen
    buffer_store_dword v14, v4, s[12:15], s27 offen sc1
L_send:
    s_cmp_lt_u32 s33, 63
    s_cbranch_scc1 L_top
    s_branch L_done
L_nred:
    s_cmp_gt_u32 s47, 63
    s_cbranch_scc1 L_kvwe
L_kvwa:
    s_min_u32 s38, s86, s87
    s_min_u32 s39, s88, s89
    s_lshl_b32 s38, s38, 1
    s_lshl_b32 s39, s39, 1
    s_add_u32 s39, s39, 1
    s_min_u32 s47, s38, s39
    s_add_u32 s38, s33, 1
    s_min_u32 s38, s38, 63
    s_cmp_gt_u32 s47, s38
    s_cbranch_scc1 L_kvwd
L_kvwb:
    s_load_dword s86, s[84:85], 0 glc
    s_load_dword s87, s[84:85], 4096 glc
    s_load_dword s88, s[84:85], 12288 glc
    s_load_dword s89, s[84:85], 16384 glc
    s_add_u32 s34, s34, 1
    s_cmp_gt_u32 s34, 400000
    s_cbranch_scc1 L_fail
    s_waitcnt lgkmcnt(0)
    s_branch L_kvwa
L_kvwd:
    s_load_dword s86, s[84:85], 0 glc
    s_load_dword s87, s[84:85], 4096 glc
    s_load_dword s88, s[84:85], 12288 glc
    s_load_dword s89, s[84:85], 16384 glc
L_kvwe:
    ds_read_b128 v[60:63], v9 offset:12288
    ds_read_b128 v[64:67], v9 offset:13312
    ds_read_b128 v[68:71], v9 offset:14336
    ds_read_b128 v[72:75], v9 offset:15360
    ds_read_b128 v[76:79], v9 offset:16384
    ds_read_b128 v[80:83], v9 offset:17408
    s_branch L_send
L_rs_1:
    buffer_load_dwordx4 v[16:19], v0, s[8:11], s32 offen offset:0 sc1
    buffer_load_dwordx4 v[20:23], v0, s[8:11], s32 offen offset:1024 sc1
    s_waitcnt vmcnt(5)
    v_mfma_f32_16x16x32_bf16 v[32:35], v[100:103], v[24:27], 0
    v_max3_u32 v13, v24, v25, v26
    s_waitcnt vmcnt(4)
    v_mfma_f32_16x16x32_bf16 v[32:35], v[100:103], v[28:31], v[32:35]
    v_max3_u32 v12, v28, v29, v30
    v_max3_u32 v13, v13, v27, v31
    v_max_u32 v13, v13, v12
    v_cmp_eq_u32 vcc, -1, v13
    s_nop 3
    v_add_f32_dpp v34, v32, v32 row_ror:4 row_mask:0xf bank_mask:0xf
    v_add_f32_dpp v35, v33, v33 row_ror:4 row_mask:0xf bank_mask:0xf
    s_nop 0
    v_add_f32_dpp v32, v34, v34 row_ror:8 row_mask:0xf bank_mask:0xf
    v_add_f32_dpp v33, v35, v35 row_ror:8 row_mask:0xf bank_mask:0xf
    v_cvt_pk_bf16_f32 v14, v32, v33
    s_cbranch_vccz L_pub2
    buffer_load_dwordx4 v[24:27], v0, s[8:11], s32 offen offset:0 sc1
    buffer_load_dwordx4 v[28:31], v0, s[8:11], s32 offen offset:1024 sc1
    s_waitcnt vmcnt(5)
    v_mfma_f32_16x16x32_bf16 v[32:35], v[100:103], v[84:87], 0
    v_max3_u32 v13, v84, v85, v86
    s_waitcnt vmcnt(4)
    v_mfma_f32_16x16x32_bf16 v[32:35], v[100:103], v[88:91], v[32:35]
    v_max3_u32 v12, v88, v89, v90
    v_max3_u32 v13, v13, v87, v91
    v_max_u32 v13, v13, v12
    v_cmp_eq_u32 vcc, -1, v13
    s_nop 3
    v_add_f32_dpp v34, v32, v32 row_ror:4 row_mask:0xf bank_mask:0xf
    v_add_f32_dpp v35, v33, v33 row_ror:4 row_mask:0xf bank_mask:0xf
    s_nop 0
    v_add_f32_dpp v32, v34, v34 row_ror:8 row_mask:0xf bank_mask:0xf
    v_add_f32_dpp v33, v35, v35 row_ror:8 row_mask:0xf bank_mask:0xf
    v_cvt_pk_bf16_f32 v14, v32, v33
    s_cbranch_vccz L_pub2
    buffer_load_dwordx4 v[84:87], v0, s[8:11], s32 offen offset:0 sc1
    buffer_load_dwordx4 v[88:91], v0, s[8:11], s32 offen offset:1024 sc1
    s_waitcnt vmcnt(5)
    v_mfma_f32_16x16x32_bf16 v[32:35], v[100:103], v[16:19], 0
    v_max3_u32 v13, v16, v17, v18
    s_waitcnt vmcnt(4)
    v_mfma_f32_16x16x32_bf16 v[32:35], v[100:103], v[20:23], v[32:35]
    v_max3_u32 v12, v20, v21, v22
    v_max3_u32 v13, v13, v19, v23
    v_max_u32 v13, v13, v12
    v_cmp_eq_u32 vcc, -1, v13
    s_nop 3
    v_add_f32_dpp v34, v32, v32 row_ror:4 row_mask:0xf bank_mask:0xf
    v_add_f32_dpp v35, v33, v33 row_ror:4 row_mask:0xf bank_mask:0xf
    s_nop 0
    v_add_f32_dpp v32, v34, v34 row_ror:8 row_mask:0xf bank_mask:0xf
    v_add_f32_dpp v33, v35, v35 row_ror:8 row_mask:0xf bank_mask:0xf
    v_cvt_pk_bf16_f32 v14, v32, v33
    s_cbranch_vccz L_pub2
    s_add_u32 s34, s34, 1
    s_cmp_gt_u32 s34, 400000
    s_cbranch_scc1 L_fail
    s_branch L_rs_1
L_rt0:
    buffer_load_dwordx4 v[32:35], v0, s[8:11], s23 offen offset:2048 sc1
    buffer_load_dwordx4 v[84:87], v0, s[8:11], s23 offen offset:3072 sc1
    buffer_load_dwordx4 v[88:91], v0, s[8:11], s23 offen offset:0 sc1
    buffer_load_dwordx4 v[92:95], v0, s[8:11], s23 offen offset:1024 sc1
    buffer_load_dwordx4 v[96:99], v0, s[8:11], s24 offen offset:0 sc1
    s_add_u32 s34, s34, 1
    s_cmp_gt_u32 s34, 400000
    s_cbranch_scc1 L_fail
    s_waitcnt vmcnt(4)
    v_max3_u32 v7, v32, v33, v34
    v_max_u32 v7, v7, v35
    v_cmp_eq_u32 vcc, -1, v7
    s_cbranch_vccnz L_rt0
    s_waitcnt vmcnt(3)
    v_max3_u32 v7, v7, v84, v85
    v_max3_u32 v7, v7, v86, v87
    s_waitcnt vmcnt(2)
    v_max3_u32 v7, v7, v88, v89
    v_max3_u32 v7, v7, v90, v91
    s_waitcnt vmcnt(1)
    v_max3_u32 v7, v7, v92, v93
    v_max3_u32 v7, v7, v94, v95
    s_waitcnt vmcnt(0)
    v_max3_u32 v7, v7, v96, v97
    v_max3_u32 v7, v7, v98, v99
    v_cmp_eq_u32 vcc, -1, v7
    s_cbranch_vccz L_ok0
    s_branch L_rt0
L_rt1:
    buffer_load_dwordx4 v[84:87], v0, s[8:11], s23 offen offset:3072 sc1
    buffer_load_dwordx4 v[88:91], v0, s[8:11], s23 offen offset:0 sc1
    buffer_load_dwordx4 v[92:95], v0, s[8:11], s23 offen offset:1024 sc1
    buffer_load_dwordx4 v[96:99], v0, s[8:11], s24 offen offset:0 sc1
    s_add_u32 s34, s34, 1
    s_cmp_gt_u32 s34, 400000
    s_cbranch_scc1 L_fail
    s_waitcnt vmcnt(3)
    v_max3_u32 v7, v84, v85, v86
    v_max_u32 v7, v7, v87
    v_cmp_eq_u32 vcc, -1, v7
    s_cbranch_vccnz L_rt1
    s_waitcnt vmcnt(2)
    v_max3_u32 v7, v7, v88, v89
    v_max3_u32 v7, v7, v90, v91
    s_waitcnt vmcnt(1)
    v_max3_u32 v7, v7, v92, v93
    v_max3_u32 v7, v7, v94, v95
    s_waitcnt vmcnt(0)
    v_max3_u32 v7, v7, v96, v97
    v_max3_u32 v7, v7, v98, v99
    v_cmp_eq_u32 vcc, -1, v7
    s_cbranch_vccz L_ok1
    s_branch L_rt1
L_rt2:
    buffer_load_dwordx4 v[88:91], v0, s[8:11], s23 offen offset:0 sc1
    buffer_load_dwordx4 v[92:95], v0, s[8:11], s23 offen offset:1024 sc1
    buffer_load_dwordx4 v[96:99], v0, s[8:11], s24 offen offset:0 sc1
    s_add_u32 s34, s34, 1
    s_cmp_gt_u32 s34, 400000
    s_cbranch_scc1 L_fail
    s_waitcnt vmcnt(2)
    v_max3_u32 v7, v88, v89, v90
    v_max_u32 v7, v7, v91
    v_cmp_eq_u32 vcc, -1, v7
    s_cbranch_vccnz L_rt2
    s_waitcnt vmcnt(1)
    v_max3_u32 v7, v7, v92, v93
    v_max3_u32 v7, v7, v94, v95
    s_waitcnt vmcnt(0)
    v_max3_u32 v7, v7, v96, v97
    v_max3_u32 v7, v7, v98, v99
    v_cmp_eq_u32 vcc, -1, v7
    s_cbranch_vccz L_ok2
    s_branch L_rt2
L_rt3:
    buffer_load_dwordx4 v[92:95], v0, s[8:11], s23 offen offset:1024 sc1
    buffer_load_dwordx4 v[96:99], v0, s[8:11], s24 offen offset:0 sc1
    s_add_u32 s34, s34, 1
    s_cmp_gt_u32 s34, 400000
    s_cbranch_scc1 L_fail
    s_waitcnt vmcnt(1)
    v_max3_u32 v7, v92, v93, v94
    v_max_u32 v7, v7, v95
    v_cmp_eq_u32 vcc, -1, v7
    s_cbranch_vccnz L_rt3
    s_waitcnt vmcnt(0)
    v_max3_u32 v7, v7, v96, v97
    v_max3_u32 v7, v7, v98, v99
    v_cmp_eq_u32 vcc, -1, v7
    s_cbranch_vccz L_ok3
    s_branch L_rt3
L_rt5:
    buffer_load_dwordx4 v[16:19], v0, s[8:11], s25 offen offset:2048 sc1
    buffer_load_dwordx4 v[20:23], v0, s[8:11], s25 offen offset:3072 sc1
    buffer_load_dwordx4 v[24:27], v0, s[8:11], s25 offen offset:0 sc1
    buffer_load_dwordx4 v[28:31], v0, s[8:11], s25 offen offset:1024 sc1
    buffer_load_dwordx4 v[32:35], v0, s[8:11], s26 offen offset:0 sc1
    s_add_u32 s34, s34, 1
    s_cmp_gt_u32 s34, 400000
    s_cbranch_scc1 L_fail
    s_waitcnt vmcnt(4)
    v_max3_u32 v7, v16, v17, v18
    v_max_u32 v7, v7, v19
    v_cmp_eq_u32 vcc, -1, v7
    s_cbranch_vccnz L_rt5
    s_waitcnt vmcnt(3)
    v_max3_u32 v7, v7, v20, v21
    v_max3_u32 v7, v7, v22, v23
    s_waitcnt vmcnt(2)
    v_max3_u32 v7, v7, v24, v25
    v_max3_u32 v7, v7, v26, v27
    s_waitcnt vmcnt(1)
    v_max3_u32 v7, v7, v28, v29
    v_max3_u32 v7, v7, v30, v31
    s_waitcnt vmcnt(0)
    v_max3_u32 v7, v7, v32, v33
    v_max3_u32 v7, v7, v34, v35
    v_cmp_eq_u32 vcc, -1, v7
    s_cbranch_vccz L_ok5
    s_branch L_rt5
L_rt6:
    buffer_load_dwordx4 v[20:23], v0, s[8:11], s25 offen offset:3072 sc1
    buffer_load_dwordx4 v[24:27], v0, s[8:11], s25 offen offset:0 sc1
    buffer_load_dwordx4 v[28:31], v0, s[8:11], s25 offen offset:1024 sc1
    buffer_load_dwordx4 v[32:35], v0, s[8:11], s26 offen offset:0 sc1
    s_add_u32 s34, s34, 1
    s_cmp_gt_u32 s34, 400000
    s_cbranch_scc1 L_fail
    s_waitcnt vmcnt(3)
    v_max3_u32 v7, v20, v21, v22
    v_max_u32 v7, v7, v23
    v_cmp_eq_u32 vcc, -1, v7
    s_cbranch_vccnz L_rt6
    s_waitcnt vmcnt(2)
    v_max3_u32 v7, v7, v24, v25
    v_max3_u32 v7, v7, v26, v27
    s_waitcnt vmcnt(1)
    v_max3_u32 v7, v7, v28, v29
    v_max3_u32 v7, v7, v30, v31
    s_waitcnt vmcnt(0)
    v_max3_u32 v7, v7, v32, v33
    v_max3_u32 v7, v7, v34, v35
    v_cmp_eq_u32 vcc, -1, v7
    s_cbranch_vccz L_ok6
    s_branch L_rt6
L_net:
    s_mov_b64 s[4:5], 0
    s_nop 7
    v_mov_b32 v41, 0
    v_mov_b32 v42, 0
    v_mov_b32 v43, 0
    v_mov_b32 v44, 0
    v_mov_b32 v45, 0
    v_mov_b32 v46, 0
    v_mov_b32 v47, 0
    v_mov_b32 v48, 0
    v_mov_b32 v49, 0
    v_mov_b32 v50, 0
    v_mov_b32 v51, 0
    v_mov_b32 v52, 0
    v_mov_b32 v53, 0
    v_mov_b32 v54, 0
    v_mov_b32 v55, 0
    v_mov_b32 v56, 0
    v_mov_b32 v57, 0
    v_mov_b32 v58, 0
    v_mov_b32 v59, 0
    v_mov_b32 v36, 0
    v_mov_b32 v37, 0
    v_mov_b32 v38, 0
    v_mov_b32 v39, 0
    v_mov_b32 v40, 0
    ds_read_b128 v[60:63], v9 offset:12288
    ds_read_b128 v[64:67], v9 offset:13312
    ds_read_b128 v[68:71], v9 offset:14336
    ds_read_b128 v[72:75], v9 offset:15360
    ds_read_b128 v[76:79], v9 offset:16384
    ds_read_b128 v[80:83], v9 offset:17408
L_nt0:
    buffer_load_dwordx4 v[16:19], v0, s[8:11], s23 offen offset:2048 sc1
    buffer_load_dwordx4 v[20:23], v0, s[8:11], s23 offen offset:3072 sc1
    buffer_load_dwordx4 v[24:27], v0, s[8:11], s23 offen offset:0 sc1
    buffer_load_dwordx4 v[28:31], v0, s[8:11], s23 offen offset:1024 sc1
    buffer_load_dwordx4 v[32:35], v0, s[8:11], s24 offen offset:0 sc1
    s_add_u32 s34, s34, 1
    s_cmp_gt_u32 s34, 400000
    s_cbranch_scc1 L_fail
    s_waitcnt vmcnt(0)
    v_max_u32 v13, v16, v17
    v_max3_u32 v13, v13, v18, v19
    v_max3_u32 v13, v13, v20, v21
    v_max3_u32 v13, v13, v22, v23
    v_max3_u32 v13, v13, v24, v25
    v_max3_u32 v13, v13, v26, v27
    v_max3_u32 v13, v13, v28, v29
    v_max3_u32 v13, v13, v30, v31
    v_max3_u32 v13, v13, v32, v33
    v_max3_u32 v13, v13, v34, v35
    v_cmp_eq_u32 vcc, -1, v13
    s_cbranch_vccnz L_nt0
    s_waitcnt lgkmcnt(4)
    v_smfmac_f32_16x16x64_bf16 v[52:55], v[16:19], v[60:67], v1
    ds_read_b128 v[60:63], v9 offset:18432
    ds_read_b128 v[64:67], v9 offset:19456
    v_smfmac_f32_16x16x64_bf16 v[36:39], v[16:19], a[0:7], v1
    v_smfmac_f32_16x16x64_bf16 v[44:47], v[16:19], a[88:95], v1
    s_waitcnt lgkmcnt(4)
    v_smfmac_f32_16x16x64_bf16 v[56:59], v[16:19], v[68:75], v1
    ds_read_b128 v[68:71], v9 offset:32768
    ds_read_b128 v[72:75], v9 offset:33792
    v_smfmac_f32_16x16x64_bf16 v[40:43], v[16:19], a[8:15], v1
    s_waitcnt lgkmcnt(4)
    v_smfmac_f32_16x16x64_bf16 v[52:55], v[20:23], v[76:83], v1
    ds_read_b128 v[76:79], v9 offset:34816
    ds_read_b128 v[80:83], v9 offset:35840
    v_smfmac_f32_16x16x64_bf16 v[48:51], v[16:19], a[96:103], v1
    v_smfmac_f32_16x16x64_bf16 v[44:47], v[20:23], a[104:111], v1
    s_waitcnt lgkmcnt(4)
    v_smfmac_f32_16x16x64_bf16 v[56:59], v[20:23], v[60:67], v1
    ds_read_b128 v[60:63], v9 offset:20480
    ds_read_b128 v[64:67], v9 offset:21504
    v_smfmac_f32_16x16x64_bf16 v[48:51], v[20:23], a[112:119], v1
    s_waitcnt lgkmcnt(4)
    v_smfmac_f32_16x16x64_bf16 v[36:39], v[20:23], v[68:75], v1
    ds_read_b128 v[68:71], v9 offset:22528
    ds_read_b128 v[72:75], v9 offset:23552
    v_smfmac_f32_16x16x64_bf16 v[36:39], v[24:27], a[16:23], v1
    v_smfmac_f32_16x16x64_bf16 v[44:47], v[24:27], a[120:127], v1
    s_waitcnt lgkmcnt(4)
    v_smfmac_f32_16x16x64_bf16 v[40:43], v[20:23], v[76:83], v1
    ds_read_b128 v[76:79], v9 offset:24576
    ds_read_b128 v[80:83], v9 offset:25600
    v_smfmac_f32_16x16x64_bf16 v[40:43], v[24:27], a[24:31], v1
    s_waitcnt lgkmcnt(4)
    v_smfmac_f32_16x16x64_bf16 v[52:55], v[24:27], v[60:67], v1
    ds_read_b128 v[60:63], v9 offset:26624
    ds_read_b128 v[64:67], v9 offset:27648
    v_smfmac_f32_16x16x64_bf16 v[48:51], v[24:27], a[128:135], v1
    v_smfmac_f32_16x16x64_bf16 v[36:39], v[28:31], a[32:39], v1
    s_waitcnt lgkmcnt(4)
    v_smfmac_f32_16x16x64_bf16 v[56:59], v[24:27], v[68:75], v1
    ds_read_b128 v[68:71], v9 offset:28672
    ds_read_b128 v[72:75], v9 offset:29696
    v_smfmac_f32_16x16x64_bf16 v[44:47], v[28:31], a[136:143], v1
    s_waitcnt lgkmcnt(4)
    v_smfmac_f32_16x16x64_bf16 v[52:55], v[28:31], v[76:83], v1
    ds_read_b128 v[76:79], v9 offset:30720
    ds_read_b128 v[80:83], v9 offset:31744
    v_smfmac_f32_16x16x64_bf16 v[40:43], v[28:31], a[40:47], v1
    v_smfmac_f32_16x16x64_bf16 v[48:51], v[28:31], a[144:151], v1
    s_waitcnt lgkmcnt(4)
    v_smfmac_f32_16x16x64_bf16 v[56:59], v[28:31], v[60:67], v1
    ds_read_b128 v[60:63], v9 offset:0
    ds_read_b128 v[64:67], v9 offset:1024
    v_smfmac_f32_16x16x64_bf16 v[36:39], v[32:35], a[48:55], v1
    s_waitcnt lgkmcnt(4)
    v_smfmac_f32_16x16x64_bf16 v[52:55], v[32:35], v[68:75], v1
    ds_read_b128 v[68:71], v9 offset:2048
    ds_read_b128 v[72:75], v9 offset:3072
    v_smfmac_f32_16x16x64_bf16 v[44:47], v[32:35], a[152:159], v1
    v_smfmac_f32_16x16x64_bf16 v[40:43], v[32:35], a[56:63], v1
    s_waitcnt lgkmcnt(4)
    v_smfmac_f32_16x16x64_bf16 v[56:59], v[32:35], v[76:83], v1
    ds_read_b128 v[76:79], v9 offset:36864
    ds_read_b128 v[80:83], v9 offset:37888
    v_smfmac_f32_16x16x64_bf16 v[48:51], v[32:35], a[160:167], v1
L_nt1:
    buffer_load_dwordx4 v[16:19], v0, s[8:11], s25 offen offset:2048 sc1
    buffer_load_dwordx4 v[20:23], v0, s[8:11], s25 offen offset:3072 sc1
    buffer_load_dwordx4 v[24:27], v0, s[8:11], s25 offen offset:0 sc1
    buffer_load_dwordx4 v[28:31], v0, s[8:11], s25 offen offset:1024 sc1
    buffer_load_dwordx4 v[32:35], v0, s[8:11], s26 offen offset:0 sc1
    s_add_u32 s34, s34, 1
    s_cmp_gt_u32 s34, 400000
    s_cbranch_scc1 L_fail
    s_waitcnt vmcnt(0)
    v_max_u32 v13, v16, v17
    v_max3_u32 v13, v13, v18, v19
    v_max3_u32 v13, v13, v20, v21
    v_max3_u32 v13, v13, v22, v23
    v_max3_u32 v13, v13, v24, v25
    v_max3_u32 v13, v13, v26, v27
    v_max3_u32 v13, v13, v28, v29
    v_max3_u32 v13, v13, v30, v31
    v_max3_u32 v13, v13, v32, v33
    v_max3_u32 v13, v13, v34, v35
    v_cmp_eq_u32 vcc, -1, v13
    s_cbranch_vccnz L_nt1
    v_smfmac_f32_16x16x64_bf16 v[44:47], v[16:19], a[168:175], v1
    s_waitcnt lgkmcnt(4)
    v_smfmac_f32_16x16x64_bf16 v[36:39], v[16:19], v[60:67], v1
    ds_read_b128 v[60:63], v9 offset:4096
    ds_read_b128 v[64:67], v9 offset:5120
    v_smfmac_f32_16x16x64_bf16 v[48:51], v[16:19], a[176:183], v1
    s_waitcnt lgkmcnt(4)
    v_smfmac_f32_16x16x64_bf16 v[40:43], v[16:19], v[68:75], v1
    ds_read_b128 v[68:71], v9 offset:6144
    ds_read_b128 v[72:75], v9 offset:7168
    v_smfmac_f32_16x16x64_bf16 v[44:47], v[20:23], a[184:191], v1
    v_smfmac_f32_16x16x64_bf16 v[40:43], v[20:23], a[64:71], v1
    s_waitcnt lgkmcnt(4)
    v_smfmac_f32_16x16x64_bf16 v[36:39], v[20:23], v[76:83], v1
    ds_read_b128 v[76:79], v9 offset:8192
    ds_read_b128 v[80:83], v9 offset:9216
    v_smfmac_f32_16x16x64_bf16 v[48:51], v[20:23], a[192:199], v1
    v_smfmac_f32_16x16x64_bf16 v[44:47], v[24:27], a[200:207], v1
    s_waitcnt lgkmcnt(4)
    v_smfmac_f32_16x16x64_bf16 v[36:39], v[24:27], v[60:67], v1
    ds_read_b128 v[60:63], v9 offset:10240
    ds_read_b128 v[64:67], v9 offset:11264
    v_smfmac_f32_16x16x64_bf16 v[48:51], v[24:27], a[208:215], v1
    s_waitcnt lgkmcnt(4)
    v_smfmac_f32_16x16x64_bf16 v[40:43], v[24:27], v[68:75], v1
    v_smfmac_f32_16x16x64_bf16 v[36:39], v[28:31], a[72:79], v1
    v_smfmac_f32_16x16x64_bf16 v[44:47], v[28:31], a[216:223], v1
    v_smfmac_f32_16x16x64_bf16 v[40:43], v[28:31], a[80:87], v1
    v_smfmac_f32_16x16x64_bf16 v[48:51], v[28:31], a[224:231], v1
    s_waitcnt lgkmcnt(2)
    v_smfmac_f32_16x16x64_bf16 v[36:39], v[32:35], v[76:83], v1
    v_smfmac_f32_16x16x64_bf16 v[44:47], v[32:35], a[232:239], v1
    s_waitcnt lgkmcnt(0)
    v_smfmac_f32_16x16x64_bf16 v[40:43], v[32:35], v[60:67], v1
    v_smfmac_f32_16x16x64_bf16 v[48:51], v[32:35], a[240:247], v1
    s_nop 7
    s_branch L_again
L_slowmode:
    v_mov_b32 v41, 0
    v_mov_b32 v42, 0
    v_mov_b32 v43, 0
    v_mov_b32 v44, 0
    v_mov_b32 v45, 0
    v_mov_b32 v46, 0
    v_mov_b32 v47, 0
    v_mov_b32 v48, 0
    v_mov_b32 v49, 0
    v_mov_b32 v50, 0
    v_mov_b32 v51, 0
    v_mov_b32 v52, 0
    v_mov_b32 v53, 0
    v_mov_b32 v54, 0
    v_mov_b32 v55, 0
    v_mov_b32 v56, 0
    v_mov_b32 v57, 0
    v_mov_b32 v58, 0
    v_mov_b32 v59, 0
    v_mov_b32 v36, 0
    v_mov_b32 v37, 0
    v_mov_b32 v38, 0
    v_mov_b32 v39, 0
    v_mov_b32 v40, 0
    ds_read_b128 v[60:63], v9 offset:12288
    ds_read_b128 v[64:67], v9 offset:13312
    ds_read_b128 v[68:71], v9 offset:14336
    ds_read_b128 v[72:75], v9 offset:15360
    ds_read_b128 v[76:79], v9 offset:16384
    ds_read_b128 v[80:83], v9 offset:17408
    v_mov_b32 v12, -1
    v_mov_b32 v13, -1
    v_mov_b32 v14, -1
    v_mov_b32 v15, -1
    s_branch L_ent_s
    .p2align 6
L_top_s:
    s_barrier
    v_mov_b32 v12, -1
    v_mov_b32 v13, -1
    v_mov_b32 v14, -1
    v_mov_b32 v15, -1
    s_nop 15
    s_nop 15
    s_nop 15
    s_nop 1
L_ent_s:
    buffer_load_dwordx4 v[32:35], v0, s[8:11], s23 offen offset:2048
    s_nop 5
    buffer_load_dwordx4 v[84:87], v0, s[8:11], s23 offen offset:3072
    s_nop 5
    buffer_load_dwordx4 v[88:91], v0, s[8:11], s23 offen offset:0
    s_nop 9
    buffer_load_dwordx4 v[92:95], v0, s[8:11], s23 offen offset:1024
    s_nop 5
    buffer_load_dwordx4 v[96:99], v0, s[8:11], s24 offen offset:0
    buffer_store_dwordx4 v[12:15], v0, s[12:15], s32 offen offset:0 sc1
    s_waitcnt vmcnt(5)
    v_cmp_u_f32 vcc, v32, v35
    s_cbranch_vccnz L_rt0_s
L_ok0_s:
    s_waitcnt lgkmcnt(4)
    v_smfmac_f32_16x16x64_bf16 v[52:55], v[32:35], v[60:67], v1
    ds_read_b128 v[60:63], v9 offset:18432
    v_smfmac_f32_16x16x64_bf16 v[36:39], v[32:35], a[0:7], v1
    ds_read_b128 v[64:67], v9 offset:19456
    buffer_load_dwordx4 v[16:19], v0, s[8:11], s25 offen offset:2048
    v_smfmac_f32_16x16x64_bf16 v[44:47], v[32:35], a[88:95], v1
    s_waitcnt lgkmcnt(4) vmcnt(5)
    v_cmp_u_f32 vcc, v84, v87
    v_smfmac_f32_16x16x64_bf16 v[56:59], v[32:35], v[68:75], v1
    ds_read_b128 v[68:71], v9 offset:32768
    buffer_load_dwordx4 v[20:23], v0, s[8:11], s25 offen offset:3072
    v_smfmac_f32_16x16x64_bf16 v[40:43], v[32:35], a[8:15], v1
    s_cbranch_vccnz L_rt1_s
L_ok1_s:
    ds_read_b128 v[72:75], v9 offset:33792
    s_waitcnt lgkmcnt(4)
    v_smfmac_f32_16x16x64_bf16 v[52:55], v[84:87], v[76:83], v1
    ds_read_b128 v[76:79], v9 offset:34816
    v_smfmac_f32_16x16x64_bf16 v[48:51], v[32:35], a[96:103], v1
    ds_read_b128 v[80:83], v9 offset:35840
    v_smfmac_f32_16x16x64_bf16 v[44:47], v[84:87], a[104:111], v1
    buffer_load_dwordx4 v[24:27], v0, s[8:11], s25 offen offset:0
    s_waitcnt lgkmcnt(4)
    v_smfmac_f32_16x16x64_bf16 v[56:59], v[84:87], v[60:67], v1
    ds_read_b128 v[60:63], v9 offset:20480
    s_waitcnt vmcnt(6)
    v_cmp_u_f32 vcc, v88, v91
    v_smfmac_f32_16x16x64_bf16 v[48:51], v[84:87], a[112:119], v1
    ds_read_b128 v[64:67], v9 offset:21504
    s_waitcnt lgkmcnt(4)
    v_smfmac_f32_16x16x64_bf16 v[36:39], v[84:87], v[68:75], v1
    s_cbranch_vccnz L_rt2_s
L_ok2_s:
    ds_read_b128 v[68:71], v9 offset:22528
    v_smfmac_f32_16x16x64_bf16 v[36:39], v[88:91], a[16:23], v1
    ds_read_b128 v[72:75], v9 offset:23552
    buffer_load_dwordx4 v[28:31], v0, s[8:11], s25 offen offset:1024
    v_smfmac_f32_16x16x64_bf16 v[44:47], v[88:91], a[120:127], v1
    s_waitcnt lgkmcnt(4)
    v_smfmac_f32_16x16x64_bf16 v[40:43], v[84:87], v[76:83], v1
    ds_read_b128 v[76:79], v9 offset:24576
    s_waitcnt vmcnt(6)
    v_cmp_u_f32 vcc, v92, v95
    v_smfmac_f32_16x16x64_bf16 v[40:43], v[88:91], a[24:31], v1
    ds_read_b128 v[80:83], v9 offset:25600
    s_waitcnt lgkmcnt(4)
    v_smfmac_f32_16x16x64_bf16 v[52:55], v[88:91], v[60:67], v1
    ds_read_b128 v[60:63], v9 offset:26624
    buffer_load_dwordx4 v[32:35], v0, s[8:11], s26 offen offset:0
    v_smfmac_f32_16x16x64_bf16 v[48:51], v[88:91], a[128:135], v1
    s_cbranch_vccnz L_rt3_s
L_ok3_s:
    ds_read_b128 v[64:67], v9 offset:27648
    v_smfmac_f32_16x16x64_bf16 v[36:39], v[92:95], a[32:39], v1
    s_waitcnt lgkmcnt(4)
    v_smfmac_f32_16x16x64_bf16 v[56:59], v[88:91], v[68:75], v1
    ds_read_b128 v[68:71], v9 offset:28672
    buffer_load_dwordx4 v[84:87], v0, s[8:11], s30 offen offset:0 sc1
    v_smfmac_f32_16x16x64_bf16 v[44:47], v[92:95], a[136:143], v1
    ds_read_b128 v[72:75], v9 offset:29696
    buffer_load_dwordx4 v[88:91], v0, s[8:11], s30 offen offset:1024 sc1
    s_waitcnt lgkmcnt(4)
    v_smfmac_f32_16x16x64_bf16 v[52:55], v[92:95], v[76:83], v1
    ds_read_b128 v[76:79], v9 offset:30720
    v_smfmac_f32_16x16x64_bf16 v[40:43], v[92:95], a[40:47], v1
    ds_read_b128 v[80:83], v9 offset:31744
    v_smfmac_f32_16x16x64_bf16 v[48:51], v[92:95], a[144:151], v1
    s_waitcnt lgkmcnt(4)
    v_smfmac_f32_16x16x64_bf16 v[56:59], v[92:95], v[60:67], v1
    ds_read_b128 v[60:63], v9 offset:0
    s_waitcnt vmcnt(8)
    v_smfmac_f32_16x16x64_bf16 v[36:39], v[96:99], a[48:55], v1
    ds_read_b128 v[64:67], v9 offset:1024
    s_waitcnt lgkmcnt(4)
    v_smfmac_f32_16x16x64_bf16 v[52:55], v[96:99], v[68:75], v1
    ds_read_b128 v[68:71], v9 offset:2048
    v_smfmac_f32_16x16x64_bf16 v[44:47], v[96:99], a[152:159], v1
    ds_read_b128 v[72:75], v9 offset:3072
    buffer_load_dwordx4 v[92:95], v0, s[8:11], s30 offen offset:2048 sc1
    v_smfmac_f32_16x16x64_bf16 v[40:43], v[96:99], a[56:63], v1
    s_waitcnt lgkmcnt(4) vmcnt(7)
    v_cmp_u_f32 vcc, v16, v19
    v_smfmac_f32_16x16x64_bf16 v[56:59], v[96:99], v[76:83], v1
    ds_read_b128 v[76:79], v9 offset:36864
    v_smfmac_f32_16x16x64_bf16 v[48:51], v[96:99], a[160:167], v1
    s_cbranch_vccnz L_rt5_s
L_ok5_s:
    ds_read_b128 v[80:83], v9 offset:37888
    buffer_load_dwordx4 v[96:99], v0, s[8:11], s30 offen offset:3072 sc1
    v_smfmac_f32_16x16x64_bf16 v[44:47], v[16:19], a[168:175], v1
    s_waitcnt lgkmcnt(4)
    v_smfmac_f32_16x16x64_bf16 v[36:39], v[16:19], v[60:67], v1
    ds_read_b128 v[60:63], v9 offset:4096
    s_waitcnt vmcnt(7)
    v_cmp_u_f32 vcc, v20, v23
    v_smfmac_f32_16x16x64_bf16 v[48:51], v[16:19], a[176:183], v1
    ds_read_b128 v[64:67], v9 offset:5120
    s_waitcnt lgkmcnt(4)
    v_smfmac_f32_16x16x64_bf16 v[40:43], v[16:19], v[68:75], v1
    s_cbranch_vccnz L_rt6_s
L_ok6_s:
    ds_read_b128 v[68:71], v9 offset:6144
    v_smfmac_f32_16x16x64_bf16 v[44:47], v[20:23], a[184:191], v1
    ds_read_b128 v[72:75], v9 offset:7168
    v_smfmac_f32_16x16x64_bf16 v[40:43], v[20:23], a[64:71], v1
    buffer_store_dwordx4 v[12:15], v0, s[12:15], s32 offen offset:1024 sc1
    s_waitcnt lgkmcnt(4)
    v_smfmac_f32_16x16x64_bf16 v[36:39], v[20:23], v[76:83], v1
    ds_read_b128 v[76:79], v9 offset:8192
    v_smfmac_f32_16x16x64_bf16 v[48:51], v[20:23], a[192:199], v1
    ds_read_b128 v[80:83], v9 offset:9216
    s_waitcnt vmcnt(7)
    v_smfmac_f32_16x16x64_bf16 v[44:47], v[24:27], a[200:207], v1
    s_waitcnt lgkmcnt(4)
    v_smfmac_f32_16x16x64_bf16 v[36:39], v[24:27], v[60:67], v1
    ds_read_b128 v[60:63], v9 offset:10240
    v_smfmac_f32_16x16x64_bf16 v[48:51], v[24:27], a[208:215], v1
    ds_read_b128 v[64:67], v9 offset:11264
    s_waitcnt lgkmcnt(4)
    v_smfmac_f32_16x16x64_bf16 v[40:43], v[24:27], v[68:75], v1
    s_waitcnt vmcnt(6)
    v_smfmac_f32_16x16x64_bf16 v[36:39], v[28:31], a[72:79], v1
    v_smfmac_f32_16x16x64_bf16 v[44:47], v[28:31], a[216:223], v1
    v_smfmac_f32_16x16x64_bf16 v[40:43], v[28:31], a[80:87], v1
    buffer_load_dword v7, v5, s[8:11], s31 offen sc1
    v_smfmac_f32_16x16x64_bf16 v[48:51], v[28:31], a[224:231], v1
    s_add_u32 s31, s31, 540672
    s_waitcnt vmcnt(6) lgkmcnt(2)
    v_smfmac_f32_16x16x64_bf16 v[36:39], v[32:35], v[76:83], v1
    s_add_u32 s33, s33, 1
    v_smfmac_f32_16x16x64_bf16 v[44:47], v[32:35], a[232:239], v1
    s_waitcnt lgkmcnt(0)
    v_mov_b32 v15, s33
    v_smfmac_f32_16x16x64_bf16 v[40:43], v[32:35], v[60:67], v1
    buffer_store_dword v15, off, s[16:19], s49 sc1
    s_nop 0
    v_smfmac_f32_16x16x64_bf16 v[48:51], v[32:35], a[240:247], v1
    s_add_u32 s29, s28, 65536
    s_nop 2
    s_mov_b64 s[4:5], -1
L_again_s:
    v_pk_add_f32 v[36:37], v[36:37], v[38:39]
    v_pk_add_f32 v[44:45], v[44:45], v[46:47]
    v_pk_add_f32 v[40:41], v[40:41], v[42:43]
    v_pk_add_f32 v[48:49], v[48:49], v[50:51]
    v_cvt_pk_bf16_f32 v44, v44, v45
    v_cvt_pk_bf16_f32 v45, v36, v37
    v_cvt_pk_bf16_f32 v46, v48, v49
    v_cvt_pk_bf16_f32 v47, v40, v41
    v_mfma_f32_16x16x16_bf16 v[36:39], v[44:45], v[10:11], 0
    s_mov_b64 vcc, s[44:45]
    v_mfma_f32_16x16x16_bf16 v[40:43], v[46:47], v[10:11], 0
    v_cmp_u_f32 s[6:7], v48, v49
    v_mov_b32 v66, 0
    v_mov_b32 v67, 0
    v_mov_b32 v68, 0x3f803f80
    v_mov_b32 v69, 0x3f803f80
    s_waitcnt vmcnt(5)
    v_cvt_pk_bf16_f32 v48, v36, v37
    v_cvt_pk_bf16_f32 v49, v38, v39
    v_cvt_pk_bf16_f32 v50, v40, v41
    v_cvt_pk_bf16_f32 v51, v42, v43
    s_and_b64 s[6:7], s[6:7], s[4:5]
    s_cbranch_scc1 L_net_s
    v_mfma_f32_16x16x32_bf16 v[36:39], v[84:87], v[48:51], 0
    v_add_u32 v76, s48, v0
    v_mfma_f32_16x16x32_bf16 v[40:43], v[88:91], v[48:51], 0
    v_mov_b32 v63, 0
    v_mov_b32 v64, 0
    v_mfma_f32_16x16x32_bf16 v[44:47], v[48:51], v[48:51], 0
    v_xor_b32 v12, 1024, v6
    v_xor_b32 v13, 2048, v6
    v_smfmac_f32_16x16x64_bf16 v[52:55], v[16:19], a[248:255], v1
    s_add_u32 s30, s30, 540672
    s_nop 0
    v_cndmask_b32_dpp v48, v36, v40, vcc quad_perm:[2,3,0,1] row_mask:0xf bank_mask:0xf
    v_cndmask_b32_dpp v49, v37, v41, vcc quad_perm:[2,3,0,1] row_mask:0xf bank_mask:0xf
    v_cndmask_b32_dpp v50, v38, v42, vcc quad_perm:[2,3,0,1] row_mask:0xf bank_mask:0xf
    v_cndmask_b32_dpp v51, v39, v43, vcc quad_perm:[2,3,0,1] row_mask:0xf bank_mask:0xf
    ds_write_b128 v6, v[48:51]
    v_cndmask_b32_dpp v46, v44, v45, vcc quad_perm:[2,3,0,1] row_mask:0xf bank_mask:0xf
    ds_write_b32 v76, v46 offset:4096
    v_smfmac_f32_16x16x64_bf16 v[56:59], v[16:19], v[104:111], v1
    v_xor_b32 v14, 3072, v6
    v_smfmac_f32_16x16x64_bf16 v[52:55], v[20:23], v[112:119], v1
    v_smfmac_f32_16x16x64_bf16 v[56:59], v[20:23], v[120:127], v1
    v_smfmac_f32_16x16x64_bf16 v[52:55], v[24:27], v[128:135], v1
    s_waitcnt lgkmcnt(0)
    s_barrier
    ds_read_b128 v[84:87], v0 offset:4096
    ds_read_b128 v[36:39], v12
    ds_read_b128 v[40:43], v13
    ds_read_b128 v[44:47], v14
    v_smfmac_f32_16x16x64_bf16 v[56:59], v[24:27], v[136:143], v1
    v_smfmac_f32_16x16x64_bf16 v[52:55], v[28:31], v[144:151], v1
    v_smfmac_f32_16x16x64_bf16 v[56:59], v[28:31], v[152:159], v1
    v_smfmac_f32_16x16x64_bf16 v[52:55], v[32:35], v[160:167], v1
    v_smfmac_f32_16x16x64_bf16 v[56:59], v[32:35], v[168:175], v1
    s_waitcnt lgkmcnt(0)
    v_add_f32 v84, v84, v86
    v_add_f32 v85, v85, v87
    v_pk_add_f32 v[36:37], v[36:37], v[40:41]
    v_pk_add_f32 v[38:39], v[38:39], v[42:43]
    v_pk_add_f32 v[44:45], v[44:45], v[48:49]
    v_pk_add_f32 v[46:47], v[46:47], v[50:51]
    v_add_f32 v40, v84, v85
    v_pk_add_f32 v[36:37], v[36:37], v[44:45]
    v_pk_add_f32 v[38:39], v[38:39], v[46:47]
    v_max3_f32 v41, v36, v37, v40
    v_max3_f32 v41, v41, v38, v39
    v_pk_add_f32 v[52:53], v[52:53], v[54:55]
    v_pk_add_f32 v[56:57], v[56:57], v[58:59]
    v_max_f32_dpp v41, v41, v41 quad_perm:[2,3,0,1] row_mask:0xf bank_mask:0xf
    v_mov_b32 v42, v41
    v_cvt_pk_bf16_f32 v60, v52, v53
    v_cvt_pk_bf16_f32 v61, v56, v57
    v_permlane16_swap_b32 v41, v42
    v_max_f32 v41, v41, v42
    v_mov_b32 v42, v41
    s_waitcnt vmcnt(3)
    s_nop 0
    v_permlane32_swap_b32 v41, v42
    v_max_f32 v41, v41, v42
    v_mul_f32 v41, s37, v41
    v_fma_f32 v40, v40, s37, -v41
    v_fma_f32 v36, v36, s37, -v41
    v_fma_f32 v37, v37, s37, -v41
    v_fma_f32 v38, v38, s37, -v41
    v_fma_f32 v39, v39, s37, -v41
    v_exp_f32 v40, v40
    v_exp_f32 v36, v36
    v_exp_f32 v37, v37
    v_mov_b32_dpp v42, v40 quad_perm:[2,3,0,1] row_mask:0xf bank_mask:0xf
    v_exp_f32 v38, v38
    v_exp_f32 v39, v39
    v_cvt_pk_bf16_f32 v62, v40, v42
    v_cvt_pk_bf16_f32 v65, v40, v42
    v_cvt_pk_bf16_f32 v72, v36, v37
    v_cvt_pk_bf16_f32 v73, v38, v39
    v_mfma_f32_16x16x32_bf16 v[44:47], v[60:63], v[62:65], 0
    v_mov_b32_dpp v74, v72 quad_perm:[2,3,0,1] row_mask:0xf bank_mask:0xf
    v_mov_b32_dpp v75, v73 quad_perm:[2,3,0,1] row_mask:0xf bank_mask:0xf
    v_mfma_f32_16x16x32_bf16 v[48:51], v[60:63], v[64:67], 0
    v_mov_b32 v70, 0x3f803f80
    v_mfma_f32_16x16x32_bf16 v[44:47], v[92:95], v[72:75], v[44:47]
    v_mov_b32 v71, 0x3f803f80
    v_mfma_f32_16x16x32_bf16 v[48:51], v[96:99], v[72:75], v[48:51]
    s_nop 4
    s_mov_b64 exec, s[42:43]
    v_cvt_pk_bf16_f32 v36, v44, v45
    v_cvt_pk_bf16_f32 v37, v46, v47
    v_cvt_pk_bf16_f32 v38, v48, v49
    v_cvt_pk_bf16_f32 v39, v50, v51
    ds_write_b128 v8, v[36:39]
    s_mov_b64 exec, -1
    v_mfma_f32_16x16x32_bf16 v[80:83], v[72:75], v[68:71], 0
    v_mfma_f32_16x16x32_bf16 v[80:83], v[64:67], v[68:71], v[80:83]
    v_mfma_f32_32x32x16_bf16 v[16:31], v[64:67], v[62:65], 0
    s_nop 0
    s_waitcnt lgkmcnt(0)
    s_barrier
    ds_read_b128 v[52:55], v0 offset:5120
    ds_read_b128 v[56:59], v0 offset:6144
    v_mfma_f32_16x16x32_bf16 v[32:35], v[64:67], v[62:65], 0
    s_add_u32 s23, s23, 540672
    v_rcp_f32 v80, v80
    v_rcp_f32 v81, v81
    s_nop 0
    s_add_u32 s24, s24, 540672
    s_waitcnt lgkmcnt(1)
    v_smfmac_f32_16x16x64_bf16 v[32:35], v[52:55], v[240:247], v1
    v_smfmac_f32_16x16x64_bf16 v[16:19], v[52:55], v[176:183], v1
    s_waitcnt lgkmcnt(0)
    v_smfmac_f32_16x16x64_bf16 v[32:35], v[56:59], v[248:255], v1
    s_add_u32 s25, s25, 16384
    s_add_u32 s26, s26, 16384
    v_smfmac_f32_16x16x64_bf16 v[20:23], v[52:55], v[184:191], v1
    s_add_u32 s27, s27, 16384
    s_xor_b32 s32, s32, s41
    v_smfmac_f32_16x16x64_bf16 v[16:19], v[56:59], v[192:199], v1
    s_nop 1
    v_add_f32 v32, v32, v34
    v_smfmac_f32_16x16x64_bf16 v[20:23], v[56:59], v[200:207], v1
    v_add_f32 v33, v33, v35
    v_smfmac_f32_16x16x64_bf16 v[24:27], v[52:55], v[208:215], v1
    v_mul_f32 v32, v32, v80
    v_smfmac_f32_16x16x64_bf16 v[28:31], v[52:55], v[216:223], v1
    v_mul_f32 v33, v33, v81
    v_smfmac_f32_16x16x64_bf16 v[24:27], v[56:59], v[224:231], v1
    v_cvt_pk_bf16_f32 v40, v32, v33
    v_smfmac_f32_16x16x64_bf16 v[28:31], v[56:59], v[232:239], v1
    buffer_store_dword v40, v3, s[8:11], s28 offen sc1
    v_pk_add_f32 v[16:17], v[16:17], v[18:19]
    v_pk_add_f32 v[20:21], v[20:21], v[22:23]
    v_pk_mul_f32 v[16:17], v[16:17], v[80:81]
    v_pk_mul_f32 v[20:21], v[20:21], v[80:81]
    v_cvt_pk_bf16_f32 v36, v16, v17
    v_cvt_pk_bf16_f32 v37, v20, v21
    buffer_store_dwordx2 v[36:37], v2, s[8:11], s28 offen sc1
    v_pk_add_f32 v[24:25], v[24:25], v[26:27]
    v_pk_add_f32 v[28:29], v[28:29], v[30:31]
    v_pk_mul_f32 v[24:25], v[24:25], v[80:81]
    v_pk_mul_f32 v[28:29], v[28:29], v[80:81]
    v_cvt_pk_bf16_f32 v38, v24, v25
    v_cvt_pk_bf16_f32 v39, v28, v29
    buffer_store_dwordx2 v[38:39], v2, s[8:11], s29 offen sc1
    v_mov_b32 v41, 0
    v_mov_b32 v42, 0
    v_mov_b32 v43, 0
    v_mov_b32 v44, 0
    v_mov_b32 v45, 0
    v_mov_b32 v46, 0
    v_mov_b32 v47, 0
    v_mov_b32 v48, 0
    v_mov_b32 v49, 0
    v_mov_b32 v50, 0
    v_mov_b32 v51, 0
    v_mov_b32 v52, 0
    v_mov_b32 v53, 0
    v_mov_b32 v54, 0
    v_mov_b32 v55, 0
    v_mov_b32 v56, 0
    v_mov_b32 v57, 0
    v_mov_b32 v58, 0
    v_mov_b32 v59, 0
    v_mov_b32 v36, 0
    v_mov_b32 v37, 0
    v_mov_b32 v38, 0
    v_mov_b32 v39, 0
    v_mov_b32 v40, 0
    s_xor_b32 s28, s28, s35
    s_cmp_eq_u32 s36, 0
    s_cbranch_scc1 L_nred_s
    s_cmp_lg_u32 s22, 1
    s_cbranch_scc1 L_rsE_s
    ds_read_b128 v[60:63], v9 offset:12288
    ds_read_b128 v[64:67], v9 offset:13312
    ds_read_b128 v[68:71], v9 offset:14336
    ds_read_b128 v[72:75], v9 offset:15360
    ds_read_b128 v[76:79], v9 offset:16384
    ds_read_b128 v[80:83], v9 offset:17408
    s_nop 4
    buffer_load_dwordx4 v[16:19], v0, s[8:11], s32 offen offset:0 sc1
    buffer_load_dwordx4 v[20:23], v0, s[8:11], s32 offen offset:1024 sc1
    s_nop 15
    s_nop 3
    buffer_load_dwordx4 v[24:27], v0, s[8:11], s32 offen offset:0 sc1
    buffer_load_dwordx4 v[28:31], v0, s[8:11], s32 offen offset:1024 sc1
    s_nop 5
    buffer_load_dwordx4 v[84:87], v0, s[8:11], s32 offen offset:0 sc1
    buffer_load_dwordx4 v[88:91], v0, s[8:11], s32 offen offset:1024 sc1
    s_nop 13
    buffer_load_dwordx4 v[92:95], v0, s[8:11], s32 offen offset:0 sc1
    buffer_load_dwordx4 v[96:99], v0, s[8:11], s32 offen offset:1024 sc1
    s_mov_b32 s38, 0
    s_cmp_lt_u32 s33, 63
L_rB0_s:
    s_waitcnt vmcnt(7)
    v_mfma_f32_16x16x32_bf16 v[32:35], v[100:103], v[16:19], 0
    s_waitcnt vmcnt(6)
    v_cmp_u_f32 vcc, v19, v23
    v_mfma_f32_16x16x32_bf16 v[32:35], v[100:103], v[20:23], v[32:35]
    s_nop 6
    s_cbranch_vccnz L_rB1_s
    v_cmp_u_f32 vcc, v32, v32
    v_add_f32_dpp v34, v32, v32 row_ror:4 row_mask:0xf bank_mask:0xf
    v_add_f32_dpp v35, v33, v33 row_ror:4 row_mask:0xf bank_mask:0xf
    s_nop 0
    v_add_f32_dpp v32, v34, v34 row_ror:8 row_mask:0xf bank_mask:0xf
    v_add_f32_dpp v33, v35, v35 row_ror:8 row_mask:0xf bank_mask:0xf
    v_cvt_pk_bf16_f32 v14, v32, v33
    s_cbranch_vccnz L_rs_0_s
    buffer_store_dword v14, v4, s[8:11], s23 offen sc1
    buffer_store_dword v14, v4, s[12:15], s27 offen sc1
    s_cbranch_scc1 L_top_s
    s_branch L_done
    .p2align 5
    s_nop 0
    s_nop 0
    s_nop 0
    s_nop 0
L_rB1_s:
    s_waitcnt vmcnt(5)
    v_mfma_f32_16x16x32_bf16 v[32:35], v[100:103], v[24:27], 0
    s_waitcnt vmcnt(4)
    v_cmp_u_f32 vcc, v27, v31
    v_mfma_f32_16x16x32_bf16 v[32:35], v[100:103], v[28:31], v[32:35]
    buffer_load_dwordx4 v[16:19], v0, s[8:11], s32 offen offset:0 sc1
    buffer_load_dwordx4 v[20:23], v0, s[8:11], s32 offen offset:1024 sc1
    s_nop 4
    s_cbranch_vccnz L_rB2_s
    v_cmp_u_f32 vcc, v32, v32
    v_add_f32_dpp v34, v32, v32 row_ror:4 row_mask:0xf bank_mask:0xf
    v_add_f32_dpp v35, v33, v33 row_ror:4 row_mask:0xf bank_mask:0xf
    s_nop 0
    v_add_f32_dpp v32, v34, v34 row_ror:8 row_mask:0xf bank_mask:0xf
    v_add_f32_dpp v33, v35, v35 row_ror:8 row_mask:0xf bank_mask:0xf
    v_cvt_pk_bf16_f32 v14, v32, v33
    s_cbranch_vccnz L_rs_0_s
    buffer_store_dword v14, v4, s[8:11], s23 offen sc1
    buffer_store_dword v14, v4, s[12:15], s27 offen sc1
    s_cbranch_scc1 L_top_s
    s_branch L_done
    .p2align 5
    s_nop 0
    s_nop 0
    s_nop 0
    s_nop 0
L_rB2_s:
    s_waitcnt vmcnt(5)
    v_mfma_f32_16x16x32_bf16 v[32:35], v[100:103], v[84:87], 0
    s_waitcnt vmcnt(4)
    v_cmp_u_f32 vcc, v87, v91
    v_mfma_f32_16x16x32_bf16 v[32:35], v[100:103], v[88:91], v[32:35]
    buffer_load_dwordx4 v[24:27], v0, s[8:11], s32 offen offset:0 sc1
    buffer_load_dwordx4 v[28:31], v0, s[8:11], s32 offen offset:1024 sc1
    s_nop 4
    s_cbranch_vccnz L_rB3_s
    v_cmp_u_f32 vcc, v32, v32
    v_add_f32_dpp v34, v32, v32 row_ror:4 row_mask:0xf bank_mask:0xf
    v_add_f32_dpp v35, v33, v33 row_ror:4 row_mask:0xf bank_mask:0xf
    s_nop 0
    v_add_f32_dpp v32, v34, v34 row_ror:8 row_mask:0xf bank_mask:0xf
    v_add_f32_dpp v33, v35, v35 row_ror:8 row_mask:0xf bank_mask:0xf
    v_cvt_pk_bf16_f32 v14, v32, v33
    s_cbranch_vccnz L_rs_0_s
    buffer_store_dword v14, v4, s[8:11], s23 offen sc1
    buffer_store_dword v14, v4, s[12:15], s27 offen sc1
    s_cbranch_scc1 L_top_s
    s_branch L_done
    .p2align 5
    s_nop 0
    s_nop 0
    s_nop 0
    s_nop 0
L_rB3_s:
    s_waitcnt vmcnt(5)
    v_mfma_f32_16x16x32_bf16 v[32:35], v[100:103], v[92:95], 0
    s_waitcnt vmcnt(4)
    v_cmp_u_f32 vcc, v95, v99
    v_mfma_f32_16x16x32_bf16 v[32:35], v[100:103], v[96:99], v[32:35]
    buffer_load_dwordx4 v[84:87], v0, s[8:11], s32 offen offset:0 sc1
    buffer_load_dwordx4 v[88:91], v0, s[8:11], s32 offen offset:1024 sc1
    s_nop 4
    s_cbranch_vccnz L_rB4_s
    v_cmp_u_f32 vcc, v32, v32
    v_add_f32_dpp v34, v32, v32 row_ror:4 row_mask:0xf bank_mask:0xf
    v_add_f32_dpp v35, v33, v33 row_ror:4 row_mask:0xf bank_mask:0xf
    s_nop 0
    v_add_f32_dpp v32, v34, v34 row_ror:8 row_mask:0xf bank_mask:0xf
    v_add_f32_dpp v33, v35, v35 row_ror:8 row_mask:0xf bank_mask:0xf
    v_cvt_pk_bf16_f32 v14, v32, v33
    s_cbranch_vccnz L_rs_0_s
    buffer_store_dword v14, v4, s[8:11], s23 offen sc1
    buffer_store_dword v14, v4, s[12:15], s27 offen sc1
    s_cbranch_scc1 L_top_s
    s_branch L_done
    .p2align 5
    s_nop 0
    s_nop 0
    s_nop 0
    s_nop 0
L_rB4_s:
    s_waitcnt vmcnt(5)
    v_mfma_f32_16x16x32_bf16 v[32:35], v[100:103], v[16:19], 0
    s_waitcnt vmcnt(4)
    v_cmp_u_f32 vcc, v19, v23
    v_mfma_f32_16x16x32_bf16 v[32:35], v[100:103], v[20:23], v[32:35]
    buffer_load_dwordx4 v[92:95], v0, s[8:11], s32 offen offset:0 sc1
    buffer_load_dwordx4 v[96:99], v0, s[8:11], s32 offen offset:1024 sc1
    s_nop 4
    s_cbranch_vccnz L_rB5_s
    v_cmp_u_f32 vcc, v32, v32
    v_add_f32_dpp v34, v32, v32 row_ror:4 row_mask:0xf bank_mask:0xf
    v_add_f32_dpp v35, v33, v33 row_ror:4 row_mask:0xf bank_mask:0xf
    s_nop 0
    v_add_f32_dpp v32, v34, v34 row_ror:8 row_mask:0xf bank_mask:0xf
    v_add_f32_dpp v33, v35, v35 row_ror:8 row_mask:0xf bank_mask:0xf
    v_cvt_pk_bf16_f32 v14, v32, v33
    s_cbranch_vccnz L_rs_0_s
    buffer_store_dword v14, v4, s[8:11], s23 offen sc1
    buffer_store_dword v14, v4, s[12:15], s27 offen sc1
    s_cbranch_scc1 L_top_s
    s_branch L_done
L_rB5_s:
    s_add_u32 s38, s38, 1
    s_and_b32 s39, s38, 15
    s_cbranch_scc0 L_rs_0_s
    s_cmp_lt_u32 s33, 63
    s_branch L_rB1_s
    .p2align 5
L_rsE_s:
    ds_read_b128 v[60:63], v9 offset:12288
    ds_read_b128 v[64:67], v9 offset:13312
    ds_read_b128 v[68:71], v9 offset:14336
    ds_read_b128 v[72:75], v9 offset:15360
    ds_read_b128 v[76:79], v9 offset:16384
    ds_read_b128 v[80:83], v9 offset:17408
    buffer_load_dwordx4 v[16:19], v0, s[8:11], s32 offen offset:0 sc1
    buffer_load_dwordx4 v[20:23], v0, s[8:11], s32 offen offset:1024 sc1
    s_nop 15
    s_nop 15
    buffer_load_dwordx4 v[24:27], v0, s[8:11], s32 offen offset:0 sc1
    buffer_load_dwordx4 v[28:31], v0, s[8:11], s32 offen offset:1024 sc1
    s_mov_b32 s38, 0
    s_cmp_lt_u32 s33, 63
L_rE0_s:
    s_waitcnt vmcnt(3)
    v_mfma_f32_16x16x32_bf16 v[32:35], v[100:103], v[16:19], 0
    s_waitcnt vmcnt(2)
    v_cmp_u_f32 vcc, v19, v23
    v_mfma_f32_16x16x32_bf16 v[32:35], v[100:103], v[20:23], v[32:35]
    s_nop 6
    s_cbranch_vccnz L_rE1_s
    v_cmp_u_f32 vcc, v32, v32
    v_add_f32_dpp v34, v32, v32 row_ror:4 row_mask:0xf bank_mask:0xf
    v_add_f32_dpp v35, v33, v33 row_ror:4 row_mask:0xf bank_mask:0xf
    s_nop 0
    v_add_f32_dpp v32, v34, v34 row_ror:8 row_mask:0xf bank_mask:0xf
    v_add_f32_dpp v33, v35, v35 row_ror:8 row_mask:0xf bank_mask:0xf
    v_cvt_pk_bf16_f32 v14, v32, v33
    s_cbranch_vccnz L_rs_0_s
    buffer_store_dword v14, v4, s[8:11], s23 offen sc1
    buffer_store_dword v14, v4, s[12:15], s27 offen sc1
    s_cbranch_scc1 L_top_s
    s_branch L_done
    .p2align 5
    s_nop 0
    s_nop 0
    s_nop 0
    s_nop 0
L_rE1_s:
    s_waitcnt vmcnt(1)
    v_mfma_f32_16x16x32_bf16 v[32:35], v[100:103], v[24:27], 0
    s_waitcnt vmcnt(0)
    v_cmp_u_f32 vcc, v27, v31
    v_mfma_f32_16x16x32_bf16 v[32:35], v[100:103], v[28:31], v[32:35]
    buffer_load_dwordx4 v[16:19], v0, s[8:11], s32 offen offset:0 sc1
    buffer_load_dwordx4 v[20:23], v0, s[8:11], s32 offen offset:1024 sc1
    s_nop 4
    s_cbranch_vccnz L_rE2_s
    v_cmp_u_f32 vcc, v32, v32
    v_add_f32_dpp v34, v32, v32 row_ror:4 row_mask:0xf bank_mask:0xf
    v_add_f32_dpp v35, v33, v33 row_ror:4 row_mask:0xf bank_mask:0xf
    s_nop 0
    v_add_f32_dpp v32, v34, v34 row_ror:8 row_mask:0xf bank_mask:0xf
    v_add_f32_dpp v33, v35, v35 row_ror:8 row_mask:0xf bank_mask:0xf
    v_cvt_pk_bf16_f32 v14, v32, v33
    s_cbranch_vccnz L_rs_0_s
    buffer_store_dword v14, v4, s[8:11], s23 offen sc1
    buffer_store_dword v14, v4, s[12:15], s27 offen sc1
    s_cbranch_scc1 L_top_s
    s_branch L_done
    .p2align 5
    s_nop 0
    s_nop 0
    s_nop 0
    s_nop 0
L_rE2_s:
    s_waitcnt vmcnt(1)
    v_mfma_f32_16x16x32_bf16 v[32:35], v[100:103], v[16:19], 0
    s_waitcnt vmcnt(0)
    v_cmp_u_f32 vcc, v19, v23
    v_mfma_f32_16x16x32_bf16 v[32:35], v[100:103], v[20:23], v[32:35]
    buffer_load_dwordx4 v[24:27], v0, s[8:11], s32 offen offset:0 sc1
    buffer_load_dwordx4 v[28:31], v0, s[8:11], s32 offen offset:1024 sc1
    s_nop 4
    s_cbranch_vccnz L_rE3_s
    v_cmp_u_f32 vcc, v32, v32
    v_add_f32_dpp v34, v32, v32 row_ror:4 row_mask:0xf bank_mask:0xf
    v_add_f32_dpp v35, v33, v33 row_ror:4 row_mask:0xf bank_mask:0xf
    s_nop 0
    v_add_f32_dpp v32, v34, v34 row_ror:8 row_mask:0xf bank_mask:0xf
    v_add_f32_dpp v33, v35, v35 row_ror:8 row_mask:0xf bank_mask:0xf
    v_cvt_pk_bf16_f32 v14, v32, v33
    s_cbranch_vccnz L_rs_0_s
    buffer_store_dword v14, v4, s[8:11], s23 offen sc1
    buffer_store_dword v14, v4, s[12:15], s27 offen sc1
    s_cbranch_scc1 L_top_s
    s_branch L_done
L_rE3_s:
    s_add_u32 s38, s38, 1
    s_and_b32 s39, s38, 15
    s_cbranch_scc0 L_rs_0_s
    s_cmp_lt_u32 s33, 63
    s_branch L_rE1_s
L_rs_0_s:
    buffer_load_dwordx4 v[16:19], v0, s[8:11], s32 offen offset:0 sc1
    buffer_load_dwordx4 v[20:23], v0, s[8:11], s32 offen offset:1024 sc1
    s_nop 7
    buffer_load_dwordx4 v[24:27], v0, s[8:11], s32 offen offset:0 sc1
    buffer_load_dwordx4 v[28:31], v0, s[8:11], s32 offen offset:1024 sc1
    s_nop 7
    buffer_load_dwordx4 v[84:87], v0, s[8:11], s32 offen offset:0 sc1
    buffer_load_dwordx4 v[88:91], v0, s[8:11], s32 offen offset:1024 sc1
    s_waitcnt vmcnt(5)
    v_mfma_f32_16x16x32_bf16 v[32:35], v[100:103], v[16:19], 0
    v_max3_u32 v13, v16, v17, v18
    s_waitcnt vmcnt(4)
    v_mfma_f32_16x16x32_bf16 v[32:35], v[100:103], v[20:23], v[32:35]
    v_max3_u32 v12, v20, v21, v22
    v_max3_u32 v13, v13, v19, v23
    v_max_u32 v13, v13, v12
    v_cmp_eq_u32 vcc, -1, v13
    s_nop 3
    v_add_f32_dpp v34, v32, v32 row_ror:4 row_mask:0xf bank_mask:0xf
    v_add_f32_dpp v35, v33, v33 row_ror:4 row_mask:0xf bank_mask:0xf
    s_nop 0
    v_add_f32_dpp v32, v34, v34 row_ror:8 row_mask:0xf bank_mask:0xf
    v_add_f32_dpp v33, v35, v35 row_ror:8 row_mask:0xf bank_mask:0xf
    v_cvt_pk_bf16_f32 v14, v32, v33
    s_cbranch_vccnz L_rs_1_s
L_pub2_s:
    buffer_store_dword v14, v4, s[8:11], s23 offen sc1
    buffer_store_dword v14, v4, s[12:15], s27 offen sc1
L_send_s:
    s_cmp_lt_u32 s33, 63
    s_cbranch_scc1 L_top_s
    s_branch L_done
L_nred_s:
    s_cmp_gt_u32 s47, 63
    s_cbranch_scc1 L_kvw_se
L_kvw_sa:
    s_min_u32 s38, s86, s87
    s_min_u32 s39, s88, s89
    s_lshl_b32 s38, s38, 1
    s_lshl_b32 s39, s39, 1
    s_add_u32 s39, s39, 1
    s_min_u32 s47, s38, s39
    s_add_u32 s38, s33, 1
    s_min_u32 s38, s38, 63
    s_cmp_gt_u32 s47, s38
    s_cbranch_scc1 L_kvw_sd
L_kvw_sb:
    s_load_dword s86, s[84:85], 0 glc
    s_load_dword s87, s[84:85], 4096 glc
    s_load_dword s88, s[84:85], 12288 glc
    s_load_dword s89, s[84:85], 16384 glc
    s_add_u32 s34, s34, 1
    s_cmp_gt_u32 s34, 400000
    s_cbranch_scc1 L_fail
    s_waitcnt lgkmcnt(0)
    s_branch L_kvw_sa
L_kvw_sd:
    s_load_dword s86, s[84:85], 0 glc
    s_load_dword s87, s[84:85], 4096 glc
    s_load_dword s88, s[84:85], 12288 glc
    s_load_dword s89, s[84:85], 16384 glc
L_kvw_se:
    ds_read_b128 v[60:63], v9 offset:12288
    ds_read_b128 v[64:67], v9 offset:13312
    ds_read_b128 v[68:71], v9 offset:14336
    ds_read_b128 v[72:75], v9 offset:15360
    ds_read_b128 v[76:79], v9 offset:16384
    ds_read_b128 v[80:83], v9 offset:17408
    s_branch L_send_s
L_rs_1_s:
    buffer_load_dwordx4 v[16:19], v0, s[8:11], s32 offen offset:0 sc1
    buffer_load_dwordx4 v[20:23], v0, s[8:11], s32 offen offset:1024 sc1
    s_waitcnt vmcnt(5)
    v_mfma_f32_16x16x32_bf16 v[32:35], v[100:103], v[24:27], 0
    v_max3_u32 v13, v24, v25, v26
    s_waitcnt vmcnt(4)
    v_mfma_f32_16x16x32_bf16 v[32:35], v[100:103], v[28:31], v[32:35]
    v_max3_u32 v12, v28, v29, v30
    v_max3_u32 v13, v13, v27, v31
    v_max_u32 v13, v13, v12
    v_cmp_eq_u32 vcc, -1, v13
    s_nop 3
    v_add_f32_dpp v34, v32, v32 row_ror:4 row_mask:0xf bank_mask:0xf
    v_add_f32_dpp v35, v33, v33 row_ror:4 row_mask:0xf bank_mask:0xf
    s_nop 0
    v_add_f32_dpp v32, v34, v34 row_ror:8 row_mask:0xf bank_mask:0xf
    v_add_f32_dpp v33, v35, v35 row_ror:8 row_mask:0xf bank_mask:0xf
    v_cvt_pk_bf16_f32 v14, v32, v33
    s_cbranch_vccz L_pub2_s
    buffer_load_dwordx4 v[24:27], v0, s[8:11], s32 offen offset:0 sc1
    buffer_load_dwordx4 v[28:31], v0, s[8:11], s32 offen offset:1024 sc1
    s_waitcnt vmcnt(5)
    v_mfma_f32_16x16x32_bf16 v[32:35], v[100:103], v[84:87], 0
    v_max3_u32 v13, v84, v85, v86
    s_waitcnt vmcnt(4)
    v_mfma_f32_16x16x32_bf16 v[32:35], v[100:103], v[88:91], v[32:35]
    v_max3_u32 v12, v88, v89, v90
    v_max3_u32 v13, v13, v87, v91
    v_max_u32 v13, v13, v12
    v_cmp_eq_u32 vcc, -1, v13
    s_nop 3
    v_add_f32_dpp v34, v32, v32 row_ror:4 row_mask:0xf bank_mask:0xf
    v_add_f32_dpp v35, v33, v33 row_ror:4 row_mask:0xf bank_mask:0xf
    s_nop 0
    v_add_f32_dpp v32, v34, v34 row_ror:8 row_mask:0xf bank_mask:0xf
    v_add_f32_dpp v33, v35, v35 row_ror:8 row_mask:0xf bank_mask:0xf
    v_cvt_pk_bf16_f32 v14, v32, v33
    s_cbranch_vccz L_pub2_s
    buffer_load_dwordx4 v[84:87], v0, s[8:11], s32 offen offset:0 sc1
    buffer_load_dwordx4 v[88:91], v0, s[8:11], s32 offen offset:1024 sc1
    s_waitcnt vmcnt(5)
    v_mfma_f32_16x16x32_bf16 v[32:35], v[100:103], v[16:19], 0
    v_max3_u32 v13, v16, v17, v18
    s_waitcnt vmcnt(4)
    v_mfma_f32_16x16x32_bf16 v[32:35], v[100:103], v[20:23], v[32:35]
    v_max3_u32 v12, v20, v21, v22
    v_max3_u32 v13, v13, v19, v23
    v_max_u32 v13, v13, v12
    v_cmp_eq_u32 vcc, -1, v13
    s_nop 3
    v_add_f32_dpp v34, v32, v32 row_ror:4 row_mask:0xf bank_mask:0xf
    v_add_f32_dpp v35, v33, v33 row_ror:4 row_mask:0xf bank_mask:0xf
    s_nop 0
    v_add_f32_dpp v32, v34, v34 row_ror:8 row_mask:0xf bank_mask:0xf
    v_add_f32_dpp v33, v35, v35 row_ror:8 row_mask:0xf bank_mask:0xf
    v_cvt_pk_bf16_f32 v14, v32, v33
    s_cbranch_vccz L_pub2_s
    s_add_u32 s34, s34, 1
    s_cmp_gt_u32 s34, 400000
    s_cbranch_scc1 L_fail
    s_branch L_rs_1_s
L_rt0_s:
    buffer_load_dwordx4 v[32:35], v0, s[8:11], s23 offen offset:2048 sc1
    buffer_load_dwordx4 v[84:87], v0, s[8:11], s23 offen offset:3072 sc1
    buffer_load_dwordx4 v[88:91], v0, s[8:11], s23 offen offset:0 sc1
    buffer_load_dwordx4 v[92:95], v0, s[8:11], s23 offen offset:1024 sc1
    buffer_load_dwordx4 v[96:99], v0, s[8:11], s24 offen offset:0 sc1
    s_add_u32 s34, s34, 1
    s_cmp_gt_u32 s34, 400000
    s_cbranch_scc1 L_fail
    s_waitcnt vmcnt(4)
    v_max3_u32 v7, v32, v33, v34
    v_max_u32 v7, v7, v35
    v_cmp_eq_u32 vcc, -1, v7
    s_cbranch_vccnz L_rt0_s
    s_waitcnt vmcnt(3)
    v_max3_u32 v7, v7, v84, v85
    v_max3_u32 v7, v7, v86, v87
    s_waitcnt vmcnt(2)
    v_max3_u32 v7, v7, v88, v89
    v_max3_u32 v7, v7, v90, v91
    s_waitcnt vmcnt(1)
    v_max3_u32 v7, v7, v92, v93
    v_max3_u32 v7, v7, v94, v95
    s_waitcnt vmcnt(0)
    v_max3_u32 v7, v7, v96, v97
    v_max3_u32 v7, v7, v98, v99
    v_cmp_eq_u32 vcc, -1, v7
    s_cbranch_vccz L_ok0_s
    s_branch L_rt0_s
L_rt1_s:
    buffer_load_dwordx4 v[84:87], v0, s[8:11], s23 offen offset:3072 sc1
    buffer_load_dwordx4 v[88:91], v0, s[8:11], s23 offen offset:0 sc1
    buffer_load_dwordx4 v[92:95], v0, s[8:11], s23 offen offset:1024 sc1
    buffer_load_dwordx4 v[96:99], v0, s[8:11], s24 offen offset:0 sc1
    s_add_u32 s34, s34, 1
    s_cmp_gt_u32 s34, 400000
    s_cbranch_scc1 L_fail
    s_waitcnt vmcnt(3)
    v_max3_u32 v7, v84, v85, v86
    v_max_u32 v7, v7, v87
    v_cmp_eq_u32 vcc, -1, v7
    s_cbranch_vccnz L_rt1_s
    s_waitcnt vmcnt(2)
    v_max3_u32 v7, v7, v88, v89
    v_max3_u32 v7, v7, v90, v91
    s_waitcnt vmcnt(1)
    v_max3_u32 v7, v7, v92, v93
    v_max3_u32 v7, v7, v94, v95
    s_waitcnt vmcnt(0)
    v_max3_u32 v7, v7, v96, v97
    v_max3_u32 v7, v7, v98, v99
    v_cmp_eq_u32 vcc, -1, v7
    s_cbranch_vccz L_ok1_s
    s_branch L_rt1_s
L_rt2_s:
    buffer_load_dwordx4 v[88:91], v0, s[8:11], s23 offen offset:0 sc1
    buffer_load_dwordx4 v[92:95], v0, s[8:11], s23 offen offset:1024 sc1
    buffer_load_dwordx4 v[96:99], v0, s[8:11], s24 offen offset:0 sc1
    s_add_u32 s34, s34, 1
    s_cmp_gt_u32 s34, 400000
    s_cbranch_scc1 L_fail
    s_waitcnt vmcnt(2)
    v_max3_u32 v7, v88, v89, v90
    v_max_u32 v7, v7, v91
    v_cmp_eq_u32 vcc, -1, v7
    s_cbranch_vccnz L_rt2_s
    s_waitcnt vmcnt(1)
    v_max3_u32 v7, v7, v92, v93
    v_max3_u32 v7, v7, v94, v95
    s_waitcnt vmcnt(0)
    v_max3_u32 v7, v7, v96, v97
    v_max3_u32 v7, v7, v98, v99
    v_cmp_eq_u32 vcc, -1, v7
    s_cbranch_vccz L_ok2_s
    s_branch L_rt2_s
L_rt3_s:
    buffer_load_dwordx4 v[92:95], v0, s[8:11], s23 offen offset:1024 sc1
    buffer_load_dwordx4 v[96:99], v0, s[8:11], s24 offen offset:0 sc1
    s_add_u32 s34, s34, 1
    s_cmp_gt_u32 s34, 400000
    s_cbranch_scc1 L_fail
    s_waitcnt vmcnt(1)
    v_max3_u32 v7, v92, v93, v94
    v_max_u32 v7, v7, v95
    v_cmp_eq_u32 vcc, -1, v7
    s_cbranch_vccnz L_rt3_s
    s_waitcnt vmcnt(0)
    v_max3_u32 v7, v7, v96, v97
    v_max3_u32 v7, v7, v98, v99
    v_cmp_eq_u32 vcc, -1, v7
    s_cbranch_vccz L_ok3_s
    s_branch L_rt3_s
L_rt5_s:
    buffer_load_dwordx4 v[16:19], v0, s[8:11], s25 offen offset:2048 sc1
    buffer_load_dwordx4 v[20:23], v0, s[8:11], s25 offen offset:3072 sc1
    buffer_load_dwordx4 v[24:27], v0, s[8:11], s25 offen offset:0 sc1
    buffer_load_dwordx4 v[28:31], v0, s[8:11], s25 offen offset:1024 sc1
    buffer_load_dwordx4 v[32:35], v0, s[8:11], s26 offen offset:0 sc1
    s_add_u32 s34, s34, 1
    s_cmp_gt_u32 s34, 400000
    s_cbranch_scc1 L_fail
    s_waitcnt vmcnt(4)
    v_max3_u32 v7, v16, v17, v18
    v_max_u32 v7, v7, v19
    v_cmp_eq_u32 vcc, -1, v7
    s_cbranch_vccnz L_rt5_s
    s_waitcnt vmcnt(3)
    v_max3_u32 v7, v7, v20, v21
    v_max3_u32 v7, v7, v22, v23
    s_waitcnt vmcnt(2)
    v_max3_u32 v7, v7, v24, v25
    v_max3_u32 v7, v7, v26, v27
    s_waitcnt vmcnt(1)
    v_max3_u32 v7, v7, v28, v29
    v_max3_u32 v7, v7, v30, v31
    s_waitcnt vmcnt(0)
    v_max3_u32 v7, v7, v32, v33
    v_max3_u32 v7, v7, v34, v35
    v_cmp_eq_u32 vcc, -1, v7
    s_cbranch_vccz L_ok5_s
    s_branch L_rt5_s
L_rt6_s:
    buffer_load_dwordx4 v[20:23], v0, s[8:11], s25 offen offset:3072 sc1
    buffer_load_dwordx4 v[24:27], v0, s[8:11], s25 offen offset:0 sc1
    buffer_load_dwordx4 v[28:31], v0, s[8:11], s25 offen offset:1024 sc1
    buffer_load_dwordx4 v[32:35], v0, s[8:11], s26 offen offset:0 sc1
    s_add_u32 s34, s34, 1
    s_cmp_gt_u32 s34, 400000
    s_cbranch_scc1 L_fail
    s_waitcnt vmcnt(3)
    v_max3_u32 v7, v20, v21, v22
    v_max_u32 v7, v7, v23
    v_cmp_eq_u32 vcc, -1, v7
    s_cbranch_vccnz L_rt6_s
    s_waitcnt vmcnt(2)
    v_max3_u32 v7, v7, v24, v25
    v_max3_u32 v7, v7, v26, v27
    s_waitcnt vmcnt(1)
    v_max3_u32 v7, v7, v28, v29
    v_max3_u32 v7, v7, v30, v31
    s_waitcnt vmcnt(0)
    v_max3_u32 v7, v7, v32, v33
    v_max3_u32 v7, v7, v34, v35
    v_cmp_eq_u32 vcc, -1, v7
    s_cbranch_vccz L_ok6_s
    s_branch L_rt6_s
L_net_s:
    s_mov_b64 s[4:5], 0
    s_nop 7
    v_mov_b32 v41, 0
    v_mov_b32 v42, 0
    v_mov_b32 v43, 0
    v_mov_b32 v44, 0
    v_mov_b32 v45, 0
    v_mov_b32 v46, 0
    v_mov_b32 v47, 0
    v_mov_b32 v48, 0
    v_mov_b32 v49, 0
    v_mov_b32 v50, 0
    v_mov_b32 v51, 0
    v_mov_b32 v52, 0
    v_mov_b32 v53, 0
    v_mov_b32 v54, 0
    v_mov_b32 v55, 0
    v_mov_b32 v56, 0
    v_mov_b32 v57, 0
    v_mov_b32 v58, 0
    v_mov_b32 v59, 0
    v_mov_b32 v36, 0
    v_mov_b32 v37, 0
    v_mov_b32 v38, 0
    v_mov_b32 v39, 0
    v_mov_b32 v40, 0
    ds_read_b128 v[60:63], v9 offset:12288
    ds_read_b128 v[64:67], v9 offset:13312
    ds_read_b128 v[68:71], v9 offset:14336
    ds_read_b128 v[72:75], v9 offset:15360
    ds_read_b128 v[76:79], v9 offset:16384
    ds_read_b128 v[80:83], v9 offset:17408
L_nt0_s:
    buffer_load_dwordx4 v[16:19], v0, s[8:11], s23 offen offset:2048 sc1
    buffer_load_dwordx4 v[20:23], v0, s[8:11], s23 offen offset:3072 sc1
    buffer_load_dwordx4 v[24:27], v0, s[8:11], s23 offen offset:0 sc1
    buffer_load_dwordx4 v[28:31], v0, s[8:11], s23 offen offset:1024 sc1
    buffer_load_dwordx4 v[32:35], v0, s[8:11], s24 offen offset:0 sc1
    s_add_u32 s34, s34, 1
    s_cmp_gt_u32 s34, 400000
    s_cbranch_scc1 L_fail
    s_waitcnt vmcnt(0)
    v_max_u32 v13, v16, v17
    v_max3_u32 v13, v13, v18, v19
    v_max3_u32 v13, v13, v20, v21
    v_max3_u32 v13, v13, v22, v23
    v_max3_u32 v13, v13, v24, v25
    v_max3_u32 v13, v13, v26, v27
    v_max3_u32 v13, v13, v28, v29
    v_max3_u32 v13, v13, v30, v31
    v_max3_u32 v13, v13, v32, v33
    v_max3_u32 v13, v13, v34, v35
    v_cmp_eq_u32 vcc, -1, v13
    s_cbranch_vccnz L_nt0_s
    s_waitcnt lgkmcnt(4)
    v_smfmac_f32_16x16x64_bf16 v[52:55], v[16:19], v[60:67], v1
    ds_read_b128 v[60:63], v9 offset:18432
    ds_read_b128 v[64:67], v9 offset:19456
    v_smfmac_f32_16x16x64_bf16 v[36:39], v[16:19], a[0:7], v1
    v_smfmac_f32_16x16x64_bf16 v[44:47], v[16:19], a[88:95], v1
    s_waitcnt lgkmcnt(4)
    v_smfmac_f32_16x16x64_bf16 v[56:59], v[16:19], v[68:75], v1
    ds_read_b128 v[68:71], v9 offset:32768
    ds_read_b128 v[72:75], v9 offset:33792
    v_smfmac_f32_16x16x64_bf16 v[40:43], v[16:19], a[8:15], v1
    s_waitcnt lgkmcnt(4)
    v_smfmac_f32_16x16x64_bf16 v[52:55], v[20:23], v[76:83], v1
    ds_read_b128 v[76:79], v9 offset:34816
    ds_read_b128 v[80:83], v9 offset:35840
    v_smfmac_f32_16x16x64_bf16 v[48:51], v[16:19], a[96:103], v1
    v_smfmac_f32_16x16x64_bf16 v[44:47], v[20:23], a[104:111], v1
    s_waitcnt lgkmcnt(4)
    v_smfmac_f32_16x16x64_bf16 v[56:59], v[20:23], v[60:67], v1
    ds_read_b128 v[60:63], v9 offset:20480
    ds_read_b128 v[64:67], v9 offset:21504
    v_smfmac_f32_16x16x64_bf16 v[48:51], v[20:23], a[112:119], v1
    s_waitcnt lgkmcnt(4)
    v_smfmac_f32_16x16x64_bf16 v[36:39], v[20:23], v[68:75], v1
    ds_read_b128 v[68:71], v9 offset:22528
    ds_read_b128 v[72:75], v9 offset:23552
    v_smfmac_f32_16x16x64_bf16 v[36:39], v[24:27], a[16:23], v1
    v_smfmac_f32_16x16x64_bf16 v[44:47], v[24:27], a[120:127], v1
    s_waitcnt lgkmcnt(4)
    v_smfmac_f32_16x16x64_bf16 v[40:43], v[20:23], v[76:83], v1
    ds_read_b128 v[76:79], v9 offset:24576
    ds_read_b128 v[80:83], v9 offset:25600
    v_smfmac_f32_16x16x64_bf16 v[40:43], v[24:27], a[24:31], v1
    s_waitcnt lgkmcnt(4)
    v_smfmac_f32_16x16x64_bf16 v[52:55], v[24:27], v[60:67], v1
    ds_read_b128 v[60:63], v9 offset:26624
    ds_read_b128 v[64:67], v9 offset:27648
    v_smfmac_f32_16x16x64_bf16 v[48:51], v[24:27], a[128:135], v1
    v_smfmac_f32_16x16x64_bf16 v[36:39], v[28:31], a[32:39], v1
    s_waitcnt lgkmcnt(4)
    v_smfmac_f32_16x16x64_bf16 v[56:59], v[24:27], v[68:75], v1
    ds_read_b128 v[68:71], v9 offset:28672
    ds_read_b128 v[72:75], v9 offset:29696
    v_smfmac_f32_16x16x64_bf16 v[44:47], v[28:31], a[136:143], v1
    s_waitcnt lgkmcnt(4)
    v_smfmac_f32_16x16x64_bf16 v[52:55], v[28:31], v[76:83], v1
    ds_read_b128 v[76:79], v9 offset:30720
    ds_read_b128 v[80:83], v9 offset:31744
    v_smfmac_f32_16x16x64_bf16 v[40:43], v[28:31], a[40:47], v1
    v_smfmac_f32_16x16x64_bf16 v[48:51], v[28:31], a[144:151], v1
    s_waitcnt lgkmcnt(4)
    v_smfmac_f32_16x16x64_bf16 v[56:59], v[28:31], v[60:67], v1
    ds_read_b128 v[60:63], v9 offset:0
    ds_read_b128 v[64:67], v9 offset:1024
    v_smfmac_f32_16x16x64_bf16 v[36:39], v[32:35], a[48:55], v1
    s_waitcnt lgkmcnt(4)
    v_smfmac_f32_16x16x64_bf16 v[52:55], v[32:35], v[68:75], v1
    ds_read_b128 v[68:71], v9 offset:2048
    ds_read_b128 v[72:75], v9 offset:3072
    v_smfmac_f32_16x16x64_bf16 v[44:47], v[32:35], a[152:159], v1
    v_smfmac_f32_16x16x64_bf16 v[40:43], v[32:35], a[56:63], v1
    s_waitcnt lgkmcnt(4)
    v_smfmac_f32_16x16x64_bf16 v[56:59], v[32:35], v[76:83], v1
    ds_read_b128 v[76:79], v9 offset:36864
    ds_read_b128 v[80:83], v9 offset:37888
    v_smfmac_f32_16x16x64_bf16 v[48:51], v[32:35], a[160:167], v1
L_nt1_s:
    buffer_load_dwordx4 v[16:19], v0, s[8:11], s25 offen offset:2048 sc1
    buffer_load_dwordx4 v[20:23], v0, s[8:11], s25 offen offset:3072 sc1
    buffer_load_dwordx4 v[24:27], v0, s[8:11], s25 offen offset:0 sc1
    buffer_load_dwordx4 v[28:31], v0, s[8:11], s25 offen offset:1024 sc1
    buffer_load_dwordx4 v[32:35], v0, s[8:11], s26 offen offset:0 sc1
    s_add_u32 s34, s34, 1
    s_cmp_gt_u32 s34, 400000
    s_cbranch_scc1 L_fail
    s_waitcnt vmcnt(0)
    v_max_u32 v13, v16, v17
    v_max3_u32 v13, v13, v18, v19
    v_max3_u32 v13, v13, v20, v21
    v_max3_u32 v13, v13, v22, v23
    v_max3_u32 v13, v13, v24, v25
    v_max3_u32 v13, v13, v26, v27
    v_max3_u32 v13, v13, v28, v29
    v_max3_u32 v13, v13, v30, v31
    v_max3_u32 v13, v13, v32, v33
    v_max3_u32 v13, v13, v34, v35
    v_cmp_eq_u32 vcc, -1, v13
    s_cbranch_vccnz L_nt1_s
    v_smfmac_f32_16x16x64_bf16 v[44:47], v[16:19], a[168:175], v1
    s_waitcnt lgkmcnt(4)
    v_smfmac_f32_16x16x64_bf16 v[36:39], v[16:19], v[60:67], v1
    ds_read_b128 v[60:63], v9 offset:4096
    ds_read_b128 v[64:67], v9 offset:5120
    v_smfmac_f32_16x16x64_bf16 v[48:51], v[16:19], a[176:183], v1
    s_waitcnt lgkmcnt(4)
    v_smfmac_f32_16x16x64_bf16 v[40:43], v[16:19], v[68:75], v1
    ds_read_b128 v[68:71], v9 offset:6144
    ds_read_b128 v[72:75], v9 offset:7168
    v_smfmac_f32_16x16x64_bf16 v[44:47], v[20:23], a[184:191], v1
    v_smfmac_f32_16x16x64_bf16 v[40:43], v[20:23], a[64:71], v1
    s_waitcnt lgkmcnt(4)
    v_smfmac_f32_16x16x64_bf16 v[36:39], v[20:23], v[76:83], v1
    ds_read_b128 v[76:79], v9 offset:8192
    ds_read_b128 v[80:83], v9 offset:9216
    v_smfmac_f32_16x16x64_bf16 v[48:51], v[20:23], a[192:199], v1
    v_smfmac_f32_16x16x64_bf16 v[44:47], v[24:27], a[200:207], v1
    s_waitcnt lgkmcnt(4)
    v_smfmac_f32_16x16x64_bf16 v[36:39], v[24:27], v[60:67], v1
    ds_read_b128 v[60:63], v9 offset:10240
    ds_read_b128 v[64:67], v9 offset:11264
    v_smfmac_f32_16x16x64_bf16 v[48:51], v[24:27], a[208:215], v1
    s_waitcnt lgkmcnt(4)
    v_smfmac_f32_16x16x64_bf16 v[40:43], v[24:27], v[68:75], v1
    v_smfmac_f32_16x16x64_bf16 v[36:39], v[28:31], a[72:79], v1
    v_smfmac_f32_16x16x64_bf16 v[44:47], v[28:31], a[216:223], v1
    v_smfmac_f32_16x16x64_bf16 v[40:43], v[28:31], a[80:87], v1
    v_smfmac_f32_16x16x64_bf16 v[48:51], v[28:31], a[224:231], v1
    s_waitcnt lgkmcnt(2)
    v_smfmac_f32_16x16x64_bf16 v[36:39], v[32:35], v[76:83], v1
    v_smfmac_f32_16x16x64_bf16 v[44:47], v[32:35], a[232:239], v1
    s_waitcnt lgkmcnt(0)
    v_smfmac_f32_16x16x64_bf16 v[40:43], v[32:35], v[60:67], v1
    v_smfmac_f32_16x16x64_bf16 v[48:51], v[32:35], a[240:247], v1
    s_nop 7
    s_branch L_again_s
L_fail:
L_done:
    s_waitcnt vmcnt(0)
L_fin:
L_end:
    s_endpgm

.section .rodata,"a"
.p2align 6
.amdhsa_kernel concat_heads__memory_aug_recurrent_mem_tr__ssm_conv_s4__prompt_kernel
  .amdhsa_next_free_vgpr 512
  .amdhsa_next_free_sgpr 102
  .amdhsa_accum_offset 256
  .amdhsa_group_segment_fixed_size 0
  .amdhsa_kernarg_size 152
  .amdhsa_user_sgpr_count 2
  .amdhsa_user_sgpr_kernarg_segment_ptr 1
  .amdhsa_system_sgpr_workgroup_id_x 1
.end_amdhsa_kernel
```
